```python
import torch

def _softmax(x, axis=-1):
    return torch.softmax(x, dim=axis)

def _gelu(x):
    return torch.nn.functional.gelu(x, approximate='tanh')

def _silu(x):
    return torch.nn.functional.silu(x)

def _sigmoid(x):
    return torch.sigmoid(x)

def _layernorm(x, axis=-1, eps=1e-05):
    m = x.mean(dim=axis, keepdim=True)
    v = x.var(dim=axis, keepdim=True, unbiased=False)
    return (x - m) / torch.sqrt(v + eps)

def _scatter_add(tgt, idx, src, axis=0):
    return tgt.clone().index_add_(axis, idx, src)

def _segment_sum(src, seg, n):
    out = torch.zeros((n,) + src.shape[1:], dtype=src.dtype)
    return out.index_add_(0, seg, src)

def _pad(x, pw):
    flat = tuple((v for pair in reversed(pw) for v in pair))
    return torch.nn.functional.pad(x, flat)
kernel_name = 'parallel_sum__memory_aug_recurrent_mem_tr__glu_gated_glu__prompt'

def setup_inputs():

    _w = lambda a: (lambda t: t.to(torch.bfloat16) if t.is_floating_point() else t)(torch.as_tensor(a))

    def _A_setup():
        B, S, Dm = (1, 2048, 512)
        H, Dh = (32, 128)
        M, seg = (8, 32)
        seg = min(seg, S)
        S = S // seg * seg
        return {'x': _w((lambda *s: torch.randn(*s, dtype=torch.bfloat16) * 0.05)(B, S, Dm)), 'mem0': _w((lambda *s: torch.randn(*s, dtype=torch.bfloat16) * 1.6)(B, M, Dm)), 'Wq': _w((lambda *s: torch.randn(*s, dtype=torch.bfloat16) * 0.8)(Dm, H, Dh) * Dm ** (-0.5)), 'Wk': _w((lambda *s: torch.randn(*s, dtype=torch.bfloat16) * 0.8)(Dm, H, Dh) * Dm ** (-0.5)), 'Wv': _w((lambda *s: torch.randn(*s, dtype=torch.bfloat16) * 1.6)(Dm, H, Dh) * Dm ** (-0.5)), 'Wo': _w((lambda *s: torch.randn(*s, dtype=torch.bfloat16) * 1.6)(H, Dh, Dm) * (H * Dh) ** (-0.5)), 'seg_len': seg}
    _A_in = _A_setup()

    def _B_setup():
        B, S, D, F = (1, 2048, 512, 1792)
        return {'x': _w((lambda *s: torch.randn(*s, dtype=torch.bfloat16) * 0.05)(B, S, D)), 'w_gate': _w((lambda *s: torch.randn(*s, dtype=torch.bfloat16) * 0.05)(D, F)), 'w_up': _w((lambda *s: torch.randn(*s, dtype=torch.bfloat16) * 0.05)(D, F)), 'w_down': _w((lambda *s: torch.randn(*s, dtype=torch.bfloat16) * 0.05)(F, D))}
    _B_in = _B_setup()
    return {'A_x': _A_in['x'], 'A_mem0': _A_in['mem0'], 'A_Wq': _A_in['Wq'], 'A_Wk': _A_in['Wk'], 'A_Wv': _A_in['Wv'], 'A_Wo': _A_in['Wo'], 'A_seg_len': _A_in['seg_len'], 'B_x': _B_in['x'], 'B_w_gate': _B_in['w_gate'], 'B_w_up': _B_in['w_up'], 'B_w_down': _B_in['w_down']}

def reference(A_x, A_mem0, A_Wq, A_Wk, A_Wv, A_Wo, A_seg_len, B_x, B_w_gate, B_w_up, B_w_down):

    def _A_ref(x, mem0, Wq, Wk, Wv, Wo, seg_len):
        B, S, Dm = x.shape
        H, Dh = (Wq.shape[1], Wq.shape[2])
        M = mem0.shape[1]
        scale = Dh ** (-0.5)
        n_seg = S // seg_len
        L = M + seg_len
        idx = torch.arange(L)
        mask = (idx[:, None] < M) | (idx[:, None] >= idx[None, :])
        mem = mem0
        outs = []
        for s in range(n_seg):
            xs = x[:, s * seg_len:(s + 1) * seg_len, :].clone()
            h = torch.concatenate([mem, xs], axis=1)
            q = torch.einsum('btd,dhe->bhte', h, Wq)
            k = torch.einsum('btd,dhe->bhte', h, Wk)
            v = torch.einsum('btd,dhe->bhte', h, Wv)
            scores = torch.einsum('bhqe,bhke->bhqk', q, k) * scale
            scores = torch.where(mask[None, None], scores, -1000000000.0)
            p = _softmax(scores, axis=-1)
            o = torch.einsum('bhqk,bhke->bhqe', p, v)
            o = torch.einsum('bhte,hed->btd', o, Wo)
            mem = o[:, :M, :].clone()
            outs.append(o[:, M:, :])
        return torch.concatenate(outs, axis=1)

    def _B_ref(x, w_gate, w_up, w_down):
        g = torch.einsum('bsd,df->bsf', x, w_gate)
        u = torch.einsum('bsd,df->bsf', x, w_up)
        h = _sigmoid(g) * u
        return torch.einsum('bsf,fd->bsd', h, w_down)
    x = A_x
    xn = _layernorm(x, axis=-1)
    return x + _A_ref(xn, A_mem0, A_Wq, A_Wk, A_Wv, A_Wo, A_seg_len) + _B_ref(xn, B_w_gate, B_w_up, B_w_down)
```

```asm
; @launch kernel=prep_kernel grid=(713,1,1) block=(256,1,1) lds=0
; @launch kernel=chain_kernel grid=(256,1,1) block=(256,1,1) lds=163840
.amdgcn_target "amdgcn-amd-amdhsa--gfx950"
.text
.globl prep_kernel
.p2align 8
.type prep_kernel,@function
prep_kernel:
    s_cmp_ge_u32 s2, 713
    s_cbranch_scc1 L_prep_done
    s_load_dwordx4 s[4:7], s[0:1], 0
    s_load_dwordx2 s[8:9], s[0:1], 104
    s_load_dwordx8 s[24:31], s[0:1], 16
    s_load_dwordx4 s[32:35], s[0:1], 64
    s_load_dwordx2 s[36:37], s[0:1], 80
    v_lshrrev_b32 v1, 6, v0
    v_and_b32 v2, 63, v0
    v_and_b32 v3, 15, v0
    v_readfirstlane_b32 s3, v1
    v_lshrrev_b32 v4, 4, v2
    v_lshlrev_b32 v5, 4, v2
    s_waitcnt lgkmcnt(0)

    s_mov_b32 s40, s8
    s_mov_b32 s41, s9
    s_and_b32 s41, s41, 0xffff
    s_mov_b32 s42, 268435456
    s_mov_b32 s43, 0x00020000
    s_cmp_lt_u32 s2, 32
    s_cbranch_scc1 L_prep_ln
    s_cmp_eq_u32 s2, 712
    s_cbranch_scc1 L_prep_misc
    s_sub_u32 s20, s2, 32
    s_lshl_b32 s20, s20, 2
    s_add_u32 s20, s20, s3
    s_cmp_lt_u32 s20, 1536
    s_cbranch_scc1 L_prep_wqkv
    s_cmp_lt_u32 s20, 1984
    s_cbranch_scc1 L_prep_wgu
    s_cmp_lt_u32 s20, 2496
    s_cbranch_scc1 L_prep_wo

    s_sub_u32 s21, s20, 2496
    s_mul_i32 s22, s21, 9363
    s_lshr_b32 s22, s22, 16
    s_mul_i32 s23, s22, 7
    s_sub_u32 s23, s21, s23
    s_mov_b32 s12, s36
    s_and_b32 s13, s37, 0xffff
    s_mov_b32 s14, 1835008
    s_mov_b32 s16, 1024
    s_lshl_b32 s17, s22, 5
    s_lshl_b32 s18, s23, 3
    s_mul_i32 s19, s22, 56
    s_add_u32 s19, s19, s18
    s_lshl_b32 s19, s19, 10
    s_add_u32 s19, s19, 23068672
    s_branch L_prep_wbody

L_prep_wo:
    s_sub_u32 s21, s20, 1984
    s_lshr_b32 s22, s21, 4
    s_and_b32 s23, s21, 15
    s_mov_b32 s12, s30
    s_and_b32 s13, s31, 0xffff
    s_mov_b32 s14, 4194304
    s_mov_b32 s16, 1024
    s_lshl_b32 s17, s22, 5
    s_lshl_b32 s18, s23, 3
    s_lshl_b32 s19, s22, 7
    s_add_u32 s19, s19, s18
    s_lshl_b32 s19, s19, 10
    s_add_u32 s19, s19, 18874368
    s_branch L_prep_wbody

L_prep_wgu:
    s_sub_u32 s21, s20, 1536
    s_lshr_b32 s22, s21, 1
    s_and_b32 s23, s21, 1
    s_lshr_b32 s44, s22, 3
    s_and_b32 s45, s22, 7
    s_cmp_lt_u32 s45, 4
    s_cselect_b32 s12, s32, s34
    s_cselect_b32 s13, s33, s35
    s_and_b32 s13, s13, 0xffff
    s_mov_b32 s14, 1835008
    s_mov_b32 s16, 3584
    s_and_b32 s45, s45, 3
    s_lshl_b32 s44, s44, 2
    s_add_u32 s44, s44, s45
    s_lshl_b32 s17, s44, 5
    s_lshl_b32 s18, s23, 3
    s_lshl_b32 s19, s22, 4
    s_add_u32 s19, s19, s18
    s_lshl_b32 s19, s19, 10
    s_add_u32 s19, s19, 14680064
    s_branch L_prep_wbody

L_prep_wqkv:
    s_lshr_b32 s22, s20, 1
    s_and_b32 s23, s20, 1
    s_lshr_b32 s44, s22, 8
    s_cmp_eq_u32 s44, 0
    s_cselect_b32 s12, s24, s26
    s_cselect_b32 s13, s25, s27
    s_cmp_eq_u32 s44, 2
    s_cselect_b32 s12, s28, s12
    s_cselect_b32 s13, s29, s13
    s_and_b32 s13, s13, 0xffff
    s_mov_b32 s14, 4194304
    s_mov_b32 s16, 8192
    s_and_b32 s44, s22, 255
    s_lshl_b32 s17, s44, 5
    s_lshl_b32 s18, s23, 3
    s_lshl_b32 s19, s22, 4
    s_add_u32 s19, s19, s18
    s_lshl_b32 s19, s19, 10
    s_add_u32 s19, s19, 2097152

L_prep_wbody:
    s_mov_b32 s15, 0x00020000
    v_lshlrev_b32 v6, 2, v4
    v_mul_lo_u32 v6, v6, s16
    v_lshlrev_b32 v7, 1, v3
    v_add3_u32 v6, v6, v7, s17
    s_lshl_b32 s46, s18, 5
    s_mul_i32 s46, s46, s16

    s_mul_i32 s47, s16, 0
    s_add_u32 s47, s47, s46
    buffer_load_ushort v80, v6, s[12:15], s47 offen
    s_mul_i32 s47, s16, 1
    s_add_u32 s47, s47, s46
    buffer_load_ushort v81, v6, s[12:15], s47 offen
    s_mul_i32 s47, s16, 2
    s_add_u32 s47, s47, s46
    buffer_load_ushort v82, v6, s[12:15], s47 offen
    s_mul_i32 s47, s16, 3
    s_add_u32 s47, s47, s46
    buffer_load_ushort v83, v6, s[12:15], s47 offen
    s_mul_i32 s47, s16, 16
    s_add_u32 s47, s47, s46
    buffer_load_ushort v84, v6, s[12:15], s47 offen
    s_mul_i32 s47, s16, 17
    s_add_u32 s47, s47, s46
    buffer_load_ushort v85, v6, s[12:15], s47 offen
    s_mul_i32 s47, s16, 18
    s_add_u32 s47, s47, s46
    buffer_load_ushort v86, v6, s[12:15], s47 offen
    s_mul_i32 s47, s16, 19
    s_add_u32 s47, s47, s46
    buffer_load_ushort v87, v6, s[12:15], s47 offen
    s_mul_i32 s47, s16, 32
    s_add_u32 s47, s47, s46
    buffer_load_ushort v88, v6, s[12:15], s47 offen
    s_mul_i32 s47, s16, 33
    s_add_u32 s47, s47, s46
    buffer_load_ushort v89, v6, s[12:15], s47 offen
    s_mul_i32 s47, s16, 34
    s_add_u32 s47, s47, s46
    buffer_load_ushort v90, v6, s[12:15], s47 offen
    s_mul_i32 s47, s16, 35
    s_add_u32 s47, s47, s46
    buffer_load_ushort v91, v6, s[12:15], s47 offen
    s_mul_i32 s47, s16, 48
    s_add_u32 s47, s47, s46
    buffer_load_ushort v92, v6, s[12:15], s47 offen
    s_mul_i32 s47, s16, 49
    s_add_u32 s47, s47, s46
    buffer_load_ushort v93, v6, s[12:15], s47 offen
    s_mul_i32 s47, s16, 50
    s_add_u32 s47, s47, s46
    buffer_load_ushort v94, v6, s[12:15], s47 offen
    s_mul_i32 s47, s16, 51
    s_add_u32 s47, s47, s46
    buffer_load_ushort v95, v6, s[12:15], s47 offen
    s_mul_i32 s47, s16, 64
    s_add_u32 s47, s47, s46
    buffer_load_ushort v96, v6, s[12:15], s47 offen
    s_mul_i32 s47, s16, 65
    s_add_u32 s47, s47, s46
    buffer_load_ushort v97, v6, s[12:15], s47 offen
    s_mul_i32 s47, s16, 66
    s_add_u32 s47, s47, s46
    buffer_load_ushort v98, v6, s[12:15], s47 offen
    s_mul_i32 s47, s16, 67
    s_add_u32 s47, s47, s46
    buffer_load_ushort v99, v6, s[12:15], s47 offen
    s_mul_i32 s47, s16, 80
    s_add_u32 s47, s47, s46
    buffer_load_ushort v100, v6, s[12:15], s47 offen
    s_mul_i32 s47, s16, 81
    s_add_u32 s47, s47, s46
    buffer_load_ushort v101, v6, s[12:15], s47 offen
    s_mul_i32 s47, s16, 82
    s_add_u32 s47, s47, s46
    buffer_load_ushort v102, v6, s[12:15], s47 offen
    s_mul_i32 s47, s16, 83
    s_add_u32 s47, s47, s46
    buffer_load_ushort v103, v6, s[12:15], s47 offen
    s_mul_i32 s47, s16, 96
    s_add_u32 s47, s47, s46
    buffer_load_ushort v104, v6, s[12:15], s47 offen
    s_mul_i32 s47, s16, 97
    s_add_u32 s47, s47, s46
    buffer_load_ushort v105, v6, s[12:15], s47 offen
    s_mul_i32 s47, s16, 98
    s_add_u32 s47, s47, s46
    buffer_load_ushort v106, v6, s[12:15], s47 offen
    s_mul_i32 s47, s16, 99
    s_add_u32 s47, s47, s46
    buffer_load_ushort v107, v6, s[12:15], s47 offen
    s_mul_i32 s47, s16, 112
    s_add_u32 s47, s47, s46
    buffer_load_ushort v108, v6, s[12:15], s47 offen
    s_mul_i32 s47, s16, 113
    s_add_u32 s47, s47, s46
    buffer_load_ushort v109, v6, s[12:15], s47 offen
    s_mul_i32 s47, s16, 114
    s_add_u32 s47, s47, s46
    buffer_load_ushort v110, v6, s[12:15], s47 offen
    s_mul_i32 s47, s16, 115
    s_add_u32 s47, s47, s46
    buffer_load_ushort v111, v6, s[12:15], s47 offen
    s_mul_i32 s47, s16, 128
    s_add_u32 s47, s47, s46
    buffer_load_ushort v112, v6, s[12:15], s47 offen
    s_mul_i32 s47, s16, 129
    s_add_u32 s47, s47, s46
    buffer_load_ushort v113, v6, s[12:15], s47 offen
    s_mul_i32 s47, s16, 130
    s_add_u32 s47, s47, s46
    buffer_load_ushort v114, v6, s[12:15], s47 offen
    s_mul_i32 s47, s16, 131
    s_add_u32 s47, s47, s46
    buffer_load_ushort v115, v6, s[12:15], s47 offen
    s_mul_i32 s47, s16, 144
    s_add_u32 s47, s47, s46
    buffer_load_ushort v116, v6, s[12:15], s47 offen
    s_mul_i32 s47, s16, 145
    s_add_u32 s47, s47, s46
    buffer_load_ushort v117, v6, s[12:15], s47 offen
    s_mul_i32 s47, s16, 146
    s_add_u32 s47, s47, s46
    buffer_load_ushort v118, v6, s[12:15], s47 offen
    s_mul_i32 s47, s16, 147
    s_add_u32 s47, s47, s46
    buffer_load_ushort v119, v6, s[12:15], s47 offen
    s_mul_i32 s47, s16, 160
    s_add_u32 s47, s47, s46
    buffer_load_ushort v120, v6, s[12:15], s47 offen
    s_mul_i32 s47, s16, 161
    s_add_u32 s47, s47, s46
    buffer_load_ushort v121, v6, s[12:15], s47 offen
    s_mul_i32 s47, s16, 162
    s_add_u32 s47, s47, s46
    buffer_load_ushort v122, v6, s[12:15], s47 offen
    s_mul_i32 s47, s16, 163
    s_add_u32 s47, s47, s46
    buffer_load_ushort v123, v6, s[12:15], s47 offen
    s_mul_i32 s47, s16, 176
    s_add_u32 s47, s47, s46
    buffer_load_ushort v124, v6, s[12:15], s47 offen
    s_mul_i32 s47, s16, 177
    s_add_u32 s47, s47, s46
    buffer_load_ushort v125, v6, s[12:15], s47 offen
    s_mul_i32 s47, s16, 178
    s_add_u32 s47, s47, s46
    buffer_load_ushort v126, v6, s[12:15], s47 offen
    s_mul_i32 s47, s16, 179
    s_add_u32 s47, s47, s46
    buffer_load_ushort v127, v6, s[12:15], s47 offen
    s_mul_i32 s47, s16, 192
    s_add_u32 s47, s47, s46
    buffer_load_ushort v128, v6, s[12:15], s47 offen
    s_mul_i32 s47, s16, 193
    s_add_u32 s47, s47, s46
    buffer_load_ushort v129, v6, s[12:15], s47 offen
    s_mul_i32 s47, s16, 194
    s_add_u32 s47, s47, s46
    buffer_load_ushort v130, v6, s[12:15], s47 offen
    s_mul_i32 s47, s16, 195
    s_add_u32 s47, s47, s46
    buffer_load_ushort v131, v6, s[12:15], s47 offen
    s_mul_i32 s47, s16, 208
    s_add_u32 s47, s47, s46
    buffer_load_ushort v132, v6, s[12:15], s47 offen
    s_mul_i32 s47, s16, 209
    s_add_u32 s47, s47, s46
    buffer_load_ushort v133, v6, s[12:15], s47 offen
    s_mul_i32 s47, s16, 210
    s_add_u32 s47, s47, s46
    buffer_load_ushort v134, v6, s[12:15], s47 offen
    s_mul_i32 s47, s16, 211
    s_add_u32 s47, s47, s46
    buffer_load_ushort v135, v6, s[12:15], s47 offen
    s_mul_i32 s47, s16, 224
    s_add_u32 s47, s47, s46
    buffer_load_ushort v136, v6, s[12:15], s47 offen
    s_mul_i32 s47, s16, 225
    s_add_u32 s47, s47, s46
    buffer_load_ushort v137, v6, s[12:15], s47 offen
    s_mul_i32 s47, s16, 226
    s_add_u32 s47, s47, s46
    buffer_load_ushort v138, v6, s[12:15], s47 offen
    s_mul_i32 s47, s16, 227
    s_add_u32 s47, s47, s46
    buffer_load_ushort v139, v6, s[12:15], s47 offen
    s_mul_i32 s47, s16, 240
    s_add_u32 s47, s47, s46
    buffer_load_ushort v140, v6, s[12:15], s47 offen
    s_mul_i32 s47, s16, 241
    s_add_u32 s47, s47, s46
    buffer_load_ushort v141, v6, s[12:15], s47 offen
    s_mul_i32 s47, s16, 242
    s_add_u32 s47, s47, s46
    buffer_load_ushort v142, v6, s[12:15], s47 offen
    s_mul_i32 s47, s16, 243
    s_add_u32 s47, s47, s46
    buffer_load_ushort v143, v6, s[12:15], s47 offen
    v_add_u32 v7, s19, v5
    s_waitcnt vmcnt(56)
    v_lshl_or_b32 v10, v81, 16, v80
    v_lshl_or_b32 v11, v83, 16, v82
    v_lshl_or_b32 v12, v85, 16, v84
    v_lshl_or_b32 v13, v87, 16, v86
    buffer_store_dwordx4 v[10:13], v7, s[40:43], 0 offen offset:0
    s_waitcnt vmcnt(49)
    v_lshl_or_b32 v14, v89, 16, v88
    v_lshl_or_b32 v15, v91, 16, v90
    v_lshl_or_b32 v16, v93, 16, v92
    v_lshl_or_b32 v17, v95, 16, v94
    buffer_store_dwordx4 v[14:17], v7, s[40:43], 0 offen offset:1024
    s_waitcnt vmcnt(42)
    v_lshl_or_b32 v18, v97, 16, v96
    v_lshl_or_b32 v19, v99, 16, v98
    v_lshl_or_b32 v20, v101, 16, v100
    v_lshl_or_b32 v21, v103, 16, v102
    buffer_store_dwordx4 v[18:21], v7, s[40:43], 0 offen offset:2048
    s_waitcnt vmcnt(35)
    v_lshl_or_b32 v22, v105, 16, v104
    v_lshl_or_b32 v23, v107, 16, v106
    v_lshl_or_b32 v24, v109, 16, v108
    v_lshl_or_b32 v25, v111, 16, v110
    buffer_store_dwordx4 v[22:25], v7, s[40:43], 0 offen offset:3072
    v_add_u32 v7, 4096, v7
    s_waitcnt vmcnt(28)
    v_lshl_or_b32 v26, v113, 16, v112
    v_lshl_or_b32 v27, v115, 16, v114
    v_lshl_or_b32 v28, v117, 16, v116
    v_lshl_or_b32 v29, v119, 16, v118
    buffer_store_dwordx4 v[26:29], v7, s[40:43], 0 offen offset:0
    s_waitcnt vmcnt(21)
    v_lshl_or_b32 v30, v121, 16, v120
    v_lshl_or_b32 v31, v123, 16, v122
    v_lshl_or_b32 v32, v125, 16, v124
    v_lshl_or_b32 v33, v127, 16, v126
    buffer_store_dwordx4 v[30:33], v7, s[40:43], 0 offen offset:1024
    s_waitcnt vmcnt(14)
    v_lshl_or_b32 v34, v129, 16, v128
    v_lshl_or_b32 v35, v131, 16, v130
    v_lshl_or_b32 v36, v133, 16, v132
    v_lshl_or_b32 v37, v135, 16, v134
    buffer_store_dwordx4 v[34:37], v7, s[40:43], 0 offen offset:2048
    s_waitcnt vmcnt(7)
    v_lshl_or_b32 v38, v137, 16, v136
    v_lshl_or_b32 v39, v139, 16, v138
    v_lshl_or_b32 v40, v141, 16, v140
    v_lshl_or_b32 v41, v143, 16, v142
    buffer_store_dwordx4 v[38:41], v7, s[40:43], 0 offen offset:3072
    s_branch L_prep_done
L_prep_misc:
    s_mov_b32 s12, s6
    s_mov_b32 s13, s7
    s_and_b32 s13, s13, 0xffff
    s_mov_b32 s14, 8192
    s_mov_b32 s15, 0x00020000
    v_and_b32 v6, 7, v2
    v_lshlrev_b32 v6, 10, v6
    v_bfe_u32 v7, v2, 3, 2
    v_lshl_add_u32 v6, v7, 3, v6
    v_lshrrev_b32 v7, 5, v2
    v_lshl_add_u32 v6, v7, 6, v6
    s_lshl_b32 s20, s3, 8
    v_add_u32 v6, s20, v6

    buffer_load_dwordx2 v[10:11], v6, s[12:15], 0 offen offset:0
    buffer_load_dwordx2 v[12:13], v6, s[12:15], 0 offen offset:32
    buffer_load_dwordx2 v[14:15], v6, s[12:15], 0 offen offset:128
    buffer_load_dwordx2 v[16:17], v6, s[12:15], 0 offen offset:160
    s_lshl_b32 s20, s3, 11
    s_add_u32 s20, s20, 118489088
    v_add_u32 v7, s20, v5
    v_mov_b32 v30, -1
    v_mov_b32 v31, -1
    v_mov_b32 v32, -1
    v_mov_b32 v33, -1
    v_lshlrev_b32 v9, 5, v0
    v_add_u32 v9, 118497280, v9
    buffer_store_dwordx4 v[30:33], v9, s[40:43], 0 offen
    buffer_store_dwordx4 v[30:33], v9, s[40:43], 0 offen offset:16
    v_mov_b32 v34, 0
    v_mov_b32 v35, 0
    v_mov_b32 v36, 0
    v_mov_b32 v37, 0
    v_lshlrev_b32 v9, 5, v0
    v_add_u32 v9, 119537664, v9
    buffer_store_dwordx4 v[34:37], v9, s[40:43], 0 offen
    buffer_store_dwordx4 v[34:37], v9, s[40:43], 0 offen offset:16
    s_waitcnt vmcnt(4)

    buffer_store_dwordx4 v[10:13], v7, s[40:43], 0 offen offset:0
    buffer_store_dwordx4 v[14:17], v7, s[40:43], 0 offen offset:1024
    s_branch L_prep_done
L_prep_ln:
    s_mov_b32 s12, s4
    s_mov_b32 s13, s5
    s_and_b32 s13, s13, 0xffff
    s_mov_b32 s14, 2097152
    s_mov_b32 s15, 0x00020000
    v_mov_b32 v30, -1
    v_mov_b32 v31, -1
    v_mov_b32 v32, -1
    v_mov_b32 v33, -1
    s_lshl_b32 s20, s2, 15
    s_add_u32 s20, s20, 117440512
    v_lshlrev_b32 v9, 4, v0

    s_add_u32 s21, s20, 0
    buffer_store_dwordx4 v[30:33], v9, s[40:43], s21 offen
    s_add_u32 s21, s20, 4096
    buffer_store_dwordx4 v[30:33], v9, s[40:43], s21 offen
    s_add_u32 s21, s20, 8192
    buffer_store_dwordx4 v[30:33], v9, s[40:43], s21 offen
    s_add_u32 s21, s20, 12288
    buffer_store_dwordx4 v[30:33], v9, s[40:43], s21 offen
    s_add_u32 s21, s20, 16384
    buffer_store_dwordx4 v[30:33], v9, s[40:43], s21 offen
    s_add_u32 s21, s20, 20480
    buffer_store_dwordx4 v[30:33], v9, s[40:43], s21 offen
    s_add_u32 s21, s20, 24576
    buffer_store_dwordx4 v[30:33], v9, s[40:43], s21 offen
    s_add_u32 s21, s20, 28672
    buffer_store_dwordx4 v[30:33], v9, s[40:43], s21 offen
    s_lshl_b32 s20, s2, 2
    s_add_u32 s20, s20, s3
    s_lshl_b32 s21, s20, 14
    v_lshlrev_b32 v6, 10, v3
    v_lshl_add_u32 v6, v4, 3, v6
    v_add_u32 v6, s21, v6

    buffer_load_dwordx2 v[10:11], v6, s[12:15], 0 offen offset:0
    buffer_load_dwordx2 v[12:13], v6, s[12:15], 0 offen offset:32
    buffer_load_dwordx2 v[14:15], v6, s[12:15], 0 offen offset:64
    buffer_load_dwordx2 v[16:17], v6, s[12:15], 0 offen offset:96
    buffer_load_dwordx2 v[18:19], v6, s[12:15], 0 offen offset:128
    buffer_load_dwordx2 v[20:21], v6, s[12:15], 0 offen offset:160
    buffer_load_dwordx2 v[22:23], v6, s[12:15], 0 offen offset:192
    buffer_load_dwordx2 v[24:25], v6, s[12:15], 0 offen offset:224
    buffer_load_dwordx2 v[26:27], v6, s[12:15], 0 offen offset:256
    buffer_load_dwordx2 v[28:29], v6, s[12:15], 0 offen offset:288
    buffer_load_dwordx2 v[30:31], v6, s[12:15], 0 offen offset:320
    buffer_load_dwordx2 v[32:33], v6, s[12:15], 0 offen offset:352
    buffer_load_dwordx2 v[34:35], v6, s[12:15], 0 offen offset:384
    buffer_load_dwordx2 v[36:37], v6, s[12:15], 0 offen offset:416
    buffer_load_dwordx2 v[38:39], v6, s[12:15], 0 offen offset:448
    buffer_load_dwordx2 v[40:41], v6, s[12:15], 0 offen offset:480
    buffer_load_dwordx2 v[42:43], v6, s[12:15], 0 offen offset:512
    buffer_load_dwordx2 v[44:45], v6, s[12:15], 0 offen offset:544
    buffer_load_dwordx2 v[46:47], v6, s[12:15], 0 offen offset:576
    buffer_load_dwordx2 v[48:49], v6, s[12:15], 0 offen offset:608
    buffer_load_dwordx2 v[50:51], v6, s[12:15], 0 offen offset:640
    buffer_load_dwordx2 v[52:53], v6, s[12:15], 0 offen offset:672
    buffer_load_dwordx2 v[54:55], v6, s[12:15], 0 offen offset:704
    buffer_load_dwordx2 v[56:57], v6, s[12:15], 0 offen offset:736
    buffer_load_dwordx2 v[58:59], v6, s[12:15], 0 offen offset:768
    buffer_load_dwordx2 v[60:61], v6, s[12:15], 0 offen offset:800
    buffer_load_dwordx2 v[62:63], v6, s[12:15], 0 offen offset:832
    buffer_load_dwordx2 v[64:65], v6, s[12:15], 0 offen offset:864
    buffer_load_dwordx2 v[66:67], v6, s[12:15], 0 offen offset:896
    buffer_load_dwordx2 v[68:69], v6, s[12:15], 0 offen offset:928
    buffer_load_dwordx2 v[70:71], v6, s[12:15], 0 offen offset:960
    buffer_load_dwordx2 v[72:73], v6, s[12:15], 0 offen offset:992
    v_xor_b32 v7, 16, v2
    v_lshlrev_b32 v7, 2, v7
    v_xor_b32 v8, 32, v2
    v_lshlrev_b32 v8, 2, v8
    s_waitcnt vmcnt(0)

    v_lshlrev_b32 v80, 16, v10
    v_and_b32 v81, 0xffff0000, v10
    v_lshlrev_b32 v82, 16, v11
    v_and_b32 v83, 0xffff0000, v11
    v_lshlrev_b32 v84, 16, v12
    v_and_b32 v85, 0xffff0000, v12
    v_lshlrev_b32 v86, 16, v13
    v_and_b32 v87, 0xffff0000, v13
    v_lshlrev_b32 v88, 16, v14
    v_and_b32 v89, 0xffff0000, v14
    v_lshlrev_b32 v90, 16, v15
    v_and_b32 v91, 0xffff0000, v15
    v_lshlrev_b32 v92, 16, v16
    v_and_b32 v93, 0xffff0000, v16
    v_lshlrev_b32 v94, 16, v17
    v_and_b32 v95, 0xffff0000, v17
    v_lshlrev_b32 v96, 16, v18
    v_and_b32 v97, 0xffff0000, v18
    v_lshlrev_b32 v98, 16, v19
    v_and_b32 v99, 0xffff0000, v19
    v_lshlrev_b32 v100, 16, v20
    v_and_b32 v101, 0xffff0000, v20
    v_lshlrev_b32 v102, 16, v21
    v_and_b32 v103, 0xffff0000, v21
    v_lshlrev_b32 v104, 16, v22
    v_and_b32 v105, 0xffff0000, v22
    v_lshlrev_b32 v106, 16, v23
    v_and_b32 v107, 0xffff0000, v23
    v_lshlrev_b32 v108, 16, v24
    v_and_b32 v109, 0xffff0000, v24
    v_lshlrev_b32 v110, 16, v25
    v_and_b32 v111, 0xffff0000, v25
    v_lshlrev_b32 v112, 16, v26
    v_and_b32 v113, 0xffff0000, v26
    v_lshlrev_b32 v114, 16, v27
    v_and_b32 v115, 0xffff0000, v27
    v_lshlrev_b32 v116, 16, v28
    v_and_b32 v117, 0xffff0000, v28
    v_lshlrev_b32 v118, 16, v29
    v_and_b32 v119, 0xffff0000, v29
    v_lshlrev_b32 v120, 16, v30
    v_and_b32 v121, 0xffff0000, v30
    v_lshlrev_b32 v122, 16, v31
    v_and_b32 v123, 0xffff0000, v31
    v_lshlrev_b32 v124, 16, v32
    v_and_b32 v125, 0xffff0000, v32
    v_lshlrev_b32 v126, 16, v33
    v_and_b32 v127, 0xffff0000, v33
    v_lshlrev_b32 v128, 16, v34
    v_and_b32 v129, 0xffff0000, v34
    v_lshlrev_b32 v130, 16, v35
    v_and_b32 v131, 0xffff0000, v35
    v_lshlrev_b32 v132, 16, v36
    v_and_b32 v133, 0xffff0000, v36
    v_lshlrev_b32 v134, 16, v37
    v_and_b32 v135, 0xffff0000, v37
    v_lshlrev_b32 v136, 16, v38
    v_and_b32 v137, 0xffff0000, v38
    v_lshlrev_b32 v138, 16, v39
    v_and_b32 v139, 0xffff0000, v39
    v_lshlrev_b32 v140, 16, v40
    v_and_b32 v141, 0xffff0000, v40
    v_lshlrev_b32 v142, 16, v41
    v_and_b32 v143, 0xffff0000, v41
    v_lshlrev_b32 v144, 16, v42
    v_and_b32 v145, 0xffff0000, v42
    v_lshlrev_b32 v146, 16, v43
    v_and_b32 v147, 0xffff0000, v43
    v_lshlrev_b32 v148, 16, v44
    v_and_b32 v149, 0xffff0000, v44
    v_lshlrev_b32 v150, 16, v45
    v_and_b32 v151, 0xffff0000, v45
    v_lshlrev_b32 v152, 16, v46
    v_and_b32 v153, 0xffff0000, v46
    v_lshlrev_b32 v154, 16, v47
    v_and_b32 v155, 0xffff0000, v47
    v_lshlrev_b32 v156, 16, v48
    v_and_b32 v157, 0xffff0000, v48
    v_lshlrev_b32 v158, 16, v49
    v_and_b32 v159, 0xffff0000, v49
    v_lshlrev_b32 v160, 16, v50
    v_and_b32 v161, 0xffff0000, v50
    v_lshlrev_b32 v162, 16, v51
    v_and_b32 v163, 0xffff0000, v51
    v_lshlrev_b32 v164, 16, v52
    v_and_b32 v165, 0xffff0000, v52
    v_lshlrev_b32 v166, 16, v53
    v_and_b32 v167, 0xffff0000, v53
    v_lshlrev_b32 v168, 16, v54
    v_and_b32 v169, 0xffff0000, v54
    v_lshlrev_b32 v170, 16, v55
    v_and_b32 v171, 0xffff0000, v55
    v_lshlrev_b32 v172, 16, v56
    v_and_b32 v173, 0xffff0000, v56
    v_lshlrev_b32 v174, 16, v57
    v_and_b32 v175, 0xffff0000, v57
    v_lshlrev_b32 v176, 16, v58
    v_and_b32 v177, 0xffff0000, v58
    v_lshlrev_b32 v178, 16, v59
    v_and_b32 v179, 0xffff0000, v59
    v_lshlrev_b32 v180, 16, v60
    v_and_b32 v181, 0xffff0000, v60
    v_lshlrev_b32 v182, 16, v61
    v_and_b32 v183, 0xffff0000, v61
    v_lshlrev_b32 v184, 16, v62
    v_and_b32 v185, 0xffff0000, v62
    v_lshlrev_b32 v186, 16, v63
    v_and_b32 v187, 0xffff0000, v63
    v_lshlrev_b32 v188, 16, v64
    v_and_b32 v189, 0xffff0000, v64
    v_lshlrev_b32 v190, 16, v65
    v_and_b32 v191, 0xffff0000, v65
    v_lshlrev_b32 v192, 16, v66
    v_and_b32 v193, 0xffff0000, v66
    v_lshlrev_b32 v194, 16, v67
    v_and_b32 v195, 0xffff0000, v67
    v_lshlrev_b32 v196, 16, v68
    v_and_b32 v197, 0xffff0000, v68
    v_lshlrev_b32 v198, 16, v69
    v_and_b32 v199, 0xffff0000, v69
    v_lshlrev_b32 v200, 16, v70
    v_and_b32 v201, 0xffff0000, v70
    v_lshlrev_b32 v202, 16, v71
    v_and_b32 v203, 0xffff0000, v71
    v_lshlrev_b32 v204, 16, v72
    v_and_b32 v205, 0xffff0000, v72
    v_lshlrev_b32 v206, 16, v73
    v_and_b32 v207, 0xffff0000, v73
    v_add_f32 v74, v80, v81
    v_add_f32 v75, v82, v83
    v_add_f32 v74, v74, v84
    v_add_f32 v75, v75, v85
    v_add_f32 v74, v74, v86
    v_add_f32 v75, v75, v87
    v_add_f32 v74, v74, v88
    v_add_f32 v75, v75, v89
    v_add_f32 v74, v74, v90
    v_add_f32 v75, v75, v91
    v_add_f32 v74, v74, v92
    v_add_f32 v75, v75, v93
    v_add_f32 v74, v74, v94
    v_add_f32 v75, v75, v95
    v_add_f32 v74, v74, v96
    v_add_f32 v75, v75, v97
    v_add_f32 v74, v74, v98
    v_add_f32 v75, v75, v99
    v_add_f32 v74, v74, v100
    v_add_f32 v75, v75, v101
    v_add_f32 v74, v74, v102
    v_add_f32 v75, v75, v103
    v_add_f32 v74, v74, v104
    v_add_f32 v75, v75, v105
    v_add_f32 v74, v74, v106
    v_add_f32 v75, v75, v107
    v_add_f32 v74, v74, v108
    v_add_f32 v75, v75, v109
    v_add_f32 v74, v74, v110
    v_add_f32 v75, v75, v111
    v_add_f32 v74, v74, v112
    v_add_f32 v75, v75, v113
    v_add_f32 v74, v74, v114
    v_add_f32 v75, v75, v115
    v_add_f32 v74, v74, v116
    v_add_f32 v75, v75, v117
    v_add_f32 v74, v74, v118
    v_add_f32 v75, v75, v119
    v_add_f32 v74, v74, v120
    v_add_f32 v75, v75, v121
    v_add_f32 v74, v74, v122
    v_add_f32 v75, v75, v123
    v_add_f32 v74, v74, v124
    v_add_f32 v75, v75, v125
    v_add_f32 v74, v74, v126
    v_add_f32 v75, v75, v127
    v_add_f32 v74, v74, v128
    v_add_f32 v75, v75, v129
    v_add_f32 v74, v74, v130
    v_add_f32 v75, v75, v131
    v_add_f32 v74, v74, v132
    v_add_f32 v75, v75, v133
    v_add_f32 v74, v74, v134
    v_add_f32 v75, v75, v135
    v_add_f32 v74, v74, v136
    v_add_f32 v75, v75, v137
    v_add_f32 v74, v74, v138
    v_add_f32 v75, v75, v139
    v_add_f32 v74, v74, v140
    v_add_f32 v75, v75, v141
    v_add_f32 v74, v74, v142
    v_add_f32 v75, v75, v143
    v_add_f32 v74, v74, v144
    v_add_f32 v75, v75, v145
    v_add_f32 v74, v74, v146
    v_add_f32 v75, v75, v147
    v_add_f32 v74, v74, v148
    v_add_f32 v75, v75, v149
    v_add_f32 v74, v74, v150
    v_add_f32 v75, v75, v151
    v_add_f32 v74, v74, v152
    v_add_f32 v75, v75, v153
    v_add_f32 v74, v74, v154
    v_add_f32 v75, v75, v155
    v_add_f32 v74, v74, v156
    v_add_f32 v75, v75, v157
    v_add_f32 v74, v74, v158
    v_add_f32 v75, v75, v159
    v_add_f32 v74, v74, v160
    v_add_f32 v75, v75, v161
    v_add_f32 v74, v74, v162
    v_add_f32 v75, v75, v163
    v_add_f32 v74, v74, v164
    v_add_f32 v75, v75, v165
    v_add_f32 v74, v74, v166
    v_add_f32 v75, v75, v167
    v_add_f32 v74, v74, v168
    v_add_f32 v75, v75, v169
    v_add_f32 v74, v74, v170
    v_add_f32 v75, v75, v171
    v_add_f32 v74, v74, v172
    v_add_f32 v75, v75, v173
    v_add_f32 v74, v74, v174
    v_add_f32 v75, v75, v175
    v_add_f32 v74, v74, v176
    v_add_f32 v75, v75, v177
    v_add_f32 v74, v74, v178
    v_add_f32 v75, v75, v179
    v_add_f32 v74, v74, v180
    v_add_f32 v75, v75, v181
    v_add_f32 v74, v74, v182
    v_add_f32 v75, v75, v183
    v_add_f32 v74, v74, v184
    v_add_f32 v75, v75, v185
    v_add_f32 v74, v74, v186
    v_add_f32 v75, v75, v187
    v_add_f32 v74, v74, v188
    v_add_f32 v75, v75, v189
    v_add_f32 v74, v74, v190
    v_add_f32 v75, v75, v191
    v_add_f32 v74, v74, v192
    v_add_f32 v75, v75, v193
    v_add_f32 v74, v74, v194
    v_add_f32 v75, v75, v195
    v_add_f32 v74, v74, v196
    v_add_f32 v75, v75, v197
    v_add_f32 v74, v74, v198
    v_add_f32 v75, v75, v199
    v_add_f32 v74, v74, v200
    v_add_f32 v75, v75, v201
    v_add_f32 v74, v74, v202
    v_add_f32 v75, v75, v203
    v_add_f32 v74, v74, v204
    v_add_f32 v75, v75, v205
    v_add_f32 v74, v74, v206
    v_add_f32 v75, v75, v207
    v_add_f32 v74, v74, v75
    ds_bpermute_b32 v76, v7, v74
    s_waitcnt lgkmcnt(0)
    v_add_f32 v74, v74, v76
    ds_bpermute_b32 v76, v8, v74
    s_waitcnt lgkmcnt(0)
    v_add_f32 v74, v74, v76

    v_mul_f32 v74, 0x3b000000, v74
    v_mov_b32 v75, 0
    v_mov_b32 v77, 0
    v_sub_f32 v78, v80, v74
    v_sub_f32 v79, v81, v74
    v_fmac_f32 v75, v78, v78
    v_fmac_f32 v77, v79, v79
    v_sub_f32 v78, v82, v74
    v_sub_f32 v79, v83, v74
    v_fmac_f32 v75, v78, v78
    v_fmac_f32 v77, v79, v79
    v_sub_f32 v78, v84, v74
    v_sub_f32 v79, v85, v74
    v_fmac_f32 v75, v78, v78
    v_fmac_f32 v77, v79, v79
    v_sub_f32 v78, v86, v74
    v_sub_f32 v79, v87, v74
    v_fmac_f32 v75, v78, v78
    v_fmac_f32 v77, v79, v79
    v_sub_f32 v78, v88, v74
    v_sub_f32 v79, v89, v74
    v_fmac_f32 v75, v78, v78
    v_fmac_f32 v77, v79, v79
    v_sub_f32 v78, v90, v74
    v_sub_f32 v79, v91, v74
    v_fmac_f32 v75, v78, v78
    v_fmac_f32 v77, v79, v79
    v_sub_f32 v78, v92, v74
    v_sub_f32 v79, v93, v74
    v_fmac_f32 v75, v78, v78
    v_fmac_f32 v77, v79, v79
    v_sub_f32 v78, v94, v74
    v_sub_f32 v79, v95, v74
    v_fmac_f32 v75, v78, v78
    v_fmac_f32 v77, v79, v79
    v_sub_f32 v78, v96, v74
    v_sub_f32 v79, v97, v74
    v_fmac_f32 v75, v78, v78
    v_fmac_f32 v77, v79, v79
    v_sub_f32 v78, v98, v74
    v_sub_f32 v79, v99, v74
    v_fmac_f32 v75, v78, v78
    v_fmac_f32 v77, v79, v79
    v_sub_f32 v78, v100, v74
    v_sub_f32 v79, v101, v74
    v_fmac_f32 v75, v78, v78
    v_fmac_f32 v77, v79, v79
    v_sub_f32 v78, v102, v74
    v_sub_f32 v79, v103, v74
    v_fmac_f32 v75, v78, v78
    v_fmac_f32 v77, v79, v79
    v_sub_f32 v78, v104, v74
    v_sub_f32 v79, v105, v74
    v_fmac_f32 v75, v78, v78
    v_fmac_f32 v77, v79, v79
    v_sub_f32 v78, v106, v74
    v_sub_f32 v79, v107, v74
    v_fmac_f32 v75, v78, v78
    v_fmac_f32 v77, v79, v79
    v_sub_f32 v78, v108, v74
    v_sub_f32 v79, v109, v74
    v_fmac_f32 v75, v78, v78
    v_fmac_f32 v77, v79, v79
    v_sub_f32 v78, v110, v74
    v_sub_f32 v79, v111, v74
    v_fmac_f32 v75, v78, v78
    v_fmac_f32 v77, v79, v79
    v_sub_f32 v78, v112, v74
    v_sub_f32 v79, v113, v74
    v_fmac_f32 v75, v78, v78
    v_fmac_f32 v77, v79, v79
    v_sub_f32 v78, v114, v74
    v_sub_f32 v79, v115, v74
    v_fmac_f32 v75, v78, v78
    v_fmac_f32 v77, v79, v79
    v_sub_f32 v78, v116, v74
    v_sub_f32 v79, v117, v74
    v_fmac_f32 v75, v78, v78
    v_fmac_f32 v77, v79, v79
    v_sub_f32 v78, v118, v74
    v_sub_f32 v79, v119, v74
    v_fmac_f32 v75, v78, v78
    v_fmac_f32 v77, v79, v79
    v_sub_f32 v78, v120, v74
    v_sub_f32 v79, v121, v74
    v_fmac_f32 v75, v78, v78
    v_fmac_f32 v77, v79, v79
    v_sub_f32 v78, v122, v74
    v_sub_f32 v79, v123, v74
    v_fmac_f32 v75, v78, v78
    v_fmac_f32 v77, v79, v79
    v_sub_f32 v78, v124, v74
    v_sub_f32 v79, v125, v74
    v_fmac_f32 v75, v78, v78
    v_fmac_f32 v77, v79, v79
    v_sub_f32 v78, v126, v74
    v_sub_f32 v79, v127, v74
    v_fmac_f32 v75, v78, v78
    v_fmac_f32 v77, v79, v79
    v_sub_f32 v78, v128, v74
    v_sub_f32 v79, v129, v74
    v_fmac_f32 v75, v78, v78
    v_fmac_f32 v77, v79, v79
    v_sub_f32 v78, v130, v74
    v_sub_f32 v79, v131, v74
    v_fmac_f32 v75, v78, v78
    v_fmac_f32 v77, v79, v79
    v_sub_f32 v78, v132, v74
    v_sub_f32 v79, v133, v74
    v_fmac_f32 v75, v78, v78
    v_fmac_f32 v77, v79, v79
    v_sub_f32 v78, v134, v74
    v_sub_f32 v79, v135, v74
    v_fmac_f32 v75, v78, v78
    v_fmac_f32 v77, v79, v79
    v_sub_f32 v78, v136, v74
    v_sub_f32 v79, v137, v74
    v_fmac_f32 v75, v78, v78
    v_fmac_f32 v77, v79, v79
    v_sub_f32 v78, v138, v74
    v_sub_f32 v79, v139, v74
    v_fmac_f32 v75, v78, v78
    v_fmac_f32 v77, v79, v79
    v_sub_f32 v78, v140, v74
    v_sub_f32 v79, v141, v74
    v_fmac_f32 v75, v78, v78
    v_fmac_f32 v77, v79, v79
    v_sub_f32 v78, v142, v74
    v_sub_f32 v79, v143, v74
    v_fmac_f32 v75, v78, v78
    v_fmac_f32 v77, v79, v79
    v_sub_f32 v78, v144, v74
    v_sub_f32 v79, v145, v74
    v_fmac_f32 v75, v78, v78
    v_fmac_f32 v77, v79, v79
    v_sub_f32 v78, v146, v74
    v_sub_f32 v79, v147, v74
    v_fmac_f32 v75, v78, v78
    v_fmac_f32 v77, v79, v79
    v_sub_f32 v78, v148, v74
    v_sub_f32 v79, v149, v74
    v_fmac_f32 v75, v78, v78
    v_fmac_f32 v77, v79, v79
    v_sub_f32 v78, v150, v74
    v_sub_f32 v79, v151, v74
    v_fmac_f32 v75, v78, v78
    v_fmac_f32 v77, v79, v79
    v_sub_f32 v78, v152, v74
    v_sub_f32 v79, v153, v74
    v_fmac_f32 v75, v78, v78
    v_fmac_f32 v77, v79, v79
    v_sub_f32 v78, v154, v74
    v_sub_f32 v79, v155, v74
    v_fmac_f32 v75, v78, v78
    v_fmac_f32 v77, v79, v79
    v_sub_f32 v78, v156, v74
    v_sub_f32 v79, v157, v74
    v_fmac_f32 v75, v78, v78
    v_fmac_f32 v77, v79, v79
    v_sub_f32 v78, v158, v74
    v_sub_f32 v79, v159, v74
    v_fmac_f32 v75, v78, v78
    v_fmac_f32 v77, v79, v79
    v_sub_f32 v78, v160, v74
    v_sub_f32 v79, v161, v74
    v_fmac_f32 v75, v78, v78
    v_fmac_f32 v77, v79, v79
    v_sub_f32 v78, v162, v74
    v_sub_f32 v79, v163, v74
    v_fmac_f32 v75, v78, v78
    v_fmac_f32 v77, v79, v79
    v_sub_f32 v78, v164, v74
    v_sub_f32 v79, v165, v74
    v_fmac_f32 v75, v78, v78
    v_fmac_f32 v77, v79, v79
    v_sub_f32 v78, v166, v74
    v_sub_f32 v79, v167, v74
    v_fmac_f32 v75, v78, v78
    v_fmac_f32 v77, v79, v79
    v_sub_f32 v78, v168, v74
    v_sub_f32 v79, v169, v74
    v_fmac_f32 v75, v78, v78
    v_fmac_f32 v77, v79, v79
    v_sub_f32 v78, v170, v74
    v_sub_f32 v79, v171, v74
    v_fmac_f32 v75, v78, v78
    v_fmac_f32 v77, v79, v79
    v_sub_f32 v78, v172, v74
    v_sub_f32 v79, v173, v74
    v_fmac_f32 v75, v78, v78
    v_fmac_f32 v77, v79, v79
    v_sub_f32 v78, v174, v74
    v_sub_f32 v79, v175, v74
    v_fmac_f32 v75, v78, v78
    v_fmac_f32 v77, v79, v79
    v_sub_f32 v78, v176, v74
    v_sub_f32 v79, v177, v74
    v_fmac_f32 v75, v78, v78
    v_fmac_f32 v77, v79, v79
    v_sub_f32 v78, v178, v74
    v_sub_f32 v79, v179, v74
    v_fmac_f32 v75, v78, v78
    v_fmac_f32 v77, v79, v79
    v_sub_f32 v78, v180, v74
    v_sub_f32 v79, v181, v74
    v_fmac_f32 v75, v78, v78
    v_fmac_f32 v77, v79, v79
    v_sub_f32 v78, v182, v74
    v_sub_f32 v79, v183, v74
    v_fmac_f32 v75, v78, v78
    v_fmac_f32 v77, v79, v79
    v_sub_f32 v78, v184, v74
    v_sub_f32 v79, v185, v74
    v_fmac_f32 v75, v78, v78
    v_fmac_f32 v77, v79, v79
    v_sub_f32 v78, v186, v74
    v_sub_f32 v79, v187, v74
    v_fmac_f32 v75, v78, v78
    v_fmac_f32 v77, v79, v79
    v_sub_f32 v78, v188, v74
    v_sub_f32 v79, v189, v74
    v_fmac_f32 v75, v78, v78
    v_fmac_f32 v77, v79, v79
    v_sub_f32 v78, v190, v74
    v_sub_f32 v79, v191, v74
    v_fmac_f32 v75, v78, v78
    v_fmac_f32 v77, v79, v79
    v_sub_f32 v78, v192, v74
    v_sub_f32 v79, v193, v74
    v_fmac_f32 v75, v78, v78
    v_fmac_f32 v77, v79, v79
    v_sub_f32 v78, v194, v74
    v_sub_f32 v79, v195, v74
    v_fmac_f32 v75, v78, v78
    v_fmac_f32 v77, v79, v79
    v_sub_f32 v78, v196, v74
    v_sub_f32 v79, v197, v74
    v_fmac_f32 v75, v78, v78
    v_fmac_f32 v77, v79, v79
    v_sub_f32 v78, v198, v74
    v_sub_f32 v79, v199, v74
    v_fmac_f32 v75, v78, v78
    v_fmac_f32 v77, v79, v79
    v_sub_f32 v78, v200, v74
    v_sub_f32 v79, v201, v74
    v_fmac_f32 v75, v78, v78
    v_fmac_f32 v77, v79, v79
    v_sub_f32 v78, v202, v74
    v_sub_f32 v79, v203, v74
    v_fmac_f32 v75, v78, v78
    v_fmac_f32 v77, v79, v79
    v_sub_f32 v78, v204, v74
    v_sub_f32 v79, v205, v74
    v_fmac_f32 v75, v78, v78
    v_fmac_f32 v77, v79, v79
    v_sub_f32 v78, v206, v74
    v_sub_f32 v79, v207, v74
    v_fmac_f32 v75, v78, v78
    v_fmac_f32 v77, v79, v79
    v_add_f32 v75, v75, v77
    ds_bpermute_b32 v76, v7, v75
    s_waitcnt lgkmcnt(0)
    v_add_f32 v75, v75, v76
    ds_bpermute_b32 v76, v8, v75
    s_waitcnt lgkmcnt(0)
    v_add_f32 v75, v75, v76

    v_mul_f32 v75, 0x3b000000, v75
    v_cvt_pk_bf16_f32 v76, v74, v75
    v_lshlrev_b32 v74, 16, v76
    v_and_b32 v75, 0xffff0000, v76
    v_add_f32 v75, 0x3727c5ac, v75
    v_cvt_pk_bf16_f32 v76, v75, v75
    v_lshlrev_b32 v75, 16, v76
    v_sqrt_f32 v75, v75
    s_nop 0
    v_cvt_pk_bf16_f32 v76, v75, v75
    v_lshlrev_b32 v75, 16, v76
    v_rcp_f32 v75, v75
    s_nop 0

    v_sub_f32 v78, v80, v74
    v_sub_f32 v79, v81, v74
    v_cvt_pk_bf16_f32 v76, v78, v79
    v_lshlrev_b32 v78, 16, v76
    v_and_b32 v79, 0xffff0000, v76
    v_mul_f32 v78, v78, v75
    v_mul_f32 v79, v79, v75
    v_cvt_pk_bf16_f32 v10, v78, v79

    v_sub_f32 v78, v82, v74
    v_sub_f32 v79, v83, v74
    v_cvt_pk_bf16_f32 v76, v78, v79
    v_lshlrev_b32 v78, 16, v76
    v_and_b32 v79, 0xffff0000, v76
    v_mul_f32 v78, v78, v75
    v_mul_f32 v79, v79, v75
    v_cvt_pk_bf16_f32 v11, v78, v79

    v_sub_f32 v78, v84, v74
    v_sub_f32 v79, v85, v74
    v_cvt_pk_bf16_f32 v76, v78, v79
    v_lshlrev_b32 v78, 16, v76
    v_and_b32 v79, 0xffff0000, v76
    v_mul_f32 v78, v78, v75
    v_mul_f32 v79, v79, v75
    v_cvt_pk_bf16_f32 v12, v78, v79

    v_sub_f32 v78, v86, v74
    v_sub_f32 v79, v87, v74
    v_cvt_pk_bf16_f32 v76, v78, v79
    v_lshlrev_b32 v78, 16, v76
    v_and_b32 v79, 0xffff0000, v76
    v_mul_f32 v78, v78, v75
    v_mul_f32 v79, v79, v75
    v_cvt_pk_bf16_f32 v13, v78, v79

    v_sub_f32 v78, v88, v74
    v_sub_f32 v79, v89, v74
    v_cvt_pk_bf16_f32 v76, v78, v79
    v_lshlrev_b32 v78, 16, v76
    v_and_b32 v79, 0xffff0000, v76
    v_mul_f32 v78, v78, v75
    v_mul_f32 v79, v79, v75
    v_cvt_pk_bf16_f32 v14, v78, v79

    v_sub_f32 v78, v90, v74
    v_sub_f32 v79, v91, v74
    v_cvt_pk_bf16_f32 v76, v78, v79
    v_lshlrev_b32 v78, 16, v76
    v_and_b32 v79, 0xffff0000, v76
    v_mul_f32 v78, v78, v75
    v_mul_f32 v79, v79, v75
    v_cvt_pk_bf16_f32 v15, v78, v79

    v_sub_f32 v78, v92, v74
    v_sub_f32 v79, v93, v74
    v_cvt_pk_bf16_f32 v76, v78, v79
    v_lshlrev_b32 v78, 16, v76
    v_and_b32 v79, 0xffff0000, v76
    v_mul_f32 v78, v78, v75
    v_mul_f32 v79, v79, v75
    v_cvt_pk_bf16_f32 v16, v78, v79

    v_sub_f32 v78, v94, v74
    v_sub_f32 v79, v95, v74
    v_cvt_pk_bf16_f32 v76, v78, v79
    v_lshlrev_b32 v78, 16, v76
    v_and_b32 v79, 0xffff0000, v76
    v_mul_f32 v78, v78, v75
    v_mul_f32 v79, v79, v75
    v_cvt_pk_bf16_f32 v17, v78, v79

    v_sub_f32 v78, v96, v74
    v_sub_f32 v79, v97, v74
    v_cvt_pk_bf16_f32 v76, v78, v79
    v_lshlrev_b32 v78, 16, v76
    v_and_b32 v79, 0xffff0000, v76
    v_mul_f32 v78, v78, v75
    v_mul_f32 v79, v79, v75
    v_cvt_pk_bf16_f32 v18, v78, v79

    v_sub_f32 v78, v98, v74
    v_sub_f32 v79, v99, v74
    v_cvt_pk_bf16_f32 v76, v78, v79
    v_lshlrev_b32 v78, 16, v76
    v_and_b32 v79, 0xffff0000, v76
    v_mul_f32 v78, v78, v75
    v_mul_f32 v79, v79, v75
    v_cvt_pk_bf16_f32 v19, v78, v79

    v_sub_f32 v78, v100, v74
    v_sub_f32 v79, v101, v74
    v_cvt_pk_bf16_f32 v76, v78, v79
    v_lshlrev_b32 v78, 16, v76
    v_and_b32 v79, 0xffff0000, v76
    v_mul_f32 v78, v78, v75
    v_mul_f32 v79, v79, v75
    v_cvt_pk_bf16_f32 v20, v78, v79

    v_sub_f32 v78, v102, v74
    v_sub_f32 v79, v103, v74
    v_cvt_pk_bf16_f32 v76, v78, v79
    v_lshlrev_b32 v78, 16, v76
    v_and_b32 v79, 0xffff0000, v76
    v_mul_f32 v78, v78, v75
    v_mul_f32 v79, v79, v75
    v_cvt_pk_bf16_f32 v21, v78, v79

    v_sub_f32 v78, v104, v74
    v_sub_f32 v79, v105, v74
    v_cvt_pk_bf16_f32 v76, v78, v79
    v_lshlrev_b32 v78, 16, v76
    v_and_b32 v79, 0xffff0000, v76
    v_mul_f32 v78, v78, v75
    v_mul_f32 v79, v79, v75
    v_cvt_pk_bf16_f32 v22, v78, v79

    v_sub_f32 v78, v106, v74
    v_sub_f32 v79, v107, v74
    v_cvt_pk_bf16_f32 v76, v78, v79
    v_lshlrev_b32 v78, 16, v76
    v_and_b32 v79, 0xffff0000, v76
    v_mul_f32 v78, v78, v75
    v_mul_f32 v79, v79, v75
    v_cvt_pk_bf16_f32 v23, v78, v79

    v_sub_f32 v78, v108, v74
    v_sub_f32 v79, v109, v74
    v_cvt_pk_bf16_f32 v76, v78, v79
    v_lshlrev_b32 v78, 16, v76
    v_and_b32 v79, 0xffff0000, v76
    v_mul_f32 v78, v78, v75
    v_mul_f32 v79, v79, v75
    v_cvt_pk_bf16_f32 v24, v78, v79

    v_sub_f32 v78, v110, v74
    v_sub_f32 v79, v111, v74
    v_cvt_pk_bf16_f32 v76, v78, v79
    v_lshlrev_b32 v78, 16, v76
    v_and_b32 v79, 0xffff0000, v76
    v_mul_f32 v78, v78, v75
    v_mul_f32 v79, v79, v75
    v_cvt_pk_bf16_f32 v25, v78, v79

    v_sub_f32 v78, v112, v74
    v_sub_f32 v79, v113, v74
    v_cvt_pk_bf16_f32 v76, v78, v79
    v_lshlrev_b32 v78, 16, v76
    v_and_b32 v79, 0xffff0000, v76
    v_mul_f32 v78, v78, v75
    v_mul_f32 v79, v79, v75
    v_cvt_pk_bf16_f32 v26, v78, v79

    v_sub_f32 v78, v114, v74
    v_sub_f32 v79, v115, v74
    v_cvt_pk_bf16_f32 v76, v78, v79
    v_lshlrev_b32 v78, 16, v76
    v_and_b32 v79, 0xffff0000, v76
    v_mul_f32 v78, v78, v75
    v_mul_f32 v79, v79, v75
    v_cvt_pk_bf16_f32 v27, v78, v79

    v_sub_f32 v78, v116, v74
    v_sub_f32 v79, v117, v74
    v_cvt_pk_bf16_f32 v76, v78, v79
    v_lshlrev_b32 v78, 16, v76
    v_and_b32 v79, 0xffff0000, v76
    v_mul_f32 v78, v78, v75
    v_mul_f32 v79, v79, v75
    v_cvt_pk_bf16_f32 v28, v78, v79

    v_sub_f32 v78, v118, v74
    v_sub_f32 v79, v119, v74
    v_cvt_pk_bf16_f32 v76, v78, v79
    v_lshlrev_b32 v78, 16, v76
    v_and_b32 v79, 0xffff0000, v76
    v_mul_f32 v78, v78, v75
    v_mul_f32 v79, v79, v75
    v_cvt_pk_bf16_f32 v29, v78, v79

    v_sub_f32 v78, v120, v74
    v_sub_f32 v79, v121, v74
    v_cvt_pk_bf16_f32 v76, v78, v79
    v_lshlrev_b32 v78, 16, v76
    v_and_b32 v79, 0xffff0000, v76
    v_mul_f32 v78, v78, v75
    v_mul_f32 v79, v79, v75
    v_cvt_pk_bf16_f32 v30, v78, v79

    v_sub_f32 v78, v122, v74
    v_sub_f32 v79, v123, v74
    v_cvt_pk_bf16_f32 v76, v78, v79
    v_lshlrev_b32 v78, 16, v76
    v_and_b32 v79, 0xffff0000, v76
    v_mul_f32 v78, v78, v75
    v_mul_f32 v79, v79, v75
    v_cvt_pk_bf16_f32 v31, v78, v79

    v_sub_f32 v78, v124, v74
    v_sub_f32 v79, v125, v74
    v_cvt_pk_bf16_f32 v76, v78, v79
    v_lshlrev_b32 v78, 16, v76
    v_and_b32 v79, 0xffff0000, v76
    v_mul_f32 v78, v78, v75
    v_mul_f32 v79, v79, v75
    v_cvt_pk_bf16_f32 v32, v78, v79

    v_sub_f32 v78, v126, v74
    v_sub_f32 v79, v127, v74
    v_cvt_pk_bf16_f32 v76, v78, v79
    v_lshlrev_b32 v78, 16, v76
    v_and_b32 v79, 0xffff0000, v76
    v_mul_f32 v78, v78, v75
    v_mul_f32 v79, v79, v75
    v_cvt_pk_bf16_f32 v33, v78, v79

    v_sub_f32 v78, v128, v74
    v_sub_f32 v79, v129, v74
    v_cvt_pk_bf16_f32 v76, v78, v79
    v_lshlrev_b32 v78, 16, v76
    v_and_b32 v79, 0xffff0000, v76
    v_mul_f32 v78, v78, v75
    v_mul_f32 v79, v79, v75
    v_cvt_pk_bf16_f32 v34, v78, v79

    v_sub_f32 v78, v130, v74
    v_sub_f32 v79, v131, v74
    v_cvt_pk_bf16_f32 v76, v78, v79
    v_lshlrev_b32 v78, 16, v76
    v_and_b32 v79, 0xffff0000, v76
    v_mul_f32 v78, v78, v75
    v_mul_f32 v79, v79, v75
    v_cvt_pk_bf16_f32 v35, v78, v79

    v_sub_f32 v78, v132, v74
    v_sub_f32 v79, v133, v74
    v_cvt_pk_bf16_f32 v76, v78, v79
    v_lshlrev_b32 v78, 16, v76
    v_and_b32 v79, 0xffff0000, v76
    v_mul_f32 v78, v78, v75
    v_mul_f32 v79, v79, v75
    v_cvt_pk_bf16_f32 v36, v78, v79

    v_sub_f32 v78, v134, v74
    v_sub_f32 v79, v135, v74
    v_cvt_pk_bf16_f32 v76, v78, v79
    v_lshlrev_b32 v78, 16, v76
    v_and_b32 v79, 0xffff0000, v76
    v_mul_f32 v78, v78, v75
    v_mul_f32 v79, v79, v75
    v_cvt_pk_bf16_f32 v37, v78, v79

    v_sub_f32 v78, v136, v74
    v_sub_f32 v79, v137, v74
    v_cvt_pk_bf16_f32 v76, v78, v79
    v_lshlrev_b32 v78, 16, v76
    v_and_b32 v79, 0xffff0000, v76
    v_mul_f32 v78, v78, v75
    v_mul_f32 v79, v79, v75
    v_cvt_pk_bf16_f32 v38, v78, v79

    v_sub_f32 v78, v138, v74
    v_sub_f32 v79, v139, v74
    v_cvt_pk_bf16_f32 v76, v78, v79
    v_lshlrev_b32 v78, 16, v76
    v_and_b32 v79, 0xffff0000, v76
    v_mul_f32 v78, v78, v75
    v_mul_f32 v79, v79, v75
    v_cvt_pk_bf16_f32 v39, v78, v79

    v_sub_f32 v78, v140, v74
    v_sub_f32 v79, v141, v74
    v_cvt_pk_bf16_f32 v76, v78, v79
    v_lshlrev_b32 v78, 16, v76
    v_and_b32 v79, 0xffff0000, v76
    v_mul_f32 v78, v78, v75
    v_mul_f32 v79, v79, v75
    v_cvt_pk_bf16_f32 v40, v78, v79

    v_sub_f32 v78, v142, v74
    v_sub_f32 v79, v143, v74
    v_cvt_pk_bf16_f32 v76, v78, v79
    v_lshlrev_b32 v78, 16, v76
    v_and_b32 v79, 0xffff0000, v76
    v_mul_f32 v78, v78, v75
    v_mul_f32 v79, v79, v75
    v_cvt_pk_bf16_f32 v41, v78, v79

    v_sub_f32 v78, v144, v74
    v_sub_f32 v79, v145, v74
    v_cvt_pk_bf16_f32 v76, v78, v79
    v_lshlrev_b32 v78, 16, v76
    v_and_b32 v79, 0xffff0000, v76
    v_mul_f32 v78, v78, v75
    v_mul_f32 v79, v79, v75
    v_cvt_pk_bf16_f32 v42, v78, v79

    v_sub_f32 v78, v146, v74
    v_sub_f32 v79, v147, v74
    v_cvt_pk_bf16_f32 v76, v78, v79
    v_lshlrev_b32 v78, 16, v76
    v_and_b32 v79, 0xffff0000, v76
    v_mul_f32 v78, v78, v75
    v_mul_f32 v79, v79, v75
    v_cvt_pk_bf16_f32 v43, v78, v79

    v_sub_f32 v78, v148, v74
    v_sub_f32 v79, v149, v74
    v_cvt_pk_bf16_f32 v76, v78, v79
    v_lshlrev_b32 v78, 16, v76
    v_and_b32 v79, 0xffff0000, v76
    v_mul_f32 v78, v78, v75
    v_mul_f32 v79, v79, v75
    v_cvt_pk_bf16_f32 v44, v78, v79

    v_sub_f32 v78, v150, v74
    v_sub_f32 v79, v151, v74
    v_cvt_pk_bf16_f32 v76, v78, v79
    v_lshlrev_b32 v78, 16, v76
    v_and_b32 v79, 0xffff0000, v76
    v_mul_f32 v78, v78, v75
    v_mul_f32 v79, v79, v75
    v_cvt_pk_bf16_f32 v45, v78, v79

    v_sub_f32 v78, v152, v74
    v_sub_f32 v79, v153, v74
    v_cvt_pk_bf16_f32 v76, v78, v79
    v_lshlrev_b32 v78, 16, v76
    v_and_b32 v79, 0xffff0000, v76
    v_mul_f32 v78, v78, v75
    v_mul_f32 v79, v79, v75
    v_cvt_pk_bf16_f32 v46, v78, v79

    v_sub_f32 v78, v154, v74
    v_sub_f32 v79, v155, v74
    v_cvt_pk_bf16_f32 v76, v78, v79
    v_lshlrev_b32 v78, 16, v76
    v_and_b32 v79, 0xffff0000, v76
    v_mul_f32 v78, v78, v75
    v_mul_f32 v79, v79, v75
    v_cvt_pk_bf16_f32 v47, v78, v79

    v_sub_f32 v78, v156, v74
    v_sub_f32 v79, v157, v74
    v_cvt_pk_bf16_f32 v76, v78, v79
    v_lshlrev_b32 v78, 16, v76
    v_and_b32 v79, 0xffff0000, v76
    v_mul_f32 v78, v78, v75
    v_mul_f32 v79, v79, v75
    v_cvt_pk_bf16_f32 v48, v78, v79

    v_sub_f32 v78, v158, v74
    v_sub_f32 v79, v159, v74
    v_cvt_pk_bf16_f32 v76, v78, v79
    v_lshlrev_b32 v78, 16, v76
    v_and_b32 v79, 0xffff0000, v76
    v_mul_f32 v78, v78, v75
    v_mul_f32 v79, v79, v75
    v_cvt_pk_bf16_f32 v49, v78, v79

    v_sub_f32 v78, v160, v74
    v_sub_f32 v79, v161, v74
    v_cvt_pk_bf16_f32 v76, v78, v79
    v_lshlrev_b32 v78, 16, v76
    v_and_b32 v79, 0xffff0000, v76
    v_mul_f32 v78, v78, v75
    v_mul_f32 v79, v79, v75
    v_cvt_pk_bf16_f32 v50, v78, v79

    v_sub_f32 v78, v162, v74
    v_sub_f32 v79, v163, v74
    v_cvt_pk_bf16_f32 v76, v78, v79
    v_lshlrev_b32 v78, 16, v76
    v_and_b32 v79, 0xffff0000, v76
    v_mul_f32 v78, v78, v75
    v_mul_f32 v79, v79, v75
    v_cvt_pk_bf16_f32 v51, v78, v79

    v_sub_f32 v78, v164, v74
    v_sub_f32 v79, v165, v74
    v_cvt_pk_bf16_f32 v76, v78, v79
    v_lshlrev_b32 v78, 16, v76
    v_and_b32 v79, 0xffff0000, v76
    v_mul_f32 v78, v78, v75
    v_mul_f32 v79, v79, v75
    v_cvt_pk_bf16_f32 v52, v78, v79

    v_sub_f32 v78, v166, v74
    v_sub_f32 v79, v167, v74
    v_cvt_pk_bf16_f32 v76, v78, v79
    v_lshlrev_b32 v78, 16, v76
    v_and_b32 v79, 0xffff0000, v76
    v_mul_f32 v78, v78, v75
    v_mul_f32 v79, v79, v75
    v_cvt_pk_bf16_f32 v53, v78, v79

    v_sub_f32 v78, v168, v74
    v_sub_f32 v79, v169, v74
    v_cvt_pk_bf16_f32 v76, v78, v79
    v_lshlrev_b32 v78, 16, v76
    v_and_b32 v79, 0xffff0000, v76
    v_mul_f32 v78, v78, v75
    v_mul_f32 v79, v79, v75
    v_cvt_pk_bf16_f32 v54, v78, v79

    v_sub_f32 v78, v170, v74
    v_sub_f32 v79, v171, v74
    v_cvt_pk_bf16_f32 v76, v78, v79
    v_lshlrev_b32 v78, 16, v76
    v_and_b32 v79, 0xffff0000, v76
    v_mul_f32 v78, v78, v75
    v_mul_f32 v79, v79, v75
    v_cvt_pk_bf16_f32 v55, v78, v79

    v_sub_f32 v78, v172, v74
    v_sub_f32 v79, v173, v74
    v_cvt_pk_bf16_f32 v76, v78, v79
    v_lshlrev_b32 v78, 16, v76
    v_and_b32 v79, 0xffff0000, v76
    v_mul_f32 v78, v78, v75
    v_mul_f32 v79, v79, v75
    v_cvt_pk_bf16_f32 v56, v78, v79

    v_sub_f32 v78, v174, v74
    v_sub_f32 v79, v175, v74
    v_cvt_pk_bf16_f32 v76, v78, v79
    v_lshlrev_b32 v78, 16, v76
    v_and_b32 v79, 0xffff0000, v76
    v_mul_f32 v78, v78, v75
    v_mul_f32 v79, v79, v75
    v_cvt_pk_bf16_f32 v57, v78, v79

    v_sub_f32 v78, v176, v74
    v_sub_f32 v79, v177, v74
    v_cvt_pk_bf16_f32 v76, v78, v79
    v_lshlrev_b32 v78, 16, v76
    v_and_b32 v79, 0xffff0000, v76
    v_mul_f32 v78, v78, v75
    v_mul_f32 v79, v79, v75
    v_cvt_pk_bf16_f32 v58, v78, v79

    v_sub_f32 v78, v178, v74
    v_sub_f32 v79, v179, v74
    v_cvt_pk_bf16_f32 v76, v78, v79
    v_lshlrev_b32 v78, 16, v76
    v_and_b32 v79, 0xffff0000, v76
    v_mul_f32 v78, v78, v75
    v_mul_f32 v79, v79, v75
    v_cvt_pk_bf16_f32 v59, v78, v79

    v_sub_f32 v78, v180, v74
    v_sub_f32 v79, v181, v74
    v_cvt_pk_bf16_f32 v76, v78, v79
    v_lshlrev_b32 v78, 16, v76
    v_and_b32 v79, 0xffff0000, v76
    v_mul_f32 v78, v78, v75
    v_mul_f32 v79, v79, v75
    v_cvt_pk_bf16_f32 v60, v78, v79

    v_sub_f32 v78, v182, v74
    v_sub_f32 v79, v183, v74
    v_cvt_pk_bf16_f32 v76, v78, v79
    v_lshlrev_b32 v78, 16, v76
    v_and_b32 v79, 0xffff0000, v76
    v_mul_f32 v78, v78, v75
    v_mul_f32 v79, v79, v75
    v_cvt_pk_bf16_f32 v61, v78, v79

    v_sub_f32 v78, v184, v74
    v_sub_f32 v79, v185, v74
    v_cvt_pk_bf16_f32 v76, v78, v79
    v_lshlrev_b32 v78, 16, v76
    v_and_b32 v79, 0xffff0000, v76
    v_mul_f32 v78, v78, v75
    v_mul_f32 v79, v79, v75
    v_cvt_pk_bf16_f32 v62, v78, v79

    v_sub_f32 v78, v186, v74
    v_sub_f32 v79, v187, v74
    v_cvt_pk_bf16_f32 v76, v78, v79
    v_lshlrev_b32 v78, 16, v76
    v_and_b32 v79, 0xffff0000, v76
    v_mul_f32 v78, v78, v75
    v_mul_f32 v79, v79, v75
    v_cvt_pk_bf16_f32 v63, v78, v79

    v_sub_f32 v78, v188, v74
    v_sub_f32 v79, v189, v74
    v_cvt_pk_bf16_f32 v76, v78, v79
    v_lshlrev_b32 v78, 16, v76
    v_and_b32 v79, 0xffff0000, v76
    v_mul_f32 v78, v78, v75
    v_mul_f32 v79, v79, v75
    v_cvt_pk_bf16_f32 v64, v78, v79

    v_sub_f32 v78, v190, v74
    v_sub_f32 v79, v191, v74
    v_cvt_pk_bf16_f32 v76, v78, v79
    v_lshlrev_b32 v78, 16, v76
    v_and_b32 v79, 0xffff0000, v76
    v_mul_f32 v78, v78, v75
    v_mul_f32 v79, v79, v75
    v_cvt_pk_bf16_f32 v65, v78, v79

    v_sub_f32 v78, v192, v74
    v_sub_f32 v79, v193, v74
    v_cvt_pk_bf16_f32 v76, v78, v79
    v_lshlrev_b32 v78, 16, v76
    v_and_b32 v79, 0xffff0000, v76
    v_mul_f32 v78, v78, v75
    v_mul_f32 v79, v79, v75
    v_cvt_pk_bf16_f32 v66, v78, v79

    v_sub_f32 v78, v194, v74
    v_sub_f32 v79, v195, v74
    v_cvt_pk_bf16_f32 v76, v78, v79
    v_lshlrev_b32 v78, 16, v76
    v_and_b32 v79, 0xffff0000, v76
    v_mul_f32 v78, v78, v75
    v_mul_f32 v79, v79, v75
    v_cvt_pk_bf16_f32 v67, v78, v79

    v_sub_f32 v78, v196, v74
    v_sub_f32 v79, v197, v74
    v_cvt_pk_bf16_f32 v76, v78, v79
    v_lshlrev_b32 v78, 16, v76
    v_and_b32 v79, 0xffff0000, v76
    v_mul_f32 v78, v78, v75
    v_mul_f32 v79, v79, v75
    v_cvt_pk_bf16_f32 v68, v78, v79

    v_sub_f32 v78, v198, v74
    v_sub_f32 v79, v199, v74
    v_cvt_pk_bf16_f32 v76, v78, v79
    v_lshlrev_b32 v78, 16, v76
    v_and_b32 v79, 0xffff0000, v76
    v_mul_f32 v78, v78, v75
    v_mul_f32 v79, v79, v75
    v_cvt_pk_bf16_f32 v69, v78, v79

    v_sub_f32 v78, v200, v74
    v_sub_f32 v79, v201, v74
    v_cvt_pk_bf16_f32 v76, v78, v79
    v_lshlrev_b32 v78, 16, v76
    v_and_b32 v79, 0xffff0000, v76
    v_mul_f32 v78, v78, v75
    v_mul_f32 v79, v79, v75
    v_cvt_pk_bf16_f32 v70, v78, v79

    v_sub_f32 v78, v202, v74
    v_sub_f32 v79, v203, v74
    v_cvt_pk_bf16_f32 v76, v78, v79
    v_lshlrev_b32 v78, 16, v76
    v_and_b32 v79, 0xffff0000, v76
    v_mul_f32 v78, v78, v75
    v_mul_f32 v79, v79, v75
    v_cvt_pk_bf16_f32 v71, v78, v79

    v_sub_f32 v78, v204, v74
    v_sub_f32 v79, v205, v74
    v_cvt_pk_bf16_f32 v76, v78, v79
    v_lshlrev_b32 v78, 16, v76
    v_and_b32 v79, 0xffff0000, v76
    v_mul_f32 v78, v78, v75
    v_mul_f32 v79, v79, v75
    v_cvt_pk_bf16_f32 v72, v78, v79

    v_sub_f32 v78, v206, v74
    v_sub_f32 v79, v207, v74
    v_cvt_pk_bf16_f32 v76, v78, v79
    v_lshlrev_b32 v78, 16, v76
    v_and_b32 v79, 0xffff0000, v76
    v_mul_f32 v78, v78, v75
    v_mul_f32 v79, v79, v75
    v_cvt_pk_bf16_f32 v73, v78, v79

    s_lshl_b32 s21, s20, 14
    v_add_u32 v7, s21, v5

    buffer_store_dwordx4 v[10:13], v7, s[40:43], 0 offen offset:0
    buffer_store_dwordx4 v[14:17], v7, s[40:43], 0 offen offset:1024
    buffer_store_dwordx4 v[18:21], v7, s[40:43], 0 offen offset:2048
    buffer_store_dwordx4 v[22:25], v7, s[40:43], 0 offen offset:3072
    v_add_u32 v7, 4096, v7
    buffer_store_dwordx4 v[26:29], v7, s[40:43], 0 offen offset:0
    buffer_store_dwordx4 v[30:33], v7, s[40:43], 0 offen offset:1024
    buffer_store_dwordx4 v[34:37], v7, s[40:43], 0 offen offset:2048
    buffer_store_dwordx4 v[38:41], v7, s[40:43], 0 offen offset:3072
    v_add_u32 v7, 4096, v7
    buffer_store_dwordx4 v[42:45], v7, s[40:43], 0 offen offset:0
    buffer_store_dwordx4 v[46:49], v7, s[40:43], 0 offen offset:1024
    buffer_store_dwordx4 v[50:53], v7, s[40:43], 0 offen offset:2048
    buffer_store_dwordx4 v[54:57], v7, s[40:43], 0 offen offset:3072
    v_add_u32 v7, 4096, v7
    buffer_store_dwordx4 v[58:61], v7, s[40:43], 0 offen offset:0
    buffer_store_dwordx4 v[62:65], v7, s[40:43], 0 offen offset:1024
    buffer_store_dwordx4 v[66:69], v7, s[40:43], 0 offen offset:2048
    buffer_store_dwordx4 v[70:73], v7, s[40:43], 0 offen offset:3072
    v_add_u32 v7, 4096, v7
L_prep_done:
    s_endpgm
.text
.globl chain_kernel
.p2align 8
.type chain_kernel,@function
chain_kernel:
    s_cmp_ge_u32 s2, 256
    s_cbranch_scc1 L_ch_end
    s_load_dwordx2 s[8:9], s[0:1], 104
    s_load_dwordx2 s[10:11], s[0:1], 96
    s_mov_b32 s94, s2
    v_lshrrev_b32 v2, 6, v0
    v_and_b32 v6, 63, v0
    v_lshlrev_b32 v1, 4, v6
    v_readfirstlane_b32 s3, v2
    v_lshlrev_b32 v3, 3, v6
    s_waitcnt lgkmcnt(0)

    s_mov_b32 s40, s8
    s_mov_b32 s41, s9
    s_and_b32 s41, s41, 0xffff
    s_mov_b32 s42, 268435456
    s_mov_b32 s43, 0x00020000
    s_mov_b32 s44, s10
    s_mov_b32 s45, s11
    s_and_b32 s45, s45, 0xffff
    s_mov_b32 s46, 256
    s_mov_b32 s47, 0x00020000
    s_cmp_lg_u32 s3, 0
    s_cbranch_scc1 L_ch_role_wait
    s_getreg_b32 s12, hwreg(HW_REG_XCC_ID)
    s_and_b32 s12, s12, 7
    s_mov_b64 exec, 1
    v_mov_b32 v10, 1
    s_lshl_b32 s13, s12, 2
    v_mov_b32 v11, s13
    v_mov_b32 v12, 1
    v_mov_b32 v13, 32
    v_mov_b32 v16, 36
    buffer_atomic_add v10, v11, s[44:47], 0 offen sc0 sc1
    buffer_atomic_add v12, v13, s[44:47], 0 offen sc0 sc1
    s_waitcnt vmcnt(0)
    v_readfirstlane_b32 s13, v10
    v_readfirstlane_b32 s14, v12
    s_add_u32 s15, s12, 1
    s_cmp_lg_u32 s13, 31
    s_cbranch_scc1 L_ch_role_poll
    v_mov_b32 v14, s15
    v_mov_b32 v15, 0
    buffer_atomic_cmpswap v[14:15], v16, s[44:47], 0 offen sc1
    s_waitcnt vmcnt(0)

L_ch_role_poll:
    s_mov_b32 s19, 1048576
L_ch_role_loop:
    buffer_load_dwordx2 v[18:19], v13, s[44:47], 0 offen sc0 sc1
    s_waitcnt vmcnt(0)
    v_readfirstlane_b32 s16, v18
    v_readfirstlane_b32 s17, v19
    s_cmp_lg_u32 s17, 0
    s_cbranch_scc1 L_ch_role_dec
    s_sub_u32 s19, s19, 1
    s_cmp_eq_u32 s19, 0
    s_cbranch_scc1 L_ch_role_dec
    s_cmp_lt_u32 s16, 256
    s_cbranch_scc1 L_ch_role_loop
    v_mov_b32 v14, 100
    v_mov_b32 v15, 0
    buffer_atomic_cmpswap v[14:15], v16, s[44:47], 0 offen sc1
    s_waitcnt vmcnt(0)
    s_branch L_ch_role_loop

L_ch_role_dec:
    s_mov_b32 s18, 0xffff
    s_cmp_eq_u32 s17, 100
    s_cbranch_scc0 L_ch_role_fast
    s_or_b32 s20, s14, 0x100
    s_cmp_lt_u32 s14, 32
    s_cselect_b32 s18, s20, s18
    s_branch L_ch_role_wr

L_ch_role_fast:
    s_cmp_lg_u32 s17, s15
    s_cbranch_scc1 L_ch_role_wr
    s_cmp_lt_u32 s13, 32
    s_cselect_b32 s18, s13, s18

L_ch_role_wr:
    v_mov_b32 v10, s18
    v_mov_b32 v11, 137192
    ds_write_b32 v11, v10
    s_waitcnt lgkmcnt(0)
    s_mov_b64 exec, -1

L_ch_role_wait:
    s_barrier
    v_mov_b32 v11, 137192
    ds_read_b32 v10, v11
    s_waitcnt lgkmcnt(0)
    v_readfirstlane_b32 s18, v10
    s_cmp_eq_u32 s18, 0xffff
    s_cbranch_scc1 L_w_entry
    s_and_b32 s4, s18, 0xff
    s_lshr_b32 s5, s18, 8

    s_lshl_b32 s6, s4, 3
    s_lshl_b32 s7, s3, 1
    s_add_u32 s6, s6, s7
    s_lshl_b32 s6, s6, 14
    s_add_u32 s6, s6, 2097152

    s_add_u32 s7, s6, 0
    buffer_load_dwordx4 a[0:3], v1, s[40:43], s7 offen offset:0
    buffer_load_dwordx4 a[4:7], v1, s[40:43], s7 offen offset:1024
    buffer_load_dwordx4 a[8:11], v1, s[40:43], s7 offen offset:2048
    buffer_load_dwordx4 a[12:15], v1, s[40:43], s7 offen offset:3072
    s_add_u32 s7, s6, 4096
    buffer_load_dwordx4 a[16:19], v1, s[40:43], s7 offen offset:0
    buffer_load_dwordx4 a[20:23], v1, s[40:43], s7 offen offset:1024
    buffer_load_dwordx4 a[24:27], v1, s[40:43], s7 offen offset:2048
    buffer_load_dwordx4 a[28:31], v1, s[40:43], s7 offen offset:3072
    s_add_u32 s7, s6, 8192
    buffer_load_dwordx4 a[32:35], v1, s[40:43], s7 offen offset:0
    buffer_load_dwordx4 a[36:39], v1, s[40:43], s7 offen offset:1024
    buffer_load_dwordx4 a[40:43], v1, s[40:43], s7 offen offset:2048
    buffer_load_dwordx4 a[44:47], v1, s[40:43], s7 offen offset:3072
    s_add_u32 s7, s6, 12288
    buffer_load_dwordx4 a[48:51], v1, s[40:43], s7 offen offset:0
    buffer_load_dwordx4 a[52:55], v1, s[40:43], s7 offen offset:1024
    buffer_load_dwordx4 a[56:59], v1, s[40:43], s7 offen offset:2048
    buffer_load_dwordx4 a[60:63], v1, s[40:43], s7 offen offset:3072
    s_add_u32 s7, s6, 16384
    buffer_load_dwordx4 a[64:67], v1, s[40:43], s7 offen offset:0
    buffer_load_dwordx4 a[68:71], v1, s[40:43], s7 offen offset:1024
    buffer_load_dwordx4 a[72:75], v1, s[40:43], s7 offen offset:2048
    buffer_load_dwordx4 a[76:79], v1, s[40:43], s7 offen offset:3072
    s_add_u32 s7, s6, 20480
    buffer_load_dwordx4 a[80:83], v1, s[40:43], s7 offen offset:0
    buffer_load_dwordx4 a[84:87], v1, s[40:43], s7 offen offset:1024
    buffer_load_dwordx4 a[88:91], v1, s[40:43], s7 offen offset:2048
    buffer_load_dwordx4 a[92:95], v1, s[40:43], s7 offen offset:3072
    s_add_u32 s7, s6, 24576
    buffer_load_dwordx4 a[96:99], v1, s[40:43], s7 offen offset:0
    buffer_load_dwordx4 a[100:103], v1, s[40:43], s7 offen offset:1024
    buffer_load_dwordx4 a[104:107], v1, s[40:43], s7 offen offset:2048
    buffer_load_dwordx4 a[108:111], v1, s[40:43], s7 offen offset:3072
    s_add_u32 s7, s6, 28672
    buffer_load_dwordx4 a[112:115], v1, s[40:43], s7 offen offset:0
    buffer_load_dwordx4 a[116:119], v1, s[40:43], s7 offen offset:1024
    buffer_load_dwordx4 a[120:123], v1, s[40:43], s7 offen offset:2048
    buffer_load_dwordx4 a[124:127], v1, s[40:43], s7 offen offset:3072
    s_add_u32 s7, s6, 4194304
    buffer_load_dwordx4 a[128:131], v1, s[40:43], s7 offen offset:0
    buffer_load_dwordx4 a[132:135], v1, s[40:43], s7 offen offset:1024
    buffer_load_dwordx4 a[136:139], v1, s[40:43], s7 offen offset:2048
    buffer_load_dwordx4 a[140:143], v1, s[40:43], s7 offen offset:3072
    s_add_u32 s7, s6, 4198400
    buffer_load_dwordx4 a[144:147], v1, s[40:43], s7 offen offset:0
    buffer_load_dwordx4 a[148:151], v1, s[40:43], s7 offen offset:1024
    buffer_load_dwordx4 a[152:155], v1, s[40:43], s7 offen offset:2048
    buffer_load_dwordx4 a[156:159], v1, s[40:43], s7 offen offset:3072
    s_add_u32 s7, s6, 4202496
    buffer_load_dwordx4 a[160:163], v1, s[40:43], s7 offen offset:0
    buffer_load_dwordx4 a[164:167], v1, s[40:43], s7 offen offset:1024
    buffer_load_dwordx4 a[168:171], v1, s[40:43], s7 offen offset:2048
    buffer_load_dwordx4 a[172:175], v1, s[40:43], s7 offen offset:3072
    s_add_u32 s7, s6, 4206592
    buffer_load_dwordx4 a[176:179], v1, s[40:43], s7 offen offset:0
    buffer_load_dwordx4 a[180:183], v1, s[40:43], s7 offen offset:1024
    buffer_load_dwordx4 a[184:187], v1, s[40:43], s7 offen offset:2048
    buffer_load_dwordx4 a[188:191], v1, s[40:43], s7 offen offset:3072
    s_add_u32 s7, s6, 4210688
    buffer_load_dwordx4 a[192:195], v1, s[40:43], s7 offen offset:0
    buffer_load_dwordx4 a[196:199], v1, s[40:43], s7 offen offset:1024
    buffer_load_dwordx4 a[200:203], v1, s[40:43], s7 offen offset:2048
    buffer_load_dwordx4 a[204:207], v1, s[40:43], s7 offen offset:3072
    s_add_u32 s7, s6, 4214784
    buffer_load_dwordx4 a[208:211], v1, s[40:43], s7 offen offset:0
    buffer_load_dwordx4 a[212:215], v1, s[40:43], s7 offen offset:1024
    buffer_load_dwordx4 a[216:219], v1, s[40:43], s7 offen offset:2048
    buffer_load_dwordx4 a[220:223], v1, s[40:43], s7 offen offset:3072
    s_add_u32 s7, s6, 4218880
    buffer_load_dwordx4 a[224:227], v1, s[40:43], s7 offen offset:0
    buffer_load_dwordx4 a[228:231], v1, s[40:43], s7 offen offset:1024
    buffer_load_dwordx4 a[232:235], v1, s[40:43], s7 offen offset:2048
    buffer_load_dwordx4 a[236:239], v1, s[40:43], s7 offen offset:3072
    s_add_u32 s7, s6, 4222976
    buffer_load_dwordx4 a[240:243], v1, s[40:43], s7 offen offset:0
    buffer_load_dwordx4 a[244:247], v1, s[40:43], s7 offen offset:1024
    buffer_load_dwordx4 a[248:251], v1, s[40:43], s7 offen offset:2048
    buffer_load_dwordx4 a[252:255], v1, s[40:43], s7 offen offset:3072
    s_lshl_b32 s13, s3, 15

    s_add_u32 m0, s13, 0
    s_add_u32 s7, s6, 8388608

    buffer_load_dwordx4 v1, s[40:43], s7 offen offset:0 lds
    buffer_load_dwordx4 v1, s[40:43], s7 offen offset:1024 lds
    buffer_load_dwordx4 v1, s[40:43], s7 offen offset:2048 lds
    buffer_load_dwordx4 v1, s[40:43], s7 offen offset:3072 lds
    s_add_u32 m0, s13, 4096
    s_add_u32 s7, s6, 8392704

    buffer_load_dwordx4 v1, s[40:43], s7 offen offset:0 lds
    buffer_load_dwordx4 v1, s[40:43], s7 offen offset:1024 lds
    buffer_load_dwordx4 v1, s[40:43], s7 offen offset:2048 lds
    buffer_load_dwordx4 v1, s[40:43], s7 offen offset:3072 lds
    s_add_u32 m0, s13, 8192
    s_add_u32 s7, s6, 8396800

    buffer_load_dwordx4 v1, s[40:43], s7 offen offset:0 lds
    buffer_load_dwordx4 v1, s[40:43], s7 offen offset:1024 lds
    buffer_load_dwordx4 v1, s[40:43], s7 offen offset:2048 lds
    buffer_load_dwordx4 v1, s[40:43], s7 offen offset:3072 lds
    s_add_u32 m0, s13, 12288
    s_add_u32 s7, s6, 8400896

    buffer_load_dwordx4 v1, s[40:43], s7 offen offset:0 lds
    buffer_load_dwordx4 v1, s[40:43], s7 offen offset:1024 lds
    buffer_load_dwordx4 v1, s[40:43], s7 offen offset:2048 lds
    buffer_load_dwordx4 v1, s[40:43], s7 offen offset:3072 lds
    s_add_u32 m0, s13, 16384
    s_add_u32 s7, s6, 8404992

    buffer_load_dwordx4 v1, s[40:43], s7 offen offset:0 lds
    buffer_load_dwordx4 v1, s[40:43], s7 offen offset:1024 lds
    buffer_load_dwordx4 v1, s[40:43], s7 offen offset:2048 lds
    buffer_load_dwordx4 v1, s[40:43], s7 offen offset:3072 lds
    s_add_u32 m0, s13, 20480
    s_add_u32 s7, s6, 8409088

    buffer_load_dwordx4 v1, s[40:43], s7 offen offset:0 lds
    buffer_load_dwordx4 v1, s[40:43], s7 offen offset:1024 lds
    buffer_load_dwordx4 v1, s[40:43], s7 offen offset:2048 lds
    buffer_load_dwordx4 v1, s[40:43], s7 offen offset:3072 lds
    s_add_u32 m0, s13, 24576
    s_add_u32 s7, s6, 8413184

    buffer_load_dwordx4 v1, s[40:43], s7 offen offset:0 lds
    buffer_load_dwordx4 v1, s[40:43], s7 offen offset:1024 lds
    buffer_load_dwordx4 v1, s[40:43], s7 offen offset:2048 lds
    buffer_load_dwordx4 v1, s[40:43], s7 offen offset:3072 lds
    s_add_u32 m0, s13, 28672
    s_add_u32 s7, s6, 8417280

    buffer_load_dwordx4 v1, s[40:43], s7 offen offset:0 lds
    buffer_load_dwordx4 v1, s[40:43], s7 offen offset:1024 lds
    buffer_load_dwordx4 v1, s[40:43], s7 offen offset:2048 lds
    buffer_load_dwordx4 v1, s[40:43], s7 offen offset:3072 lds
    s_lshl_b32 s6, s3, 20
    s_lshl_b32 s7, s4, 12
    s_add_u32 s6, s6, s7
    s_add_u32 s6, s6, 18874368
    s_lshl_b32 s7, s3, 15

    s_add_u32 s12, s6, 0
    buffer_load_dwordx4 v[128:131], v1, s[40:43], s12 offen offset:0
    buffer_load_dwordx4 v[132:135], v1, s[40:43], s12 offen offset:1024
    buffer_load_dwordx4 v[136:139], v1, s[40:43], s12 offen offset:2048
    buffer_load_dwordx4 v[140:143], v1, s[40:43], s12 offen offset:3072
    s_add_u32 s12, s6, 131072
    buffer_load_dwordx4 v[144:147], v1, s[40:43], s12 offen offset:0
    buffer_load_dwordx4 v[148:151], v1, s[40:43], s12 offen offset:1024
    buffer_load_dwordx4 v[152:155], v1, s[40:43], s12 offen offset:2048
    buffer_load_dwordx4 v[156:159], v1, s[40:43], s12 offen offset:3072
    s_add_u32 s12, s6, 262144
    buffer_load_dwordx4 v[160:163], v1, s[40:43], s12 offen offset:0
    buffer_load_dwordx4 v[164:167], v1, s[40:43], s12 offen offset:1024
    buffer_load_dwordx4 v[168:171], v1, s[40:43], s12 offen offset:2048
    buffer_load_dwordx4 v[172:175], v1, s[40:43], s12 offen offset:3072
    s_add_u32 s12, s6, 393216
    buffer_load_dwordx4 v[176:179], v1, s[40:43], s12 offen offset:0
    buffer_load_dwordx4 v[180:183], v1, s[40:43], s12 offen offset:1024
    buffer_load_dwordx4 v[184:187], v1, s[40:43], s12 offen offset:2048
    buffer_load_dwordx4 v[188:191], v1, s[40:43], s12 offen offset:3072
    s_add_u32 s12, s6, 524288
    buffer_load_dwordx4 v[192:195], v1, s[40:43], s12 offen offset:0
    buffer_load_dwordx4 v[196:199], v1, s[40:43], s12 offen offset:1024
    buffer_load_dwordx4 v[200:203], v1, s[40:43], s12 offen offset:2048
    buffer_load_dwordx4 v[204:207], v1, s[40:43], s12 offen offset:3072
    s_add_u32 s12, s6, 655360
    buffer_load_dwordx4 v[208:211], v1, s[40:43], s12 offen offset:0
    buffer_load_dwordx4 v[212:215], v1, s[40:43], s12 offen offset:1024
    buffer_load_dwordx4 v[216:219], v1, s[40:43], s12 offen offset:2048
    buffer_load_dwordx4 v[220:223], v1, s[40:43], s12 offen offset:3072
    s_add_u32 s12, s6, 786432
    buffer_load_dwordx4 v[224:227], v1, s[40:43], s12 offen offset:0
    buffer_load_dwordx4 v[228:231], v1, s[40:43], s12 offen offset:1024
    buffer_load_dwordx4 v[232:235], v1, s[40:43], s12 offen offset:2048
    buffer_load_dwordx4 v[236:239], v1, s[40:43], s12 offen offset:3072
    s_add_u32 s12, s6, 917504
    buffer_load_dwordx4 v[240:243], v1, s[40:43], s12 offen offset:0
    buffer_load_dwordx4 v[244:247], v1, s[40:43], s12 offen offset:1024
    buffer_load_dwordx4 v[248:251], v1, s[40:43], s12 offen offset:2048
    buffer_load_dwordx4 v[252:255], v1, s[40:43], s12 offen offset:3072
    v_add_u32 v4, s7, v1
    v_and_b32 v34, 15, v6
    v_lshrrev_b32 v35, 4, v6
    v_and_b32 v36, 7, v6
    v_lshl_add_u32 v5, v35, 3, v36
    v_lshlrev_b32 v5, 4, v5
    v_cmp_gt_u32 s[60:61], 8, v34
    v_cmp_gt_u32 s[62:63], 32, v6
    v_cmp_gt_u32 s[76:77], 8, v6
    s_mul_i32 s12, s3, 1536
    s_add_u32 s12, s12, 131072
    v_add_u32 v8, s12, v5
    v_lshrrev_b32 v37, 3, v34
    v_add_u32 v7, s3, v37
    v_add_u32 v7, 1, v7
    v_and_b32 v7, 3, v7
    v_mul_u32_u24 v7, 1536, v7
    v_add3_u32 v7, v7, v5, 0
    v_add_u32 v7, 131072, v7
    v_add_u32 v0, s3, v37
    v_add_u32 v0, 3, v0
    v_and_b32 v0, 3, v0
    v_mul_u32_u24 v0, 1536, v0
    v_add3_u32 v0, v0, v5, 0
    v_add_u32 v0, 131072, v0
    v_add_u32 v9, 137216, v5
    s_lshl_b32 s12, s3, 9
    v_add_u32 v2, s12, v9
    s_lshl_b32 s12, s3, 11
    s_add_u32 s12, s12, 139264
    v_add_u32 v38, s12, v1
    v_lshrrev_b32 v37, 3, v6
    v_lshlrev_b32 v39, 14, v37
    v_lshl_add_u32 v39, v36, 4, v39
    s_lshl_b32 s12, s3, 7
    v_add_u32 v39, s12, v39
    v_mov_b32 v24, 0
    v_mov_b32 v25, 0
    v_mov_b32 v32, 0
    v_mov_b32 v33, 0
    s_mov_b32 s50, 0
    s_lshl_b32 s12, s3, 11
    s_add_u32 s51, s12, 118489088
    s_add_u32 s52, s51, 8192
    s_add_u32 s59, s51, 16384
    s_lshl_b32 s53, s4, 14
    s_lshl_b32 s12, s3, 12
    s_add_u32 s53, s53, s12
    s_add_u32 s53, s53, 117440512
    s_lshl_b32 s54, s4, 9
    s_add_u32 s54, s54, 117440512
    s_lshl_b32 s12, s4, 2
    s_add_u32 s12, s12, s3
    s_lshl_b32 s12, s12, 10
    s_add_u32 s55, s12, 41943040
    s_add_u32 s57, s12, 100663296
    s_lshl_b32 s12, s4, 3
    s_lshl_b32 s13, s3, 1
    s_add_u32 s12, s12, s13
    s_lshl_b32 s13, s12, 10
    s_add_u32 s56, s13, 58720256
    s_lshl_b32 s13, s12, 9
    s_add_u32 s58, s13, 109051904
    s_lshr_b32 s12, s4, 1
    s_lshl_b32 s12, s12, 9
    s_and_b32 s13, s4, 1
    s_lshl_b32 s13, s13, 3
    s_add_u32 s68, s12, s13
    s_lshl_b32 s12, s3, 7
    s_add_u32 s68, s68, s12
    s_lshl_b32 s12, s3, 11
    s_sub_u32 s68, s68, s12
    s_mov_b32 s69, 0x3e0293ee

    s_lshr_b32 s71, s4, 1
    s_lshl_b32 s71, s71, 2
    s_add_u32 s71, s71, 119537728
    s_lshl_b32 s72, s4, 2
    s_add_u32 s72, s72, 119541760

    s_lshl_b32 s73, s3, 12
    s_add_u32 s73, s73, 147456

    s_mov_b64 exec, 3
    v_lshlrev_b32 v34, 6, v6
    s_mov_b32 s19, 1048576

L_ch_kv0_loop:
    buffer_load_dword v35, v34, s[40:43], s71 offen sc0 sc1
    s_waitcnt vmcnt(0)
    v_cmp_eq_u32 vcc, 0, v35
    s_cbranch_vccz L_ch_kv0_ok
    s_sleep 4
    s_sub_u32 s19, s19, 1
    s_cmp_lg_u32 s19, 0
    s_cbranch_scc1 L_ch_kv0_loop
    s_mov_b64 exec, -1
    s_branch L_ch_done

L_ch_kv0_ok:
    s_mov_b64 exec, -1
    s_add_u32 s71, s71, 256

    s_add_u32 s12, s55, 131072
    s_mov_b32 m0, s73
    s_nop 0
    buffer_load_dwordx4 v1, s[40:43], s55 offen sc0 sc1 lds
    s_add_u32 m0, s73, 1024
    s_nop 0
    buffer_load_dwordx4 v1, s[40:43], s12 offen sc0 sc1 lds
    s_add_u32 m0, s73, 2048
    s_nop 0
    buffer_load_dwordx4 v1, s[40:43], s56 offen sc0 sc1 lds
    buffer_load_dwordx4 v1, s[40:43], s56 offen offset:1024 sc0 sc1 lds
    s_add_u32 s55, s55, 262144
    s_add_u32 s56, s56, 262144

    s_waitcnt vmcnt(0)
    s_barrier
    s_cmp_eq_u32 s5, 0
    s_cbranch_scc0 L_ch_slow_step

L_ch_fast_step:
    s_mov_b32 s19, 1048576
    s_waitcnt vmcnt(0)

L_ch_fast_pm_loop:
    buffer_load_dwordx4 v[80:83], v1, s[40:43], s51 offen sc1
    buffer_load_dwordx4 v[84:87], v1, s[40:43], s51 offen offset:1024 sc1

    s_waitcnt vmcnt(0)
    v_max3_u32 v34, v80, v81, v82
    v_max3_u32 v35, v83, v84, v85
    v_max3_u32 v34, v34, v86, v87
    v_max_u32 v34, v34, v35
    v_cmp_eq_u32 vcc, -1, v34
    s_cbranch_vccz L_ch_fast_pm_okA

    s_sub_u32 s19, s19, 1
    s_cmp_lg_u32 s19, 0
    s_cbranch_scc1 L_ch_fast_pm_loop
    s_branch L_ch_done

L_ch_fast_pm_okB:
    ds_write_b128 v38, v[88:91]
    ds_write_b128 v38, v[92:95] offset:1024
    s_branch L_ch_fast_pm_join

L_ch_fast_pm_okA:
    ds_write_b128 v38, v[80:83]
    ds_write_b128 v38, v[84:87] offset:1024

L_ch_fast_pm_join:
    s_waitcnt lgkmcnt(0)
    s_barrier
    s_cmp_lg_u32 s3, 0
    s_cbranch_scc1 L_ch_fast_nocf
    s_cmp_eq_u32 s50, 0
    s_cbranch_scc1 L_ch_fast_nocf
    s_mov_b64 exec, 1
    s_sub_u32 s12, s50, 1
    v_mov_b32 v34, s12
    v_mov_b32 v35, 0
    buffer_store_dword v34, v35, s[40:43], s72 offen sc0 sc1
    s_mov_b64 exec, -1

L_ch_fast_nocf:
    v_add_u32 v34, s73, v1
    ds_read_b128 v[10:13], v34
    ds_read_b128 v[14:17], v34 offset:1024
    ds_read_b128 v[20:23], v34 offset:2048
    ds_read_b128 v[28:31], v34 offset:3072
    s_cmp_eq_u32 s50, 0
    s_cbranch_scc1 L_ch_fast_novm
    buffer_store_dwordx2 v[18:19], v3, s[40:43], s58 offen sc0 sc1
    buffer_store_dwordx2 v[26:27], v3, s[40:43], s58 offen offset:512 sc0 sc1
    s_add_u32 s58, s58, 131072

L_ch_fast_novm:
    ds_read_b128 v[96:99], v9 offset:2048
    ds_read_b128 v[64:67], v4 offset:0
    ds_read_b128 v[68:71], v4 offset:16384
    ds_read_b128 v[100:103], v9 offset:2560
    ds_read_b128 v[72:75], v4 offset:1024
    ds_read_b128 v[76:79], v4 offset:17408
    ds_read_b128 v[104:107], v9 offset:3072
    ds_read_b128 v[108:111], v9 offset:3584
    ds_read_b128 v[112:115], v9 offset:4096
    ds_read_b128 v[116:119], v9 offset:4608
    ds_read_b128 v[120:123], v9 offset:5120
    ds_read_b128 v[124:127], v9 offset:5632
    s_waitcnt lgkmcnt(11)
    v_mfma_f32_16x16x32_bf16 v[40:43], a[0:3], v[96:99], 0
    v_mfma_f32_16x16x32_bf16 v[44:47], a[64:67], v[96:99], 0
    v_mfma_f32_16x16x32_bf16 v[48:51], a[128:131], v[96:99], 0
    v_mfma_f32_16x16x32_bf16 v[52:55], a[192:195], v[96:99], 0
    s_waitcnt lgkmcnt(10)
    v_mfma_f32_16x16x32_bf16 v[56:59], v[96:99], v[64:67], 0
    s_waitcnt lgkmcnt(9)
    v_mfma_f32_16x16x32_bf16 v[60:63], v[96:99], v[68:71], 0
    ds_read_b128 v[96:99], v9 offset:6144
    ds_read_b128 v[64:67], v4 offset:2048
    ds_read_b128 v[68:71], v4 offset:18432
    s_waitcnt lgkmcnt(11)
    v_mfma_f32_16x16x32_bf16 v[40:43], a[4:7], v[100:103], v[40:43]
    v_mfma_f32_16x16x32_bf16 v[44:47], a[68:71], v[100:103], v[44:47]
    v_mfma_f32_16x16x32_bf16 v[48:51], a[132:135], v[100:103], v[48:51]
    v_mfma_f32_16x16x32_bf16 v[52:55], a[196:199], v[100:103], v[52:55]
    s_waitcnt lgkmcnt(10)
    v_mfma_f32_16x16x32_bf16 v[56:59], v[100:103], v[72:75], v[56:59]
    s_waitcnt lgkmcnt(9)
    v_mfma_f32_16x16x32_bf16 v[60:63], v[100:103], v[76:79], v[60:63]
    ds_read_b128 v[100:103], v9 offset:6656
    ds_read_b128 v[72:75], v4 offset:3072
    ds_read_b128 v[76:79], v4 offset:19456
    s_and_b32 s12, s50, 3
    s_cmp_lg_u32 s12, 3
    s_cbranch_scc1 L_ch_fast_nokv
    s_cmp_eq_u32 s50, 63
    s_cbranch_scc1 L_ch_fast_nokv

    s_mov_b64 exec, 3
    v_lshlrev_b32 v34, 6, v6
    s_mov_b32 s19, 1048576

L_ch_fast_kv_loop:
    buffer_load_dword v35, v34, s[40:43], s71 offen sc0 sc1
    s_waitcnt vmcnt(0)
    v_cmp_eq_u32 vcc, 0, v35
    s_cbranch_vccz L_ch_fast_kv_ok
    s_sleep 4
    s_sub_u32 s19, s19, 1
    s_cmp_lg_u32 s19, 0
    s_cbranch_scc1 L_ch_fast_kv_loop
    s_mov_b64 exec, -1
    s_branch L_ch_done

L_ch_fast_kv_ok:
    s_mov_b64 exec, -1
    s_add_u32 s71, s71, 256

L_ch_fast_nokv:
    s_add_u32 s12, s55, 131072
    s_mov_b32 m0, s73
    s_nop 0
    buffer_load_dwordx4 v1, s[40:43], s55 offen sc0 sc1 lds
    s_add_u32 m0, s73, 1024
    s_nop 0
    buffer_load_dwordx4 v1, s[40:43], s12 offen sc0 sc1 lds
    s_add_u32 m0, s73, 2048
    s_nop 0
    buffer_load_dwordx4 v1, s[40:43], s56 offen sc0 sc1 lds
    buffer_load_dwordx4 v1, s[40:43], s56 offen offset:1024 sc0 sc1 lds
    s_add_u32 s55, s55, 262144
    s_add_u32 s56, s56, 262144

    s_waitcnt lgkmcnt(11)
    v_mfma_f32_16x16x32_bf16 v[40:43], a[8:11], v[104:107], v[40:43]
    v_mfma_f32_16x16x32_bf16 v[44:47], a[72:75], v[104:107], v[44:47]
    v_mfma_f32_16x16x32_bf16 v[48:51], a[136:139], v[104:107], v[48:51]
    v_mfma_f32_16x16x32_bf16 v[52:55], a[200:203], v[104:107], v[52:55]
    s_waitcnt lgkmcnt(4)
    v_mfma_f32_16x16x32_bf16 v[56:59], v[104:107], v[64:67], v[56:59]
    s_waitcnt lgkmcnt(3)
    v_mfma_f32_16x16x32_bf16 v[60:63], v[104:107], v[68:71], v[60:63]
    ds_read_b128 v[104:107], v9 offset:7168
    ds_read_b128 v[64:67], v4 offset:4096
    ds_read_b128 v[68:71], v4 offset:20480
    v_mfma_f32_16x16x32_bf16 v[40:43], a[12:15], v[108:111], v[40:43]
    v_mfma_f32_16x16x32_bf16 v[44:47], a[76:79], v[108:111], v[44:47]
    v_mfma_f32_16x16x32_bf16 v[48:51], a[140:143], v[108:111], v[48:51]
    v_mfma_f32_16x16x32_bf16 v[52:55], a[204:207], v[108:111], v[52:55]
    s_waitcnt lgkmcnt(4)
    v_mfma_f32_16x16x32_bf16 v[56:59], v[108:111], v[72:75], v[56:59]
    s_waitcnt lgkmcnt(3)
    v_mfma_f32_16x16x32_bf16 v[60:63], v[108:111], v[76:79], v[60:63]
    ds_read_b128 v[108:111], v9 offset:7680
    ds_read_b128 v[72:75], v4 offset:5120
    ds_read_b128 v[76:79], v4 offset:21504
    v_mfma_f32_16x16x32_bf16 v[40:43], a[16:19], v[112:115], v[40:43]
    v_mfma_f32_16x16x32_bf16 v[44:47], a[80:83], v[112:115], v[44:47]
    v_mfma_f32_16x16x32_bf16 v[48:51], a[144:147], v[112:115], v[48:51]
    v_mfma_f32_16x16x32_bf16 v[52:55], a[208:211], v[112:115], v[52:55]
    s_waitcnt lgkmcnt(4)
    v_mfma_f32_16x16x32_bf16 v[56:59], v[112:115], v[64:67], v[56:59]
    s_waitcnt lgkmcnt(3)
    v_mfma_f32_16x16x32_bf16 v[60:63], v[112:115], v[68:71], v[60:63]
    ds_read_b128 v[112:115], v9 offset:8192
    ds_read_b128 v[64:67], v4 offset:6144
    ds_read_b128 v[68:71], v4 offset:22528
    v_mfma_f32_16x16x32_bf16 v[40:43], a[20:23], v[116:119], v[40:43]
    v_mfma_f32_16x16x32_bf16 v[44:47], a[84:87], v[116:119], v[44:47]
    v_mfma_f32_16x16x32_bf16 v[48:51], a[148:151], v[116:119], v[48:51]
    v_mfma_f32_16x16x32_bf16 v[52:55], a[212:215], v[116:119], v[52:55]
    s_waitcnt lgkmcnt(4)
    v_mfma_f32_16x16x32_bf16 v[56:59], v[116:119], v[72:75], v[56:59]
    s_waitcnt lgkmcnt(3)
    v_mfma_f32_16x16x32_bf16 v[60:63], v[116:119], v[76:79], v[60:63]
    ds_read_b128 v[116:119], v9 offset:8704
    ds_read_b128 v[72:75], v4 offset:7168
    ds_read_b128 v[76:79], v4 offset:23552
    v_mfma_f32_16x16x32_bf16 v[40:43], a[24:27], v[120:123], v[40:43]
    v_mfma_f32_16x16x32_bf16 v[44:47], a[88:91], v[120:123], v[44:47]
    v_mfma_f32_16x16x32_bf16 v[48:51], a[152:155], v[120:123], v[48:51]
    v_mfma_f32_16x16x32_bf16 v[52:55], a[216:219], v[120:123], v[52:55]
    s_waitcnt lgkmcnt(4)
    v_mfma_f32_16x16x32_bf16 v[56:59], v[120:123], v[64:67], v[56:59]
    s_waitcnt lgkmcnt(3)
    v_mfma_f32_16x16x32_bf16 v[60:63], v[120:123], v[68:71], v[60:63]
    ds_read_b128 v[120:123], v9 offset:9216
    ds_read_b128 v[64:67], v4 offset:8192
    ds_read_b128 v[68:71], v4 offset:24576
    v_mfma_f32_16x16x32_bf16 v[40:43], a[28:31], v[124:127], v[40:43]
    v_mfma_f32_16x16x32_bf16 v[44:47], a[92:95], v[124:127], v[44:47]
    v_mfma_f32_16x16x32_bf16 v[48:51], a[156:159], v[124:127], v[48:51]
    v_mfma_f32_16x16x32_bf16 v[52:55], a[220:223], v[124:127], v[52:55]
    s_waitcnt lgkmcnt(4)
    v_mfma_f32_16x16x32_bf16 v[56:59], v[124:127], v[72:75], v[56:59]
    s_waitcnt lgkmcnt(3)
    v_mfma_f32_16x16x32_bf16 v[60:63], v[124:127], v[76:79], v[60:63]
    ds_read_b128 v[124:127], v9 offset:9728
    ds_read_b128 v[72:75], v4 offset:9216
    ds_read_b128 v[76:79], v4 offset:25600
    v_mfma_f32_16x16x32_bf16 v[40:43], a[32:35], v[96:99], v[40:43]
    v_mfma_f32_16x16x32_bf16 v[44:47], a[96:99], v[96:99], v[44:47]
    v_mfma_f32_16x16x32_bf16 v[48:51], a[160:163], v[96:99], v[48:51]
    v_mfma_f32_16x16x32_bf16 v[52:55], a[224:227], v[96:99], v[52:55]
    v_mfma_f32_16x16x32_bf16 v[40:43], a[36:39], v[100:103], v[40:43]
    v_mfma_f32_16x16x32_bf16 v[44:47], a[100:103], v[100:103], v[44:47]
    v_mfma_f32_16x16x32_bf16 v[48:51], a[164:167], v[100:103], v[48:51]
    v_mfma_f32_16x16x32_bf16 v[52:55], a[228:231], v[100:103], v[52:55]
    v_mfma_f32_16x16x32_bf16 v[40:43], a[40:43], v[104:107], v[40:43]
    v_mfma_f32_16x16x32_bf16 v[44:47], a[104:107], v[104:107], v[44:47]
    v_mfma_f32_16x16x32_bf16 v[48:51], a[168:171], v[104:107], v[48:51]
    v_mfma_f32_16x16x32_bf16 v[52:55], a[232:235], v[104:107], v[52:55]
    v_mfma_f32_16x16x32_bf16 v[40:43], a[44:47], v[108:111], v[40:43]
    v_mfma_f32_16x16x32_bf16 v[44:47], a[108:111], v[108:111], v[44:47]
    v_mfma_f32_16x16x32_bf16 v[48:51], a[172:175], v[108:111], v[48:51]
    v_mfma_f32_16x16x32_bf16 v[52:55], a[236:239], v[108:111], v[52:55]
    v_mfma_f32_16x16x32_bf16 v[40:43], a[48:51], v[112:115], v[40:43]
    v_mfma_f32_16x16x32_bf16 v[44:47], a[112:115], v[112:115], v[44:47]
    v_mfma_f32_16x16x32_bf16 v[48:51], a[176:179], v[112:115], v[48:51]
    v_mfma_f32_16x16x32_bf16 v[52:55], a[240:243], v[112:115], v[52:55]
    v_mfma_f32_16x16x32_bf16 v[40:43], a[52:55], v[116:119], v[40:43]
    v_mfma_f32_16x16x32_bf16 v[44:47], a[116:119], v[116:119], v[44:47]
    v_mfma_f32_16x16x32_bf16 v[48:51], a[180:183], v[116:119], v[48:51]
    v_mfma_f32_16x16x32_bf16 v[52:55], a[244:247], v[116:119], v[52:55]
    s_waitcnt lgkmcnt(5)
    v_mfma_f32_16x16x32_bf16 v[40:43], a[56:59], v[120:123], v[40:43]
    v_mfma_f32_16x16x32_bf16 v[44:47], a[120:123], v[120:123], v[44:47]
    v_mfma_f32_16x16x32_bf16 v[48:51], a[184:187], v[120:123], v[48:51]
    v_mfma_f32_16x16x32_bf16 v[52:55], a[248:251], v[120:123], v[52:55]
    s_waitcnt lgkmcnt(2)
    v_mfma_f32_16x16x32_bf16 v[40:43], a[60:63], v[124:127], v[40:43]
    v_mfma_f32_16x16x32_bf16 v[44:47], a[124:127], v[124:127], v[44:47]
    v_mfma_f32_16x16x32_bf16 v[48:51], a[188:191], v[124:127], v[48:51]
    v_mfma_f32_16x16x32_bf16 v[52:55], a[252:255], v[124:127], v[52:55]
    s_nop 7
    v_cvt_pk_bf16_f32 v34, v40, v41
    v_cvt_pk_bf16_f32 v35, v42, v43
    v_cvt_pk_bf16_f32 v36, v44, v45
    v_cvt_pk_bf16_f32 v37, v46, v47
    v_cvt_pk_bf16_f32 v40, v48, v49
    v_cvt_pk_bf16_f32 v41, v50, v51
    v_cvt_pk_bf16_f32 v42, v52, v53
    v_cvt_pk_bf16_f32 v43, v54, v55
    s_nop 1
    v_mfma_f32_16x16x32_bf16 v[44:47], v[40:43], v[34:37], 0
    v_mfma_f32_16x16x32_bf16 v[48:51], v[10:13], v[34:37], 0
    v_mfma_f32_16x16x32_bf16 v[52:55], v[14:17], v[34:37], 0
    buffer_store_dwordx4 v[40:43], v1, s[40:43], s57 offen sc0 sc1

    v_mfma_f32_16x16x32_bf16 v[56:59], v[96:99], v[64:67], v[56:59]
    v_mfma_f32_16x16x32_bf16 v[60:63], v[96:99], v[68:71], v[60:63]
    ds_read_b128 v[64:67], v4 offset:10240
    ds_read_b128 v[68:71], v4 offset:26624
    s_nop 3
    ds_write_b128 v8, v[44:47]
    ds_write_b128 v8, v[48:51] offset:512
    ds_write_b128 v8, v[52:55] offset:1024
    s_waitcnt lgkmcnt(6)
    v_mfma_f32_16x16x32_bf16 v[56:59], v[100:103], v[72:75], v[56:59]
    s_waitcnt lgkmcnt(5)
    v_mfma_f32_16x16x32_bf16 v[60:63], v[100:103], v[76:79], v[60:63]
    ds_read_b128 v[72:75], v4 offset:11264
    ds_read_b128 v[76:79], v4 offset:27648
    s_waitcnt lgkmcnt(2)
    s_barrier
    ds_read_b128 v[80:83], v7 offset:0
    ds_read_b128 v[84:87], v7 offset:512
    ds_read_b128 v[88:91], v7 offset:1024
    ds_read_b128 v[44:47], v0 offset:0
    ds_read_b128 v[48:51], v0 offset:512
    ds_read_b128 v[52:55], v0 offset:1024
    v_mov_b32 v95, 0xf149f2ca
    v_mfma_f32_16x16x32_bf16 v[56:59], v[104:107], v[64:67], v[56:59]
    v_mfma_f32_16x16x32_bf16 v[60:63], v[104:107], v[68:71], v[60:63]
    ds_read_b128 v[64:67], v4 offset:12288
    ds_read_b128 v[68:71], v4 offset:28672
    s_waitcnt lgkmcnt(2)
    v_add_f32 v44, v44, v80
    v_add_f32 v45, v45, v81
    v_add_f32 v46, v46, v82
    v_add_f32 v47, v47, v83
    v_add_f32 v48, v48, v84
    v_add_f32 v49, v49, v85
    v_add_f32 v50, v50, v86
    v_add_f32 v51, v51, v87
    v_add_f32 v52, v52, v88
    v_add_f32 v53, v53, v89
    v_add_f32 v54, v54, v90
    v_add_f32 v55, v55, v91
    v_mfma_f32_16x16x32_bf16 v[56:59], v[108:111], v[72:75], v[56:59]
    v_mfma_f32_16x16x32_bf16 v[60:63], v[108:111], v[76:79], v[60:63]
    ds_read_b128 v[72:75], v4 offset:13312
    ds_read_b128 v[76:79], v4 offset:29696
    v_add_f32_dpp v44, v44, v44 row_ror:8 row_mask:0xf bank_mask:0xf
    v_add_f32_dpp v45, v45, v45 row_ror:8 row_mask:0xf bank_mask:0xf
    v_add_f32_dpp v46, v46, v46 row_ror:8 row_mask:0xf bank_mask:0xf
    v_add_f32_dpp v47, v47, v47 row_ror:8 row_mask:0xf bank_mask:0xf
    v_add_f32_dpp v48, v48, v48 row_ror:8 row_mask:0xf bank_mask:0xf
    v_add_f32_dpp v49, v49, v49 row_ror:8 row_mask:0xf bank_mask:0xf
    v_add_f32_dpp v50, v50, v50 row_ror:8 row_mask:0xf bank_mask:0xf
    v_add_f32_dpp v51, v51, v51 row_ror:8 row_mask:0xf bank_mask:0xf
    v_add_f32_dpp v52, v52, v52 row_ror:8 row_mask:0xf bank_mask:0xf
    v_add_f32_dpp v53, v53, v53 row_ror:8 row_mask:0xf bank_mask:0xf
    v_add_f32_dpp v54, v54, v54 row_ror:8 row_mask:0xf bank_mask:0xf
    v_add_f32_dpp v55, v55, v55 row_ror:8 row_mask:0xf bank_mask:0xf
    v_cndmask_b32 v44, v95, v44, s[62:63]
    v_cndmask_b32 v45, v95, v45, s[62:63]
    v_cndmask_b32 v46, v95, v46, s[62:63]
    v_cndmask_b32 v47, v95, v47, s[62:63]
    s_waitcnt lgkmcnt(3)
    v_mfma_f32_16x16x32_bf16 v[56:59], v[112:115], v[64:67], v[56:59]
    s_waitcnt lgkmcnt(2)
    v_mfma_f32_16x16x32_bf16 v[60:63], v[112:115], v[68:71], v[60:63]
    ds_read_b128 v[64:67], v4 offset:14336
    ds_read_b128 v[68:71], v4 offset:30720
    v_max3_f32 v92, v48, v49, v50
    v_max3_f32 v93, v51, v52, v53
    v_max3_f32 v94, v54, v55, v44
    v_max3_f32 v92, v92, v45, v46
    v_max3_f32 v93, v93, v94, v47
    v_max_f32 v92, v92, v93
    v_mov_b32 v93, v92

    s_waitcnt lgkmcnt(3)
    v_mfma_f32_16x16x32_bf16 v[56:59], v[116:119], v[72:75], v[56:59]
    s_waitcnt lgkmcnt(2)
    v_mfma_f32_16x16x32_bf16 v[60:63], v[116:119], v[76:79], v[60:63]
    ds_read_b128 v[72:75], v4 offset:15360
    ds_read_b128 v[76:79], v4 offset:31744
    v_permlane32_swap_b32 v92, v93
    v_max_f32 v92, v92, v93
    v_mov_b32 v93, v92
    s_nop 1
    v_permlane16_swap_b32 v92, v93
    v_max_f32 v92, v92, v93
    v_mul_f32 v92, s69, v92

    v_fma_f32 v44, v44, s69, -v92
    v_fma_f32 v45, v45, s69, -v92
    v_fma_f32 v46, v46, s69, -v92
    v_fma_f32 v47, v47, s69, -v92
    v_fma_f32 v48, v48, s69, -v92
    v_fma_f32 v49, v49, s69, -v92
    v_fma_f32 v50, v50, s69, -v92
    v_fma_f32 v51, v51, s69, -v92
    v_fma_f32 v52, v52, s69, -v92
    v_fma_f32 v53, v53, s69, -v92
    v_fma_f32 v54, v54, s69, -v92
    v_fma_f32 v55, v55, s69, -v92
    s_waitcnt lgkmcnt(3)
    v_mfma_f32_16x16x32_bf16 v[56:59], v[120:123], v[64:67], v[56:59]
    s_waitcnt lgkmcnt(2)
    v_mfma_f32_16x16x32_bf16 v[60:63], v[120:123], v[68:71], v[60:63]
    v_exp_f32 v44, v44
    v_exp_f32 v45, v45
    v_exp_f32 v46, v46
    v_exp_f32 v47, v47
    v_exp_f32 v48, v48
    v_exp_f32 v49, v49
    s_waitcnt lgkmcnt(1)
    v_mfma_f32_16x16x32_bf16 v[56:59], v[124:127], v[72:75], v[56:59]
    s_waitcnt lgkmcnt(0)
    v_mfma_f32_16x16x32_bf16 v[60:63], v[124:127], v[76:79], v[60:63]
    v_exp_f32 v50, v50
    v_exp_f32 v51, v51
    v_exp_f32 v52, v52
    v_exp_f32 v53, v53
    v_exp_f32 v54, v54
    v_exp_f32 v55, v55
    v_mov_b32 v86, 0
    v_mov_b32 v87, 0
    v_cvt_pk_bf16_f32 v80, v44, v45
    v_cvt_pk_bf16_f32 v81, v46, v47
    v_cvt_pk_bf16_f32 v82, v48, v49
    v_cvt_pk_bf16_f32 v83, v50, v51
    v_cvt_pk_bf16_f32 v84, v52, v53
    v_cvt_pk_bf16_f32 v85, v54, v55
    v_add_f32 v92, v44, v45
    v_add_f32 v93, v46, v47
    v_add_f32 v94, v48, v49
    v_add_f32 v95, v50, v51
    v_cvt_pk_bf16_f32 v18, v56, v57
    v_cvt_pk_bf16_f32 v19, v58, v59
    v_cvt_pk_bf16_f32 v26, v60, v61
    v_cvt_pk_bf16_f32 v27, v62, v63
    v_add_f32 v92, v92, v52
    v_add_f32 v93, v93, v53
    v_mfma_f32_16x16x32_bf16 v[64:67], v[18:21], v[80:83], 0
    v_mfma_f32_16x16x32_bf16 v[68:71], v[26:29], v[80:83], 0
    v_mfma_f32_16x16x32_bf16 v[64:67], v[22:25], v[84:87], v[64:67]
    v_mfma_f32_16x16x32_bf16 v[68:71], v[30:33], v[84:87], v[68:71]
    s_cmp_eq_u32 s50, 63
    s_cbranch_scc1 L_ch_fin
    v_add_f32 v94, v94, v54
    v_add_f32 v95, v95, v55
    v_add_f32 v92, v92, v93
    v_add_f32 v94, v94, v95
    v_add_f32 v92, v92, v94
    v_mov_b32 v93, v92
    s_nop 1
    v_permlane32_swap_b32 v92, v93
    v_add_f32 v92, v92, v93
    v_mov_b32 v93, v92
    s_nop 1
    v_permlane16_swap_b32 v92, v93
    v_add_f32 v92, v92, v93
    v_rcp_f32 v92, v92
    s_nop 0

    v_mul_f32 v64, v64, v92
    v_mul_f32 v65, v65, v92
    v_mul_f32 v66, v66, v92
    v_mul_f32 v67, v67, v92
    v_mul_f32 v68, v68, v92
    v_mul_f32 v69, v69, v92
    v_mul_f32 v70, v70, v92
    v_mul_f32 v71, v71, v92
    v_cvt_pk_bf16_f32 v72, v64, v65
    v_cvt_pk_bf16_f32 v73, v66, v67
    v_cvt_pk_bf16_f32 v74, v68, v69
    v_cvt_pk_bf16_f32 v75, v70, v71
    ds_write_b128 v2, v[72:75]
    s_waitcnt lgkmcnt(0)
    s_barrier

    ds_read_b128 v[96:99], v9 offset:0
    ds_read_b128 v[100:103], v9 offset:512
    ds_read_b128 v[104:107], v9 offset:1024
    ds_read_b128 v[108:111], v9 offset:1536
    v_bfe_u32 v37, v6, 3, 1
    v_lshl_add_u32 v37, v37, 9, v5
    v_mov_b32 v120, -1
    v_mov_b32 v121, -1
    v_lshlrev_b32 v122, 4, v6
    s_add_u32 s12, s59, s68
    s_mov_b64 exec, s[76:77]
    buffer_store_dwordx2 v[120:121], v122, s[40:43], s12 offen
    s_mov_b64 exec, -1

    s_waitcnt lgkmcnt(0)
    v_mfma_f32_16x16x32_bf16 v[40:43], v[128:131], v[96:99], 0
    v_mfma_f32_16x16x32_bf16 v[40:43], v[132:135], v[100:103], v[40:43]
    v_mfma_f32_16x16x32_bf16 v[40:43], v[136:139], v[104:107], v[40:43]
    v_mfma_f32_16x16x32_bf16 v[40:43], v[140:143], v[108:111], v[40:43]
    v_mfma_f32_16x16x32_bf16 v[44:47], v[144:147], v[96:99], 0
    v_mfma_f32_16x16x32_bf16 v[44:47], v[148:151], v[100:103], v[44:47]
    v_mfma_f32_16x16x32_bf16 v[44:47], v[152:155], v[104:107], v[44:47]
    v_mfma_f32_16x16x32_bf16 v[44:47], v[156:159], v[108:111], v[44:47]
    v_mfma_f32_16x16x32_bf16 v[48:51], v[160:163], v[96:99], 0
    v_mfma_f32_16x16x32_bf16 v[48:51], v[164:167], v[100:103], v[48:51]
    v_mfma_f32_16x16x32_bf16 v[48:51], v[168:171], v[104:107], v[48:51]
    v_mfma_f32_16x16x32_bf16 v[48:51], v[172:175], v[108:111], v[48:51]
    v_mfma_f32_16x16x32_bf16 v[52:55], v[176:179], v[96:99], 0
    v_mfma_f32_16x16x32_bf16 v[52:55], v[180:183], v[100:103], v[52:55]
    v_mfma_f32_16x16x32_bf16 v[52:55], v[184:187], v[104:107], v[52:55]
    v_mfma_f32_16x16x32_bf16 v[52:55], v[188:191], v[108:111], v[52:55]
    v_cndmask_b32 v40, v44, v40, s[60:61]
    v_cndmask_b32 v41, v45, v41, s[60:61]
    v_cndmask_b32 v42, v46, v42, s[60:61]
    v_cndmask_b32 v43, v47, v43, s[60:61]
    buffer_store_dwordx4 v[40:43], v37, s[40:43], s53 offen offset:0
    v_mfma_f32_16x16x32_bf16 v[56:59], v[192:195], v[96:99], 0
    v_mfma_f32_16x16x32_bf16 v[56:59], v[196:199], v[100:103], v[56:59]
    v_mfma_f32_16x16x32_bf16 v[56:59], v[200:203], v[104:107], v[56:59]
    v_mfma_f32_16x16x32_bf16 v[56:59], v[204:207], v[108:111], v[56:59]
    v_mfma_f32_16x16x32_bf16 v[60:63], v[208:211], v[96:99], 0
    v_mfma_f32_16x16x32_bf16 v[60:63], v[212:215], v[100:103], v[60:63]
    v_mfma_f32_16x16x32_bf16 v[60:63], v[216:219], v[104:107], v[60:63]
    v_mfma_f32_16x16x32_bf16 v[60:63], v[220:223], v[108:111], v[60:63]
    v_cndmask_b32 v48, v52, v48, s[60:61]
    v_cndmask_b32 v49, v53, v49, s[60:61]
    v_cndmask_b32 v50, v54, v50, s[60:61]
    v_cndmask_b32 v51, v55, v51, s[60:61]
    buffer_store_dwordx4 v[48:51], v37, s[40:43], s53 offen offset:1024
    v_mfma_f32_16x16x32_bf16 v[112:115], v[224:227], v[96:99], 0
    v_mfma_f32_16x16x32_bf16 v[112:115], v[228:231], v[100:103], v[112:115]
    v_mfma_f32_16x16x32_bf16 v[112:115], v[232:235], v[104:107], v[112:115]
    v_mfma_f32_16x16x32_bf16 v[112:115], v[236:239], v[108:111], v[112:115]
    v_mfma_f32_16x16x32_bf16 v[116:119], v[240:243], v[96:99], 0
    v_mfma_f32_16x16x32_bf16 v[116:119], v[244:247], v[100:103], v[116:119]
    v_mfma_f32_16x16x32_bf16 v[116:119], v[248:251], v[104:107], v[116:119]
    v_mfma_f32_16x16x32_bf16 v[116:119], v[252:255], v[108:111], v[116:119]
    v_cndmask_b32 v56, v60, v56, s[60:61]
    v_cndmask_b32 v57, v61, v57, s[60:61]
    v_cndmask_b32 v58, v62, v58, s[60:61]
    v_cndmask_b32 v59, v63, v59, s[60:61]
    buffer_store_dwordx4 v[56:59], v37, s[40:43], s53 offen offset:2048
    s_nop 7
    v_cndmask_b32 v112, v116, v112, s[60:61]
    v_cndmask_b32 v113, v117, v113, s[60:61]
    v_cndmask_b32 v114, v118, v114, s[60:61]
    v_cndmask_b32 v115, v119, v115, s[60:61]
    buffer_store_dwordx4 v[112:115], v37, s[40:43], s53 offen offset:3072
    s_add_u32 s50, s50, 1
    s_add_u32 s12, s54, 131072
    s_add_u32 s13, s54, 262144
    s_add_u32 s14, s54, 393216
    s_mov_b32 s19, 1048576

L_ch_fast_pr_loop:
    buffer_load_dwordx4 v[64:67], v39, s[40:43], s54 offen sc1
    buffer_load_dwordx4 v[68:71], v39, s[40:43], s12 offen sc1
    buffer_load_dwordx4 v[72:75], v39, s[40:43], s13 offen sc1
    buffer_load_dwordx4 v[76:79], v39, s[40:43], s14 offen sc1
    s_waitcnt vmcnt(0)
    v_max3_u32 v34, v64, v65, v66
    v_max3_u32 v35, v67, v68, v69
    v_max3_u32 v36, v70, v71, v72
    v_max3_u32 v37, v73, v74, v75
    v_max3_u32 v34, v34, v76, v77
    v_max3_u32 v35, v35, v78, v79
    v_max3_u32 v34, v34, v36, v37
    v_max_u32 v34, v34, v35
    v_cmp_eq_u32 vcc, -1, v34
    s_cbranch_vccz L_ch_fast_pr_okA

    s_sub_u32 s19, s19, 1
    s_cmp_lg_u32 s19, 0
    s_cbranch_scc1 L_ch_fast_pr_loop
    s_branch L_ch_done

L_ch_fast_pr_okB:
    v_add_f32 v96, v80, v84
    v_add_f32 v100, v88, v92
    v_add_f32 v97, v81, v85
    v_add_f32 v101, v89, v93
    v_add_f32 v98, v82, v86
    v_add_f32 v102, v90, v94
    v_add_f32 v99, v83, v87
    v_add_f32 v103, v91, v95
    s_branch L_ch_fast_pr_join
L_ch_fast_pr_okA:
    v_add_f32 v96, v64, v68
    v_add_f32 v100, v72, v76
    v_add_f32 v97, v65, v69
    v_add_f32 v101, v73, v77
    v_add_f32 v98, v66, v70
    v_add_f32 v102, v74, v78
    v_add_f32 v99, v67, v71
    v_add_f32 v103, v75, v79
L_ch_fast_pr_join:
    v_add_f32 v96, v96, v100
    v_add_f32 v97, v97, v101
    v_add_f32 v98, v98, v102
    v_add_f32 v99, v99, v103
    s_nop 1
    v_add_f32_dpp v96, v96, v96 row_ror:8 row_mask:0xf bank_mask:0xf
    v_add_f32_dpp v97, v97, v97 row_ror:8 row_mask:0xf bank_mask:0xf
    v_add_f32_dpp v98, v98, v98 row_ror:8 row_mask:0xf bank_mask:0xf
    v_add_f32_dpp v99, v99, v99 row_ror:8 row_mask:0xf bank_mask:0xf
    v_mov_b32 v100, v96
    v_mov_b32 v101, v97
    v_mov_b32 v102, v98
    v_mov_b32 v103, v99
    s_nop 0
    v_permlane32_swap_b32 v96, v100
    v_permlane32_swap_b32 v97, v101
    v_permlane32_swap_b32 v98, v102
    v_permlane32_swap_b32 v99, v103
    v_add_f32 v96, v96, v100
    v_add_f32 v97, v97, v101
    v_add_f32 v98, v98, v102
    v_add_f32 v99, v99, v103
    v_mov_b32 v100, v96
    v_mov_b32 v101, v97
    v_mov_b32 v102, v98
    v_mov_b32 v103, v99
    s_nop 0
    v_permlane16_swap_b32 v96, v100
    v_permlane16_swap_b32 v97, v101
    v_permlane16_swap_b32 v98, v102
    v_permlane16_swap_b32 v99, v103
    v_add_f32 v96, v96, v100
    v_add_f32 v97, v97, v101
    v_add_f32 v98, v98, v102
    v_add_f32 v99, v99, v103
    v_cvt_pk_bf16_f32 v96, v96, v97
    v_cvt_pk_bf16_f32 v97, v98, v99
    v_lshlrev_b32 v98, 4, v6
    s_add_u32 s15, s52, s68
    s_mov_b64 exec, s[76:77]
    buffer_store_dwordx2 v[96:97], v98, s[40:43], s15 offen
    s_mov_b64 exec, -1
    v_mov_b32 v100, -1
    v_mov_b32 v101, -1
    v_mov_b32 v102, -1
    v_mov_b32 v103, -1
    buffer_store_dwordx4 v[100:103], v39, s[40:43], s54 offen
    buffer_store_dwordx4 v[100:103], v39, s[40:43], s12 offen
    buffer_store_dwordx4 v[100:103], v39, s[40:43], s13 offen
    buffer_store_dwordx4 v[100:103], v39, s[40:43], s14 offen

    s_mov_b32 s12, s51
    s_mov_b32 s51, s52
    s_mov_b32 s52, s59
    s_mov_b32 s59, s12
    s_xor_b32 s53, s53, 524288
    s_xor_b32 s54, s54, 524288
    s_add_u32 s57, s57, 131072
    s_branch L_ch_fast_step

L_ch_slow_step:
    s_mov_b32 s19, 1048576
    s_waitcnt vmcnt(0)

L_ch_slow_pm_loop:
    buffer_load_dwordx4 v[80:83], v1, s[40:43], s51 offen sc0 sc1
    buffer_load_dwordx4 v[84:87], v1, s[40:43], s51 offen offset:1024 sc0 sc1

    s_waitcnt vmcnt(0)
    v_max3_u32 v34, v80, v81, v82
    v_max3_u32 v35, v83, v84, v85
    v_max3_u32 v34, v34, v86, v87
    v_max_u32 v34, v34, v35
    v_cmp_eq_u32 vcc, -1, v34
    s_cbranch_vccz L_ch_slow_pm_okA

    s_sub_u32 s19, s19, 1
    s_cmp_lg_u32 s19, 0
    s_cbranch_scc1 L_ch_slow_pm_loop
    s_branch L_ch_done

L_ch_slow_pm_okB:
    ds_write_b128 v38, v[88:91]
    ds_write_b128 v38, v[92:95] offset:1024
    s_branch L_ch_slow_pm_join

L_ch_slow_pm_okA:
    ds_write_b128 v38, v[80:83]
    ds_write_b128 v38, v[84:87] offset:1024

L_ch_slow_pm_join:
    s_waitcnt lgkmcnt(0)
    s_barrier
    s_cmp_lg_u32 s3, 0
    s_cbranch_scc1 L_ch_slow_nocf
    s_cmp_eq_u32 s50, 0
    s_cbranch_scc1 L_ch_slow_nocf
    s_mov_b64 exec, 1
    s_sub_u32 s12, s50, 1
    v_mov_b32 v34, s12
    v_mov_b32 v35, 0
    buffer_store_dword v34, v35, s[40:43], s72 offen sc0 sc1
    s_mov_b64 exec, -1

L_ch_slow_nocf:
    v_add_u32 v34, s73, v1
    ds_read_b128 v[10:13], v34
    ds_read_b128 v[14:17], v34 offset:1024
    ds_read_b128 v[20:23], v34 offset:2048
    ds_read_b128 v[28:31], v34 offset:3072
    s_cmp_eq_u32 s50, 0
    s_cbranch_scc1 L_ch_slow_novm
    buffer_store_dwordx2 v[18:19], v3, s[40:43], s58 offen sc0 sc1
    buffer_store_dwordx2 v[26:27], v3, s[40:43], s58 offen offset:512 sc0 sc1
    s_add_u32 s58, s58, 131072

L_ch_slow_novm:
    ds_read_b128 v[96:99], v9 offset:2048
    ds_read_b128 v[64:67], v4 offset:0
    ds_read_b128 v[68:71], v4 offset:16384
    ds_read_b128 v[100:103], v9 offset:2560
    ds_read_b128 v[72:75], v4 offset:1024
    ds_read_b128 v[76:79], v4 offset:17408
    ds_read_b128 v[104:107], v9 offset:3072
    ds_read_b128 v[108:111], v9 offset:3584
    ds_read_b128 v[112:115], v9 offset:4096
    ds_read_b128 v[116:119], v9 offset:4608
    ds_read_b128 v[120:123], v9 offset:5120
    ds_read_b128 v[124:127], v9 offset:5632
    s_waitcnt lgkmcnt(11)
    v_mfma_f32_16x16x32_bf16 v[40:43], a[0:3], v[96:99], 0
    v_mfma_f32_16x16x32_bf16 v[44:47], a[64:67], v[96:99], 0
    v_mfma_f32_16x16x32_bf16 v[48:51], a[128:131], v[96:99], 0
    v_mfma_f32_16x16x32_bf16 v[52:55], a[192:195], v[96:99], 0
    s_waitcnt lgkmcnt(10)
    v_mfma_f32_16x16x32_bf16 v[56:59], v[96:99], v[64:67], 0
    s_waitcnt lgkmcnt(9)
    v_mfma_f32_16x16x32_bf16 v[60:63], v[96:99], v[68:71], 0
    ds_read_b128 v[96:99], v9 offset:6144
    ds_read_b128 v[64:67], v4 offset:2048
    ds_read_b128 v[68:71], v4 offset:18432
    s_waitcnt lgkmcnt(11)
    v_mfma_f32_16x16x32_bf16 v[40:43], a[4:7], v[100:103], v[40:43]
    v_mfma_f32_16x16x32_bf16 v[44:47], a[68:71], v[100:103], v[44:47]
    v_mfma_f32_16x16x32_bf16 v[48:51], a[132:135], v[100:103], v[48:51]
    v_mfma_f32_16x16x32_bf16 v[52:55], a[196:199], v[100:103], v[52:55]
    s_waitcnt lgkmcnt(10)
    v_mfma_f32_16x16x32_bf16 v[56:59], v[100:103], v[72:75], v[56:59]
    s_waitcnt lgkmcnt(9)
    v_mfma_f32_16x16x32_bf16 v[60:63], v[100:103], v[76:79], v[60:63]
    ds_read_b128 v[100:103], v9 offset:6656
    ds_read_b128 v[72:75], v4 offset:3072
    ds_read_b128 v[76:79], v4 offset:19456
    s_and_b32 s12, s50, 3
    s_cmp_lg_u32 s12, 3
    s_cbranch_scc1 L_ch_slow_nokv
    s_cmp_eq_u32 s50, 63
    s_cbranch_scc1 L_ch_slow_nokv

    s_mov_b64 exec, 3
    v_lshlrev_b32 v34, 6, v6
    s_mov_b32 s19, 1048576

L_ch_slow_kv_loop:
    buffer_load_dword v35, v34, s[40:43], s71 offen sc0 sc1
    s_waitcnt vmcnt(0)
    v_cmp_eq_u32 vcc, 0, v35
    s_cbranch_vccz L_ch_slow_kv_ok
    s_sleep 4
    s_sub_u32 s19, s19, 1
    s_cmp_lg_u32 s19, 0
    s_cbranch_scc1 L_ch_slow_kv_loop
    s_mov_b64 exec, -1
    s_branch L_ch_done

L_ch_slow_kv_ok:
    s_mov_b64 exec, -1
    s_add_u32 s71, s71, 256

L_ch_slow_nokv:
    s_add_u32 s12, s55, 131072
    s_mov_b32 m0, s73
    s_nop 0
    buffer_load_dwordx4 v1, s[40:43], s55 offen sc0 sc1 lds
    s_add_u32 m0, s73, 1024
    s_nop 0
    buffer_load_dwordx4 v1, s[40:43], s12 offen sc0 sc1 lds
    s_add_u32 m0, s73, 2048
    s_nop 0
    buffer_load_dwordx4 v1, s[40:43], s56 offen sc0 sc1 lds
    buffer_load_dwordx4 v1, s[40:43], s56 offen offset:1024 sc0 sc1 lds
    s_add_u32 s55, s55, 262144
    s_add_u32 s56, s56, 262144

    s_waitcnt lgkmcnt(11)
    v_mfma_f32_16x16x32_bf16 v[40:43], a[8:11], v[104:107], v[40:43]
    v_mfma_f32_16x16x32_bf16 v[44:47], a[72:75], v[104:107], v[44:47]
    v_mfma_f32_16x16x32_bf16 v[48:51], a[136:139], v[104:107], v[48:51]
    v_mfma_f32_16x16x32_bf16 v[52:55], a[200:203], v[104:107], v[52:55]
    s_waitcnt lgkmcnt(4)
    v_mfma_f32_16x16x32_bf16 v[56:59], v[104:107], v[64:67], v[56:59]
    s_waitcnt lgkmcnt(3)
    v_mfma_f32_16x16x32_bf16 v[60:63], v[104:107], v[68:71], v[60:63]
    ds_read_b128 v[104:107], v9 offset:7168
    ds_read_b128 v[64:67], v4 offset:4096
    ds_read_b128 v[68:71], v4 offset:20480
    v_mfma_f32_16x16x32_bf16 v[40:43], a[12:15], v[108:111], v[40:43]
    v_mfma_f32_16x16x32_bf16 v[44:47], a[76:79], v[108:111], v[44:47]
    v_mfma_f32_16x16x32_bf16 v[48:51], a[140:143], v[108:111], v[48:51]
    v_mfma_f32_16x16x32_bf16 v[52:55], a[204:207], v[108:111], v[52:55]
    s_waitcnt lgkmcnt(4)
    v_mfma_f32_16x16x32_bf16 v[56:59], v[108:111], v[72:75], v[56:59]
    s_waitcnt lgkmcnt(3)
    v_mfma_f32_16x16x32_bf16 v[60:63], v[108:111], v[76:79], v[60:63]
    ds_read_b128 v[108:111], v9 offset:7680
    ds_read_b128 v[72:75], v4 offset:5120
    ds_read_b128 v[76:79], v4 offset:21504
    v_mfma_f32_16x16x32_bf16 v[40:43], a[16:19], v[112:115], v[40:43]
    v_mfma_f32_16x16x32_bf16 v[44:47], a[80:83], v[112:115], v[44:47]
    v_mfma_f32_16x16x32_bf16 v[48:51], a[144:147], v[112:115], v[48:51]
    v_mfma_f32_16x16x32_bf16 v[52:55], a[208:211], v[112:115], v[52:55]
    s_waitcnt lgkmcnt(4)
    v_mfma_f32_16x16x32_bf16 v[56:59], v[112:115], v[64:67], v[56:59]
    s_waitcnt lgkmcnt(3)
    v_mfma_f32_16x16x32_bf16 v[60:63], v[112:115], v[68:71], v[60:63]
    ds_read_b128 v[112:115], v9 offset:8192
    ds_read_b128 v[64:67], v4 offset:6144
    ds_read_b128 v[68:71], v4 offset:22528
    v_mfma_f32_16x16x32_bf16 v[40:43], a[20:23], v[116:119], v[40:43]
    v_mfma_f32_16x16x32_bf16 v[44:47], a[84:87], v[116:119], v[44:47]
    v_mfma_f32_16x16x32_bf16 v[48:51], a[148:151], v[116:119], v[48:51]
    v_mfma_f32_16x16x32_bf16 v[52:55], a[212:215], v[116:119], v[52:55]
    s_waitcnt lgkmcnt(4)
    v_mfma_f32_16x16x32_bf16 v[56:59], v[116:119], v[72:75], v[56:59]
    s_waitcnt lgkmcnt(3)
    v_mfma_f32_16x16x32_bf16 v[60:63], v[116:119], v[76:79], v[60:63]
    ds_read_b128 v[116:119], v9 offset:8704
    ds_read_b128 v[72:75], v4 offset:7168
    ds_read_b128 v[76:79], v4 offset:23552
    v_mfma_f32_16x16x32_bf16 v[40:43], a[24:27], v[120:123], v[40:43]
    v_mfma_f32_16x16x32_bf16 v[44:47], a[88:91], v[120:123], v[44:47]
    v_mfma_f32_16x16x32_bf16 v[48:51], a[152:155], v[120:123], v[48:51]
    v_mfma_f32_16x16x32_bf16 v[52:55], a[216:219], v[120:123], v[52:55]
    s_waitcnt lgkmcnt(4)
    v_mfma_f32_16x16x32_bf16 v[56:59], v[120:123], v[64:67], v[56:59]
    s_waitcnt lgkmcnt(3)
    v_mfma_f32_16x16x32_bf16 v[60:63], v[120:123], v[68:71], v[60:63]
    ds_read_b128 v[120:123], v9 offset:9216
    ds_read_b128 v[64:67], v4 offset:8192
    ds_read_b128 v[68:71], v4 offset:24576
    v_mfma_f32_16x16x32_bf16 v[40:43], a[28:31], v[124:127], v[40:43]
    v_mfma_f32_16x16x32_bf16 v[44:47], a[92:95], v[124:127], v[44:47]
    v_mfma_f32_16x16x32_bf16 v[48:51], a[156:159], v[124:127], v[48:51]
    v_mfma_f32_16x16x32_bf16 v[52:55], a[220:223], v[124:127], v[52:55]
    s_waitcnt lgkmcnt(4)
    v_mfma_f32_16x16x32_bf16 v[56:59], v[124:127], v[72:75], v[56:59]
    s_waitcnt lgkmcnt(3)
    v_mfma_f32_16x16x32_bf16 v[60:63], v[124:127], v[76:79], v[60:63]
    ds_read_b128 v[124:127], v9 offset:9728
    ds_read_b128 v[72:75], v4 offset:9216
    ds_read_b128 v[76:79], v4 offset:25600
    v_mfma_f32_16x16x32_bf16 v[40:43], a[32:35], v[96:99], v[40:43]
    v_mfma_f32_16x16x32_bf16 v[44:47], a[96:99], v[96:99], v[44:47]
    v_mfma_f32_16x16x32_bf16 v[48:51], a[160:163], v[96:99], v[48:51]
    v_mfma_f32_16x16x32_bf16 v[52:55], a[224:227], v[96:99], v[52:55]
    v_mfma_f32_16x16x32_bf16 v[40:43], a[36:39], v[100:103], v[40:43]
    v_mfma_f32_16x16x32_bf16 v[44:47], a[100:103], v[100:103], v[44:47]
    v_mfma_f32_16x16x32_bf16 v[48:51], a[164:167], v[100:103], v[48:51]
    v_mfma_f32_16x16x32_bf16 v[52:55], a[228:231], v[100:103], v[52:55]
    v_mfma_f32_16x16x32_bf16 v[40:43], a[40:43], v[104:107], v[40:43]
    v_mfma_f32_16x16x32_bf16 v[44:47], a[104:107], v[104:107], v[44:47]
    v_mfma_f32_16x16x32_bf16 v[48:51], a[168:171], v[104:107], v[48:51]
    v_mfma_f32_16x16x32_bf16 v[52:55], a[232:235], v[104:107], v[52:55]
    v_mfma_f32_16x16x32_bf16 v[40:43], a[44:47], v[108:111], v[40:43]
    v_mfma_f32_16x16x32_bf16 v[44:47], a[108:111], v[108:111], v[44:47]
    v_mfma_f32_16x16x32_bf16 v[48:51], a[172:175], v[108:111], v[48:51]
    v_mfma_f32_16x16x32_bf16 v[52:55], a[236:239], v[108:111], v[52:55]
    v_mfma_f32_16x16x32_bf16 v[40:43], a[48:51], v[112:115], v[40:43]
    v_mfma_f32_16x16x32_bf16 v[44:47], a[112:115], v[112:115], v[44:47]
    v_mfma_f32_16x16x32_bf16 v[48:51], a[176:179], v[112:115], v[48:51]
    v_mfma_f32_16x16x32_bf16 v[52:55], a[240:243], v[112:115], v[52:55]
    v_mfma_f32_16x16x32_bf16 v[40:43], a[52:55], v[116:119], v[40:43]
    v_mfma_f32_16x16x32_bf16 v[44:47], a[116:119], v[116:119], v[44:47]
    v_mfma_f32_16x16x32_bf16 v[48:51], a[180:183], v[116:119], v[48:51]
    v_mfma_f32_16x16x32_bf16 v[52:55], a[244:247], v[116:119], v[52:55]
    s_waitcnt lgkmcnt(5)
    v_mfma_f32_16x16x32_bf16 v[40:43], a[56:59], v[120:123], v[40:43]
    v_mfma_f32_16x16x32_bf16 v[44:47], a[120:123], v[120:123], v[44:47]
    v_mfma_f32_16x16x32_bf16 v[48:51], a[184:187], v[120:123], v[48:51]
    v_mfma_f32_16x16x32_bf16 v[52:55], a[248:251], v[120:123], v[52:55]
    s_waitcnt lgkmcnt(2)
    v_mfma_f32_16x16x32_bf16 v[40:43], a[60:63], v[124:127], v[40:43]
    v_mfma_f32_16x16x32_bf16 v[44:47], a[124:127], v[124:127], v[44:47]
    v_mfma_f32_16x16x32_bf16 v[48:51], a[188:191], v[124:127], v[48:51]
    v_mfma_f32_16x16x32_bf16 v[52:55], a[252:255], v[124:127], v[52:55]
    s_nop 7
    v_cvt_pk_bf16_f32 v34, v40, v41
    v_cvt_pk_bf16_f32 v35, v42, v43
    v_cvt_pk_bf16_f32 v36, v44, v45
    v_cvt_pk_bf16_f32 v37, v46, v47
    v_cvt_pk_bf16_f32 v40, v48, v49
    v_cvt_pk_bf16_f32 v41, v50, v51
    v_cvt_pk_bf16_f32 v42, v52, v53
    v_cvt_pk_bf16_f32 v43, v54, v55
    s_nop 1
    v_mfma_f32_16x16x32_bf16 v[44:47], v[40:43], v[34:37], 0
    v_mfma_f32_16x16x32_bf16 v[48:51], v[10:13], v[34:37], 0
    v_mfma_f32_16x16x32_bf16 v[52:55], v[14:17], v[34:37], 0
    buffer_store_dwordx4 v[40:43], v1, s[40:43], s57 offen sc0 sc1

    v_mfma_f32_16x16x32_bf16 v[56:59], v[96:99], v[64:67], v[56:59]
    v_mfma_f32_16x16x32_bf16 v[60:63], v[96:99], v[68:71], v[60:63]
    ds_read_b128 v[64:67], v4 offset:10240
    ds_read_b128 v[68:71], v4 offset:26624
    s_nop 3
    ds_write_b128 v8, v[44:47]
    ds_write_b128 v8, v[48:51] offset:512
    ds_write_b128 v8, v[52:55] offset:1024
    s_waitcnt lgkmcnt(6)
    v_mfma_f32_16x16x32_bf16 v[56:59], v[100:103], v[72:75], v[56:59]
    s_waitcnt lgkmcnt(5)
    v_mfma_f32_16x16x32_bf16 v[60:63], v[100:103], v[76:79], v[60:63]
    ds_read_b128 v[72:75], v4 offset:11264
    ds_read_b128 v[76:79], v4 offset:27648
    s_waitcnt lgkmcnt(2)
    s_barrier
    ds_read_b128 v[80:83], v7 offset:0
    ds_read_b128 v[84:87], v7 offset:512
    ds_read_b128 v[88:91], v7 offset:1024
    ds_read_b128 v[44:47], v0 offset:0
    ds_read_b128 v[48:51], v0 offset:512
    ds_read_b128 v[52:55], v0 offset:1024
    v_mov_b32 v95, 0xf149f2ca
    v_mfma_f32_16x16x32_bf16 v[56:59], v[104:107], v[64:67], v[56:59]
    v_mfma_f32_16x16x32_bf16 v[60:63], v[104:107], v[68:71], v[60:63]
    ds_read_b128 v[64:67], v4 offset:12288
    ds_read_b128 v[68:71], v4 offset:28672
    s_waitcnt lgkmcnt(2)
    v_add_f32 v44, v44, v80
    v_add_f32 v45, v45, v81
    v_add_f32 v46, v46, v82
    v_add_f32 v47, v47, v83
    v_add_f32 v48, v48, v84
    v_add_f32 v49, v49, v85
    v_add_f32 v50, v50, v86
    v_add_f32 v51, v51, v87
    v_add_f32 v52, v52, v88
    v_add_f32 v53, v53, v89
    v_add_f32 v54, v54, v90
    v_add_f32 v55, v55, v91
    v_mfma_f32_16x16x32_bf16 v[56:59], v[108:111], v[72:75], v[56:59]
    v_mfma_f32_16x16x32_bf16 v[60:63], v[108:111], v[76:79], v[60:63]
    ds_read_b128 v[72:75], v4 offset:13312
    ds_read_b128 v[76:79], v4 offset:29696
    v_add_f32_dpp v44, v44, v44 row_ror:8 row_mask:0xf bank_mask:0xf
    v_add_f32_dpp v45, v45, v45 row_ror:8 row_mask:0xf bank_mask:0xf
    v_add_f32_dpp v46, v46, v46 row_ror:8 row_mask:0xf bank_mask:0xf
    v_add_f32_dpp v47, v47, v47 row_ror:8 row_mask:0xf bank_mask:0xf
    v_add_f32_dpp v48, v48, v48 row_ror:8 row_mask:0xf bank_mask:0xf
    v_add_f32_dpp v49, v49, v49 row_ror:8 row_mask:0xf bank_mask:0xf
    v_add_f32_dpp v50, v50, v50 row_ror:8 row_mask:0xf bank_mask:0xf
    v_add_f32_dpp v51, v51, v51 row_ror:8 row_mask:0xf bank_mask:0xf
    v_add_f32_dpp v52, v52, v52 row_ror:8 row_mask:0xf bank_mask:0xf
    v_add_f32_dpp v53, v53, v53 row_ror:8 row_mask:0xf bank_mask:0xf
    v_add_f32_dpp v54, v54, v54 row_ror:8 row_mask:0xf bank_mask:0xf
    v_add_f32_dpp v55, v55, v55 row_ror:8 row_mask:0xf bank_mask:0xf
    v_cndmask_b32 v44, v95, v44, s[62:63]
    v_cndmask_b32 v45, v95, v45, s[62:63]
    v_cndmask_b32 v46, v95, v46, s[62:63]
    v_cndmask_b32 v47, v95, v47, s[62:63]
    s_waitcnt lgkmcnt(3)
    v_mfma_f32_16x16x32_bf16 v[56:59], v[112:115], v[64:67], v[56:59]
    s_waitcnt lgkmcnt(2)
    v_mfma_f32_16x16x32_bf16 v[60:63], v[112:115], v[68:71], v[60:63]
    ds_read_b128 v[64:67], v4 offset:14336
    ds_read_b128 v[68:71], v4 offset:30720
    v_max3_f32 v92, v48, v49, v50
    v_max3_f32 v93, v51, v52, v53
    v_max3_f32 v94, v54, v55, v44
    v_max3_f32 v92, v92, v45, v46
    v_max3_f32 v93, v93, v94, v47
    v_max_f32 v92, v92, v93
    v_mov_b32 v93, v92

    s_waitcnt lgkmcnt(3)
    v_mfma_f32_16x16x32_bf16 v[56:59], v[116:119], v[72:75], v[56:59]
    s_waitcnt lgkmcnt(2)
    v_mfma_f32_16x16x32_bf16 v[60:63], v[116:119], v[76:79], v[60:63]
    ds_read_b128 v[72:75], v4 offset:15360
    ds_read_b128 v[76:79], v4 offset:31744
    v_permlane32_swap_b32 v92, v93
    v_max_f32 v92, v92, v93
    v_mov_b32 v93, v92
    s_nop 1
    v_permlane16_swap_b32 v92, v93
    v_max_f32 v92, v92, v93
    v_mul_f32 v92, s69, v92

    v_fma_f32 v44, v44, s69, -v92
    v_fma_f32 v45, v45, s69, -v92
    v_fma_f32 v46, v46, s69, -v92
    v_fma_f32 v47, v47, s69, -v92
    v_fma_f32 v48, v48, s69, -v92
    v_fma_f32 v49, v49, s69, -v92
    v_fma_f32 v50, v50, s69, -v92
    v_fma_f32 v51, v51, s69, -v92
    v_fma_f32 v52, v52, s69, -v92
    v_fma_f32 v53, v53, s69, -v92
    v_fma_f32 v54, v54, s69, -v92
    v_fma_f32 v55, v55, s69, -v92
    s_waitcnt lgkmcnt(3)
    v_mfma_f32_16x16x32_bf16 v[56:59], v[120:123], v[64:67], v[56:59]
    s_waitcnt lgkmcnt(2)
    v_mfma_f32_16x16x32_bf16 v[60:63], v[120:123], v[68:71], v[60:63]
    v_exp_f32 v44, v44
    v_exp_f32 v45, v45
    v_exp_f32 v46, v46
    v_exp_f32 v47, v47
    v_exp_f32 v48, v48
    v_exp_f32 v49, v49
    s_waitcnt lgkmcnt(1)
    v_mfma_f32_16x16x32_bf16 v[56:59], v[124:127], v[72:75], v[56:59]
    s_waitcnt lgkmcnt(0)
    v_mfma_f32_16x16x32_bf16 v[60:63], v[124:127], v[76:79], v[60:63]
    v_exp_f32 v50, v50
    v_exp_f32 v51, v51
    v_exp_f32 v52, v52
    v_exp_f32 v53, v53
    v_exp_f32 v54, v54
    v_exp_f32 v55, v55
    v_mov_b32 v86, 0
    v_mov_b32 v87, 0
    v_cvt_pk_bf16_f32 v80, v44, v45
    v_cvt_pk_bf16_f32 v81, v46, v47
    v_cvt_pk_bf16_f32 v82, v48, v49
    v_cvt_pk_bf16_f32 v83, v50, v51
    v_cvt_pk_bf16_f32 v84, v52, v53
    v_cvt_pk_bf16_f32 v85, v54, v55
    v_add_f32 v92, v44, v45
    v_add_f32 v93, v46, v47
    v_add_f32 v94, v48, v49
    v_add_f32 v95, v50, v51
    v_cvt_pk_bf16_f32 v18, v56, v57
    v_cvt_pk_bf16_f32 v19, v58, v59
    v_cvt_pk_bf16_f32 v26, v60, v61
    v_cvt_pk_bf16_f32 v27, v62, v63
    v_add_f32 v92, v92, v52
    v_add_f32 v93, v93, v53
    v_mfma_f32_16x16x32_bf16 v[64:67], v[18:21], v[80:83], 0
    v_mfma_f32_16x16x32_bf16 v[68:71], v[26:29], v[80:83], 0
    v_mfma_f32_16x16x32_bf16 v[64:67], v[22:25], v[84:87], v[64:67]
    v_mfma_f32_16x16x32_bf16 v[68:71], v[30:33], v[84:87], v[68:71]
    s_cmp_eq_u32 s50, 63
    s_cbranch_scc1 L_ch_fin
    v_add_f32 v94, v94, v54
    v_add_f32 v95, v95, v55
    v_add_f32 v92, v92, v93
    v_add_f32 v94, v94, v95
    v_add_f32 v92, v92, v94
    v_mov_b32 v93, v92
    s_nop 1
    v_permlane32_swap_b32 v92, v93
    v_add_f32 v92, v92, v93
    v_mov_b32 v93, v92
    s_nop 1
    v_permlane16_swap_b32 v92, v93
    v_add_f32 v92, v92, v93
    v_rcp_f32 v92, v92
    s_nop 0

    v_mul_f32 v64, v64, v92
    v_mul_f32 v65, v65, v92
    v_mul_f32 v66, v66, v92
    v_mul_f32 v67, v67, v92
    v_mul_f32 v68, v68, v92
    v_mul_f32 v69, v69, v92
    v_mul_f32 v70, v70, v92
    v_mul_f32 v71, v71, v92
    v_cvt_pk_bf16_f32 v72, v64, v65
    v_cvt_pk_bf16_f32 v73, v66, v67
    v_cvt_pk_bf16_f32 v74, v68, v69
    v_cvt_pk_bf16_f32 v75, v70, v71
    ds_write_b128 v2, v[72:75]
    s_waitcnt lgkmcnt(0)
    s_barrier

    ds_read_b128 v[96:99], v9 offset:0
    ds_read_b128 v[100:103], v9 offset:512
    ds_read_b128 v[104:107], v9 offset:1024
    ds_read_b128 v[108:111], v9 offset:1536
    v_bfe_u32 v37, v6, 3, 1
    v_lshl_add_u32 v37, v37, 9, v5
    v_mov_b32 v120, -1
    v_mov_b32 v121, -1
    v_lshlrev_b32 v122, 4, v6
    s_add_u32 s12, s59, s68
    s_mov_b64 exec, s[76:77]
    buffer_store_dwordx2 v[120:121], v122, s[40:43], s12 offen sc0 sc1
    s_mov_b64 exec, -1

    s_waitcnt lgkmcnt(0)
    v_mfma_f32_16x16x32_bf16 v[40:43], v[128:131], v[96:99], 0
    v_mfma_f32_16x16x32_bf16 v[40:43], v[132:135], v[100:103], v[40:43]
    v_mfma_f32_16x16x32_bf16 v[40:43], v[136:139], v[104:107], v[40:43]
    v_mfma_f32_16x16x32_bf16 v[40:43], v[140:143], v[108:111], v[40:43]
    v_mfma_f32_16x16x32_bf16 v[44:47], v[144:147], v[96:99], 0
    v_mfma_f32_16x16x32_bf16 v[44:47], v[148:151], v[100:103], v[44:47]
    v_mfma_f32_16x16x32_bf16 v[44:47], v[152:155], v[104:107], v[44:47]
    v_mfma_f32_16x16x32_bf16 v[44:47], v[156:159], v[108:111], v[44:47]
    v_mfma_f32_16x16x32_bf16 v[48:51], v[160:163], v[96:99], 0
    v_mfma_f32_16x16x32_bf16 v[48:51], v[164:167], v[100:103], v[48:51]
    v_mfma_f32_16x16x32_bf16 v[48:51], v[168:171], v[104:107], v[48:51]
    v_mfma_f32_16x16x32_bf16 v[48:51], v[172:175], v[108:111], v[48:51]
    v_mfma_f32_16x16x32_bf16 v[52:55], v[176:179], v[96:99], 0
    v_mfma_f32_16x16x32_bf16 v[52:55], v[180:183], v[100:103], v[52:55]
    v_mfma_f32_16x16x32_bf16 v[52:55], v[184:187], v[104:107], v[52:55]
    v_mfma_f32_16x16x32_bf16 v[52:55], v[188:191], v[108:111], v[52:55]
    v_cndmask_b32 v40, v44, v40, s[60:61]
    v_cndmask_b32 v41, v45, v41, s[60:61]
    v_cndmask_b32 v42, v46, v42, s[60:61]
    v_cndmask_b32 v43, v47, v43, s[60:61]
    buffer_store_dwordx4 v[40:43], v37, s[40:43], s53 offen offset:0 sc0 sc1
    v_mfma_f32_16x16x32_bf16 v[56:59], v[192:195], v[96:99], 0
    v_mfma_f32_16x16x32_bf16 v[56:59], v[196:199], v[100:103], v[56:59]
    v_mfma_f32_16x16x32_bf16 v[56:59], v[200:203], v[104:107], v[56:59]
    v_mfma_f32_16x16x32_bf16 v[56:59], v[204:207], v[108:111], v[56:59]
    v_mfma_f32_16x16x32_bf16 v[60:63], v[208:211], v[96:99], 0
    v_mfma_f32_16x16x32_bf16 v[60:63], v[212:215], v[100:103], v[60:63]
    v_mfma_f32_16x16x32_bf16 v[60:63], v[216:219], v[104:107], v[60:63]
    v_mfma_f32_16x16x32_bf16 v[60:63], v[220:223], v[108:111], v[60:63]
    v_cndmask_b32 v48, v52, v48, s[60:61]
    v_cndmask_b32 v49, v53, v49, s[60:61]
    v_cndmask_b32 v50, v54, v50, s[60:61]
    v_cndmask_b32 v51, v55, v51, s[60:61]
    buffer_store_dwordx4 v[48:51], v37, s[40:43], s53 offen offset:1024 sc0 sc1
    v_mfma_f32_16x16x32_bf16 v[112:115], v[224:227], v[96:99], 0
    v_mfma_f32_16x16x32_bf16 v[112:115], v[228:231], v[100:103], v[112:115]
    v_mfma_f32_16x16x32_bf16 v[112:115], v[232:235], v[104:107], v[112:115]
    v_mfma_f32_16x16x32_bf16 v[112:115], v[236:239], v[108:111], v[112:115]
    v_mfma_f32_16x16x32_bf16 v[116:119], v[240:243], v[96:99], 0
    v_mfma_f32_16x16x32_bf16 v[116:119], v[244:247], v[100:103], v[116:119]
    v_mfma_f32_16x16x32_bf16 v[116:119], v[248:251], v[104:107], v[116:119]
    v_mfma_f32_16x16x32_bf16 v[116:119], v[252:255], v[108:111], v[116:119]
    v_cndmask_b32 v56, v60, v56, s[60:61]
    v_cndmask_b32 v57, v61, v57, s[60:61]
    v_cndmask_b32 v58, v62, v58, s[60:61]
    v_cndmask_b32 v59, v63, v59, s[60:61]
    buffer_store_dwordx4 v[56:59], v37, s[40:43], s53 offen offset:2048 sc0 sc1
    s_nop 7
    v_cndmask_b32 v112, v116, v112, s[60:61]
    v_cndmask_b32 v113, v117, v113, s[60:61]
    v_cndmask_b32 v114, v118, v114, s[60:61]
    v_cndmask_b32 v115, v119, v115, s[60:61]
    buffer_store_dwordx4 v[112:115], v37, s[40:43], s53 offen offset:3072 sc0 sc1
    s_add_u32 s50, s50, 1
    s_add_u32 s12, s54, 131072
    s_add_u32 s13, s54, 262144
    s_add_u32 s14, s54, 393216
    s_mov_b32 s19, 1048576

L_ch_slow_pr_loop:
    buffer_load_dwordx4 v[64:67], v39, s[40:43], s54 offen sc0 sc1
    buffer_load_dwordx4 v[68:71], v39, s[40:43], s12 offen sc0 sc1
    buffer_load_dwordx4 v[72:75], v39, s[40:43], s13 offen sc0 sc1
    buffer_load_dwordx4 v[76:79], v39, s[40:43], s14 offen sc0 sc1
    s_waitcnt vmcnt(0)
    v_max3_u32 v34, v64, v65, v66
    v_max3_u32 v35, v67, v68, v69
    v_max3_u32 v36, v70, v71, v72
    v_max3_u32 v37, v73, v74, v75
    v_max3_u32 v34, v34, v76, v77
    v_max3_u32 v35, v35, v78, v79
    v_max3_u32 v34, v34, v36, v37
    v_max_u32 v34, v34, v35
    v_cmp_eq_u32 vcc, -1, v34
    s_cbranch_vccz L_ch_slow_pr_okA

    s_sub_u32 s19, s19, 1
    s_cmp_lg_u32 s19, 0
    s_cbranch_scc1 L_ch_slow_pr_loop
    s_branch L_ch_done

L_ch_slow_pr_okB:
    v_add_f32 v96, v80, v84
    v_add_f32 v100, v88, v92
    v_add_f32 v97, v81, v85
    v_add_f32 v101, v89, v93
    v_add_f32 v98, v82, v86
    v_add_f32 v102, v90, v94
    v_add_f32 v99, v83, v87
    v_add_f32 v103, v91, v95
    s_branch L_ch_slow_pr_join
L_ch_slow_pr_okA:
    v_add_f32 v96, v64, v68
    v_add_f32 v100, v72, v76
    v_add_f32 v97, v65, v69
    v_add_f32 v101, v73, v77
    v_add_f32 v98, v66, v70
    v_add_f32 v102, v74, v78
    v_add_f32 v99, v67, v71
    v_add_f32 v103, v75, v79
L_ch_slow_pr_join:
    v_add_f32 v96, v96, v100
    v_add_f32 v97, v97, v101
    v_add_f32 v98, v98, v102
    v_add_f32 v99, v99, v103
    s_nop 1
    v_add_f32_dpp v96, v96, v96 row_ror:8 row_mask:0xf bank_mask:0xf
    v_add_f32_dpp v97, v97, v97 row_ror:8 row_mask:0xf bank_mask:0xf
    v_add_f32_dpp v98, v98, v98 row_ror:8 row_mask:0xf bank_mask:0xf
    v_add_f32_dpp v99, v99, v99 row_ror:8 row_mask:0xf bank_mask:0xf
    v_mov_b32 v100, v96
    v_mov_b32 v101, v97
    v_mov_b32 v102, v98
    v_mov_b32 v103, v99
    s_nop 0
    v_permlane32_swap_b32 v96, v100
    v_permlane32_swap_b32 v97, v101
    v_permlane32_swap_b32 v98, v102
    v_permlane32_swap_b32 v99, v103
    v_add_f32 v96, v96, v100
    v_add_f32 v97, v97, v101
    v_add_f32 v98, v98, v102
    v_add_f32 v99, v99, v103
    v_mov_b32 v100, v96
    v_mov_b32 v101, v97
    v_mov_b32 v102, v98
    v_mov_b32 v103, v99
    s_nop 0
    v_permlane16_swap_b32 v96, v100
    v_permlane16_swap_b32 v97, v101
    v_permlane16_swap_b32 v98, v102
    v_permlane16_swap_b32 v99, v103
    v_add_f32 v96, v96, v100
    v_add_f32 v97, v97, v101
    v_add_f32 v98, v98, v102
    v_add_f32 v99, v99, v103
    v_cvt_pk_bf16_f32 v96, v96, v97
    v_cvt_pk_bf16_f32 v97, v98, v99
    v_lshlrev_b32 v98, 4, v6
    s_add_u32 s15, s52, s68
    s_mov_b64 exec, s[76:77]
    buffer_store_dwordx2 v[96:97], v98, s[40:43], s15 offen sc0 sc1
    s_mov_b64 exec, -1
    v_mov_b32 v100, -1
    v_mov_b32 v101, -1
    v_mov_b32 v102, -1
    v_mov_b32 v103, -1
    buffer_store_dwordx4 v[100:103], v39, s[40:43], s54 offen sc0 sc1
    buffer_store_dwordx4 v[100:103], v39, s[40:43], s12 offen sc0 sc1
    buffer_store_dwordx4 v[100:103], v39, s[40:43], s13 offen sc0 sc1
    buffer_store_dwordx4 v[100:103], v39, s[40:43], s14 offen sc0 sc1

    s_mov_b32 s12, s51
    s_mov_b32 s51, s52
    s_mov_b32 s52, s59
    s_mov_b32 s59, s12
    s_xor_b32 s53, s53, 524288
    s_xor_b32 s54, s54, 524288
    s_add_u32 s57, s57, 131072
    s_branch L_ch_slow_step

L_ch_fin:
    buffer_store_dwordx2 v[18:19], v3, s[40:43], s58 offen sc0 sc1
    buffer_store_dwordx2 v[26:27], v3, s[40:43], s58 offen offset:512 sc0 sc1
    s_waitcnt vmcnt(0)
    s_barrier
    s_cmp_lg_u32 s3, 0
    s_cbranch_scc1 L_ch_done
    s_mov_b64 exec, 1
    v_mov_b32 v34, 64
    v_mov_b32 v35, 0
    buffer_store_dword v34, v35, s[40:43], s72 offen sc0 sc1
    s_branch L_ch_done

L_w_entry:
    s_load_dwordx2 s[10:11], s[0:1], 0
    s_load_dwordx2 s[12:13], s[0:1], 88
    s_waitcnt lgkmcnt(0)

    s_mov_b32 s84, s10
    s_mov_b32 s85, s11
    s_and_b32 s85, s85, 0xffff
    s_mov_b32 s86, 2097152
    s_mov_b32 s87, 0x00020000
    s_mov_b32 s88, s12
    s_mov_b32 s89, s13
    s_and_b32 s89, s89, 0xffff
    s_mov_b32 s90, 2097152
    s_mov_b32 s91, 0x00020000
L_w_loop:
    s_barrier
    s_cmp_lg_u32 s3, 0
    s_cbranch_scc1 L_w_get
    s_mov_b64 exec, 1
    v_mov_b32 v10, 1
    v_mov_b32 v11, 64
    buffer_atomic_add v10, v11, s[44:47], 0 offen sc0 sc1
    v_mov_b32 v11, 137196
    s_waitcnt vmcnt(0)
    ds_write_b32 v11, v10
    s_waitcnt lgkmcnt(0)
    s_mov_b64 exec, -1

L_w_get:
    s_barrier
    v_mov_b32 v11, 137196
    ds_read_b32 v10, v11
    v_and_b32 v6, 63, v0
    v_lshlrev_b32 v1, 4, v6
    v_lshlrev_b32 v3, 3, v6
    v_and_b32 v8, 15, v6
    v_lshrrev_b32 v9, 4, v6
    s_waitcnt lgkmcnt(0)
    v_readfirstlane_b32 s2, v10
    s_cmp_ge_u32 s2, 2016
    s_cbranch_scc1 L_ch_done
    s_cmp_ge_u32 s2, 992
    s_cbranch_scc1 L_w_t3
    s_cmp_ge_u32 s2, 512
    s_cbranch_scc1 L_w_t2
    s_lshr_b32 s5, s2, 5
    s_and_b32 s4, s2, 31
    s_add_u32 s4, s4, 16
    s_branch L_w_g1

L_w_t2:
    s_sub_u32 s6, s2, 512
    s_mul_i32 s5, s6, 2185
    s_lshr_b32 s5, s5, 16
    s_mul_i32 s7, s5, 30
    s_sub_u32 s4, s6, s7
    s_add_u32 s7, s4, 32
    s_cmp_lt_u32 s4, 16
    s_cselect_b32 s4, s4, s7

L_w_g1:
    s_mov_b32 s92, s4
    s_mov_b32 s93, s5
    s_lshl_b32 s6, s4, 18
    s_add_u32 s6, s6, 2097152
    s_lshl_b32 s7, s5, 17
    s_add_u32 s7, s7, -262144
    s_mul_i32 s10, s3, 6

    s_add_u32 s11, s10, 0
    s_cmp_lt_u32 s11, 16
    s_cselect_b32 s12, s6, s7
    s_lshl_b32 s13, s11, 14
    s_add_u32 s20, s12, s13
    s_lshl_b32 s26, s11, 11

    s_add_u32 s11, s10, 1
    s_cmp_lt_u32 s11, 16
    s_cselect_b32 s12, s6, s7
    s_lshl_b32 s13, s11, 14
    s_add_u32 s21, s12, s13
    s_lshl_b32 s27, s11, 11

    s_add_u32 s11, s10, 2
    s_cmp_lt_u32 s11, 16
    s_cselect_b32 s12, s6, s7
    s_lshl_b32 s13, s11, 14
    s_add_u32 s22, s12, s13
    s_lshl_b32 s28, s11, 11

    s_add_u32 s11, s10, 3
    s_cmp_lt_u32 s11, 16
    s_cselect_b32 s12, s6, s7
    s_lshl_b32 s13, s11, 14
    s_add_u32 s23, s12, s13
    s_lshl_b32 s29, s11, 11

    s_add_u32 s11, s10, 4
    s_cmp_lt_u32 s11, 16
    s_cselect_b32 s12, s6, s7
    s_lshl_b32 s13, s11, 14
    s_add_u32 s24, s12, s13
    s_lshl_b32 s30, s11, 11

    s_add_u32 s11, s10, 5
    s_cmp_lt_u32 s11, 16
    s_cselect_b32 s12, s6, s7
    s_lshl_b32 s13, s11, 14
    s_add_u32 s25, s12, s13
    s_lshl_b32 s31, s11, 11

    s_lshr_b32 s14, s3, 1
    s_and_b32 s15, s3, 1
    s_lshl_b32 s16, s14, 14
    s_lshl_b32 s17, s15, 13
    s_add_u32 s17, s17, 32768
    v_add_u32 v3, s16, v1
    v_add_u32 v4, s17, v1

    v_mov_b32 v128, 0
    v_mov_b32 v129, 0
    v_mov_b32 v130, 0
    v_mov_b32 v131, 0
    v_mov_b32 v132, 0
    v_mov_b32 v133, 0
    v_mov_b32 v134, 0
    v_mov_b32 v135, 0
    v_mov_b32 v136, 0
    v_mov_b32 v137, 0
    v_mov_b32 v138, 0
    v_mov_b32 v139, 0
    v_mov_b32 v140, 0
    v_mov_b32 v141, 0
    v_mov_b32 v142, 0
    v_mov_b32 v143, 0
    v_mov_b32 v144, 0
    v_mov_b32 v145, 0
    v_mov_b32 v146, 0
    v_mov_b32 v147, 0
    v_mov_b32 v148, 0
    v_mov_b32 v149, 0
    v_mov_b32 v150, 0
    v_mov_b32 v151, 0
    v_mov_b32 v152, 0
    v_mov_b32 v153, 0
    v_mov_b32 v154, 0
    v_mov_b32 v155, 0
    v_mov_b32 v156, 0
    v_mov_b32 v157, 0
    v_mov_b32 v158, 0
    v_mov_b32 v159, 0
    v_mov_b32 v160, 0
    v_mov_b32 v161, 0
    v_mov_b32 v162, 0
    v_mov_b32 v163, 0
    v_mov_b32 v164, 0
    v_mov_b32 v165, 0
    v_mov_b32 v166, 0
    v_mov_b32 v167, 0
    v_mov_b32 v168, 0
    v_mov_b32 v169, 0
    v_mov_b32 v170, 0
    v_mov_b32 v171, 0
    v_mov_b32 v172, 0
    v_mov_b32 v173, 0
    v_mov_b32 v174, 0
    v_mov_b32 v175, 0
    v_mov_b32 v176, 0
    v_mov_b32 v177, 0
    v_mov_b32 v178, 0
    v_mov_b32 v179, 0
    v_mov_b32 v180, 0
    v_mov_b32 v181, 0
    v_mov_b32 v182, 0
    v_mov_b32 v183, 0
    v_mov_b32 v184, 0
    v_mov_b32 v185, 0
    v_mov_b32 v186, 0
    v_mov_b32 v187, 0
    v_mov_b32 v188, 0
    v_mov_b32 v189, 0
    v_mov_b32 v190, 0
    v_mov_b32 v191, 0
    v_mov_b32 v192, 0
    v_mov_b32 v193, 0
    v_mov_b32 v194, 0
    v_mov_b32 v195, 0
    v_mov_b32 v196, 0
    v_mov_b32 v197, 0
    v_mov_b32 v198, 0
    v_mov_b32 v199, 0
    v_mov_b32 v200, 0
    v_mov_b32 v201, 0
    v_mov_b32 v202, 0
    v_mov_b32 v203, 0
    v_mov_b32 v204, 0
    v_mov_b32 v205, 0
    v_mov_b32 v206, 0
    v_mov_b32 v207, 0
    v_mov_b32 v208, 0
    v_mov_b32 v209, 0
    v_mov_b32 v210, 0
    v_mov_b32 v211, 0
    v_mov_b32 v212, 0
    v_mov_b32 v213, 0
    v_mov_b32 v214, 0
    v_mov_b32 v215, 0
    v_mov_b32 v216, 0
    v_mov_b32 v217, 0
    v_mov_b32 v218, 0
    v_mov_b32 v219, 0
    v_mov_b32 v220, 0
    v_mov_b32 v221, 0
    v_mov_b32 v222, 0
    v_mov_b32 v223, 0
    v_mov_b32 v224, 0
    v_mov_b32 v225, 0
    v_mov_b32 v226, 0
    v_mov_b32 v227, 0
    v_mov_b32 v228, 0
    v_mov_b32 v229, 0
    v_mov_b32 v230, 0
    v_mov_b32 v231, 0
    v_mov_b32 v232, 0
    v_mov_b32 v233, 0
    v_mov_b32 v234, 0
    v_mov_b32 v235, 0
    v_mov_b32 v236, 0
    v_mov_b32 v237, 0
    v_mov_b32 v238, 0
    v_mov_b32 v239, 0
    v_mov_b32 v240, 0
    v_mov_b32 v241, 0
    v_mov_b32 v242, 0
    v_mov_b32 v243, 0
    v_mov_b32 v244, 0
    v_mov_b32 v245, 0
    v_mov_b32 v246, 0
    v_mov_b32 v247, 0
    v_mov_b32 v248, 0
    v_mov_b32 v249, 0
    v_mov_b32 v250, 0
    v_mov_b32 v251, 0
    v_mov_b32 v252, 0
    v_mov_b32 v253, 0
    v_mov_b32 v254, 0
    v_mov_b32 v255, 0
    s_add_u32 m0, s26, 0
    s_add_u32 s32, s20, 0
    buffer_load_dwordx4 v1, s[40:43], s32 offen lds
    buffer_load_dwordx4 v1, s[40:43], s32 offen offset:1024 lds

    s_add_u32 m0, s27, 0
    s_add_u32 s32, s21, 0
    buffer_load_dwordx4 v1, s[40:43], s32 offen lds
    buffer_load_dwordx4 v1, s[40:43], s32 offen offset:1024 lds

    s_add_u32 m0, s28, 0
    s_add_u32 s32, s22, 0
    buffer_load_dwordx4 v1, s[40:43], s32 offen lds
    buffer_load_dwordx4 v1, s[40:43], s32 offen offset:1024 lds

    s_add_u32 m0, s29, 0
    s_add_u32 s32, s23, 0
    buffer_load_dwordx4 v1, s[40:43], s32 offen lds
    buffer_load_dwordx4 v1, s[40:43], s32 offen offset:1024 lds

    s_add_u32 m0, s30, 0
    s_add_u32 s32, s24, 0
    buffer_load_dwordx4 v1, s[40:43], s32 offen lds
    buffer_load_dwordx4 v1, s[40:43], s32 offen offset:1024 lds

    s_add_u32 m0, s31, 0
    s_add_u32 s32, s25, 0
    buffer_load_dwordx4 v1, s[40:43], s32 offen lds
    buffer_load_dwordx4 v1, s[40:43], s32 offen offset:1024 lds

    s_cmp_ge_u32 s4, 32
    s_cbranch_scc0 L_g1_main_n
    s_cmp_lt_u32 s4, 48
    s_cbranch_scc1 L_g1_main_v

L_g1_main_n:
    s_waitcnt vmcnt(0)
    s_barrier
    s_add_u32 m0, s26, 49152
    s_add_u32 s32, s20, 2048
    buffer_load_dwordx4 v1, s[40:43], s32 offen lds
    buffer_load_dwordx4 v1, s[40:43], s32 offen offset:1024 lds

    s_add_u32 m0, s27, 49152
    s_add_u32 s32, s21, 2048
    buffer_load_dwordx4 v1, s[40:43], s32 offen lds
    buffer_load_dwordx4 v1, s[40:43], s32 offen offset:1024 lds

    s_add_u32 m0, s28, 49152
    s_add_u32 s32, s22, 2048
    buffer_load_dwordx4 v1, s[40:43], s32 offen lds
    buffer_load_dwordx4 v1, s[40:43], s32 offen offset:1024 lds

    s_add_u32 m0, s29, 49152
    s_add_u32 s32, s23, 2048
    buffer_load_dwordx4 v1, s[40:43], s32 offen lds
    buffer_load_dwordx4 v1, s[40:43], s32 offen offset:1024 lds

    s_add_u32 m0, s30, 49152
    s_add_u32 s32, s24, 2048
    buffer_load_dwordx4 v1, s[40:43], s32 offen lds
    buffer_load_dwordx4 v1, s[40:43], s32 offen offset:1024 lds

    s_add_u32 m0, s31, 49152
    s_add_u32 s32, s25, 2048
    buffer_load_dwordx4 v1, s[40:43], s32 offen lds
    buffer_load_dwordx4 v1, s[40:43], s32 offen offset:1024 lds

    ds_read_b128 v[32:35], v3 offset:0
    ds_read_b128 v[36:39], v3 offset:2048
    ds_read_b128 v[40:43], v3 offset:4096
    ds_read_b128 v[44:47], v3 offset:6144
    ds_read_b128 v[48:51], v3 offset:8192
    ds_read_b128 v[52:55], v3 offset:10240
    ds_read_b128 v[56:59], v3 offset:12288
    ds_read_b128 v[60:63], v3 offset:14336
    ds_read_b128 v[64:67], v4 offset:0
    ds_read_b128 v[68:71], v4 offset:2048
    ds_read_b128 v[72:75], v4 offset:4096
    ds_read_b128 v[76:79], v4 offset:6144
    ds_read_b128 v[80:83], v3 offset:1024
    ds_read_b128 v[84:87], v3 offset:3072
    ds_read_b128 v[88:91], v3 offset:5120
    ds_read_b128 v[92:95], v3 offset:7168
    ds_read_b128 v[96:99], v3 offset:9216
    ds_read_b128 v[100:103], v3 offset:11264
    ds_read_b128 v[104:107], v3 offset:13312
    ds_read_b128 v[108:111], v3 offset:15360
    ds_read_b128 v[112:115], v4 offset:1024
    ds_read_b128 v[116:119], v4 offset:3072
    ds_read_b128 v[120:123], v4 offset:5120
    ds_read_b128 v[124:127], v4 offset:7168
    s_waitcnt lgkmcnt(12)
    v_mfma_f32_16x16x32_bf16 v[128:131], v[32:35], v[64:67], v[128:131]
    v_mfma_f32_16x16x32_bf16 v[132:135], v[32:35], v[68:71], v[132:135]
    v_mfma_f32_16x16x32_bf16 v[136:139], v[32:35], v[72:75], v[136:139]
    v_mfma_f32_16x16x32_bf16 v[140:143], v[32:35], v[76:79], v[140:143]
    v_mfma_f32_16x16x32_bf16 v[144:147], v[36:39], v[64:67], v[144:147]
    v_mfma_f32_16x16x32_bf16 v[148:151], v[36:39], v[68:71], v[148:151]
    v_mfma_f32_16x16x32_bf16 v[152:155], v[36:39], v[72:75], v[152:155]
    v_mfma_f32_16x16x32_bf16 v[156:159], v[36:39], v[76:79], v[156:159]
    v_mfma_f32_16x16x32_bf16 v[160:163], v[40:43], v[64:67], v[160:163]
    v_mfma_f32_16x16x32_bf16 v[164:167], v[40:43], v[68:71], v[164:167]
    v_mfma_f32_16x16x32_bf16 v[168:171], v[40:43], v[72:75], v[168:171]
    v_mfma_f32_16x16x32_bf16 v[172:175], v[40:43], v[76:79], v[172:175]
    v_mfma_f32_16x16x32_bf16 v[176:179], v[44:47], v[64:67], v[176:179]
    v_mfma_f32_16x16x32_bf16 v[180:183], v[44:47], v[68:71], v[180:183]
    v_mfma_f32_16x16x32_bf16 v[184:187], v[44:47], v[72:75], v[184:187]
    v_mfma_f32_16x16x32_bf16 v[188:191], v[44:47], v[76:79], v[188:191]
    v_mfma_f32_16x16x32_bf16 v[192:195], v[48:51], v[64:67], v[192:195]
    v_mfma_f32_16x16x32_bf16 v[196:199], v[48:51], v[68:71], v[196:199]
    v_mfma_f32_16x16x32_bf16 v[200:203], v[48:51], v[72:75], v[200:203]
    v_mfma_f32_16x16x32_bf16 v[204:207], v[48:51], v[76:79], v[204:207]
    v_mfma_f32_16x16x32_bf16 v[208:211], v[52:55], v[64:67], v[208:211]
    v_mfma_f32_16x16x32_bf16 v[212:215], v[52:55], v[68:71], v[212:215]
    v_mfma_f32_16x16x32_bf16 v[216:219], v[52:55], v[72:75], v[216:219]
    v_mfma_f32_16x16x32_bf16 v[220:223], v[52:55], v[76:79], v[220:223]
    v_mfma_f32_16x16x32_bf16 v[224:227], v[56:59], v[64:67], v[224:227]
    v_mfma_f32_16x16x32_bf16 v[228:231], v[56:59], v[68:71], v[228:231]
    v_mfma_f32_16x16x32_bf16 v[232:235], v[56:59], v[72:75], v[232:235]
    v_mfma_f32_16x16x32_bf16 v[236:239], v[56:59], v[76:79], v[236:239]
    v_mfma_f32_16x16x32_bf16 v[240:243], v[60:63], v[64:67], v[240:243]
    v_mfma_f32_16x16x32_bf16 v[244:247], v[60:63], v[68:71], v[244:247]
    v_mfma_f32_16x16x32_bf16 v[248:251], v[60:63], v[72:75], v[248:251]
    v_mfma_f32_16x16x32_bf16 v[252:255], v[60:63], v[76:79], v[252:255]
    s_waitcnt lgkmcnt(0)
    v_mfma_f32_16x16x32_bf16 v[128:131], v[80:83], v[112:115], v[128:131]
    v_mfma_f32_16x16x32_bf16 v[132:135], v[80:83], v[116:119], v[132:135]
    v_mfma_f32_16x16x32_bf16 v[136:139], v[80:83], v[120:123], v[136:139]
    v_mfma_f32_16x16x32_bf16 v[140:143], v[80:83], v[124:127], v[140:143]
    v_mfma_f32_16x16x32_bf16 v[144:147], v[84:87], v[112:115], v[144:147]
    v_mfma_f32_16x16x32_bf16 v[148:151], v[84:87], v[116:119], v[148:151]
    v_mfma_f32_16x16x32_bf16 v[152:155], v[84:87], v[120:123], v[152:155]
    v_mfma_f32_16x16x32_bf16 v[156:159], v[84:87], v[124:127], v[156:159]
    v_mfma_f32_16x16x32_bf16 v[160:163], v[88:91], v[112:115], v[160:163]
    v_mfma_f32_16x16x32_bf16 v[164:167], v[88:91], v[116:119], v[164:167]
    v_mfma_f32_16x16x32_bf16 v[168:171], v[88:91], v[120:123], v[168:171]
    v_mfma_f32_16x16x32_bf16 v[172:175], v[88:91], v[124:127], v[172:175]
    v_mfma_f32_16x16x32_bf16 v[176:179], v[92:95], v[112:115], v[176:179]
    v_mfma_f32_16x16x32_bf16 v[180:183], v[92:95], v[116:119], v[180:183]
    v_mfma_f32_16x16x32_bf16 v[184:187], v[92:95], v[120:123], v[184:187]
    v_mfma_f32_16x16x32_bf16 v[188:191], v[92:95], v[124:127], v[188:191]
    v_mfma_f32_16x16x32_bf16 v[192:195], v[96:99], v[112:115], v[192:195]
    v_mfma_f32_16x16x32_bf16 v[196:199], v[96:99], v[116:119], v[196:199]
    v_mfma_f32_16x16x32_bf16 v[200:203], v[96:99], v[120:123], v[200:203]
    v_mfma_f32_16x16x32_bf16 v[204:207], v[96:99], v[124:127], v[204:207]
    v_mfma_f32_16x16x32_bf16 v[208:211], v[100:103], v[112:115], v[208:211]
    v_mfma_f32_16x16x32_bf16 v[212:215], v[100:103], v[116:119], v[212:215]
    v_mfma_f32_16x16x32_bf16 v[216:219], v[100:103], v[120:123], v[216:219]
    v_mfma_f32_16x16x32_bf16 v[220:223], v[100:103], v[124:127], v[220:223]
    v_mfma_f32_16x16x32_bf16 v[224:227], v[104:107], v[112:115], v[224:227]
    v_mfma_f32_16x16x32_bf16 v[228:231], v[104:107], v[116:119], v[228:231]
    v_mfma_f32_16x16x32_bf16 v[232:235], v[104:107], v[120:123], v[232:235]
    v_mfma_f32_16x16x32_bf16 v[236:239], v[104:107], v[124:127], v[236:239]
    v_mfma_f32_16x16x32_bf16 v[240:243], v[108:111], v[112:115], v[240:243]
    v_mfma_f32_16x16x32_bf16 v[244:247], v[108:111], v[116:119], v[244:247]
    v_mfma_f32_16x16x32_bf16 v[248:251], v[108:111], v[120:123], v[248:251]
    v_mfma_f32_16x16x32_bf16 v[252:255], v[108:111], v[124:127], v[252:255]
    s_waitcnt vmcnt(0)
    s_barrier
    s_add_u32 m0, s26, 0
    s_add_u32 s32, s20, 4096
    buffer_load_dwordx4 v1, s[40:43], s32 offen lds
    buffer_load_dwordx4 v1, s[40:43], s32 offen offset:1024 lds

    s_add_u32 m0, s27, 0
    s_add_u32 s32, s21, 4096
    buffer_load_dwordx4 v1, s[40:43], s32 offen lds
    buffer_load_dwordx4 v1, s[40:43], s32 offen offset:1024 lds

    s_add_u32 m0, s28, 0
    s_add_u32 s32, s22, 4096
    buffer_load_dwordx4 v1, s[40:43], s32 offen lds
    buffer_load_dwordx4 v1, s[40:43], s32 offen offset:1024 lds

    s_add_u32 m0, s29, 0
    s_add_u32 s32, s23, 4096
    buffer_load_dwordx4 v1, s[40:43], s32 offen lds
    buffer_load_dwordx4 v1, s[40:43], s32 offen offset:1024 lds

    s_add_u32 m0, s30, 0
    s_add_u32 s32, s24, 4096
    buffer_load_dwordx4 v1, s[40:43], s32 offen lds
    buffer_load_dwordx4 v1, s[40:43], s32 offen offset:1024 lds

    s_add_u32 m0, s31, 0
    s_add_u32 s32, s25, 4096
    buffer_load_dwordx4 v1, s[40:43], s32 offen lds
    buffer_load_dwordx4 v1, s[40:43], s32 offen offset:1024 lds

    ds_read_b128 v[32:35], v3 offset:49152
    ds_read_b128 v[36:39], v3 offset:51200
    ds_read_b128 v[40:43], v3 offset:53248
    ds_read_b128 v[44:47], v3 offset:55296
    ds_read_b128 v[48:51], v3 offset:57344
    ds_read_b128 v[52:55], v3 offset:59392
    ds_read_b128 v[56:59], v3 offset:61440
    ds_read_b128 v[60:63], v3 offset:63488
    ds_read_b128 v[64:67], v4 offset:49152
    ds_read_b128 v[68:71], v4 offset:51200
    ds_read_b128 v[72:75], v4 offset:53248
    ds_read_b128 v[76:79], v4 offset:55296
    ds_read_b128 v[80:83], v3 offset:50176
    ds_read_b128 v[84:87], v3 offset:52224
    ds_read_b128 v[88:91], v3 offset:54272
    ds_read_b128 v[92:95], v3 offset:56320
    ds_read_b128 v[96:99], v3 offset:58368
    ds_read_b128 v[100:103], v3 offset:60416
    ds_read_b128 v[104:107], v3 offset:62464
    ds_read_b128 v[108:111], v3 offset:64512
    ds_read_b128 v[112:115], v4 offset:50176
    ds_read_b128 v[116:119], v4 offset:52224
    ds_read_b128 v[120:123], v4 offset:54272
    ds_read_b128 v[124:127], v4 offset:56320
    s_waitcnt lgkmcnt(12)
    v_mfma_f32_16x16x32_bf16 v[128:131], v[32:35], v[64:67], v[128:131]
    v_mfma_f32_16x16x32_bf16 v[132:135], v[32:35], v[68:71], v[132:135]
    v_mfma_f32_16x16x32_bf16 v[136:139], v[32:35], v[72:75], v[136:139]
    v_mfma_f32_16x16x32_bf16 v[140:143], v[32:35], v[76:79], v[140:143]
    v_mfma_f32_16x16x32_bf16 v[144:147], v[36:39], v[64:67], v[144:147]
    v_mfma_f32_16x16x32_bf16 v[148:151], v[36:39], v[68:71], v[148:151]
    v_mfma_f32_16x16x32_bf16 v[152:155], v[36:39], v[72:75], v[152:155]
    v_mfma_f32_16x16x32_bf16 v[156:159], v[36:39], v[76:79], v[156:159]
    v_mfma_f32_16x16x32_bf16 v[160:163], v[40:43], v[64:67], v[160:163]
    v_mfma_f32_16x16x32_bf16 v[164:167], v[40:43], v[68:71], v[164:167]
    v_mfma_f32_16x16x32_bf16 v[168:171], v[40:43], v[72:75], v[168:171]
    v_mfma_f32_16x16x32_bf16 v[172:175], v[40:43], v[76:79], v[172:175]
    v_mfma_f32_16x16x32_bf16 v[176:179], v[44:47], v[64:67], v[176:179]
    v_mfma_f32_16x16x32_bf16 v[180:183], v[44:47], v[68:71], v[180:183]
    v_mfma_f32_16x16x32_bf16 v[184:187], v[44:47], v[72:75], v[184:187]
    v_mfma_f32_16x16x32_bf16 v[188:191], v[44:47], v[76:79], v[188:191]
    v_mfma_f32_16x16x32_bf16 v[192:195], v[48:51], v[64:67], v[192:195]
    v_mfma_f32_16x16x32_bf16 v[196:199], v[48:51], v[68:71], v[196:199]
    v_mfma_f32_16x16x32_bf16 v[200:203], v[48:51], v[72:75], v[200:203]
    v_mfma_f32_16x16x32_bf16 v[204:207], v[48:51], v[76:79], v[204:207]
    v_mfma_f32_16x16x32_bf16 v[208:211], v[52:55], v[64:67], v[208:211]
    v_mfma_f32_16x16x32_bf16 v[212:215], v[52:55], v[68:71], v[212:215]
    v_mfma_f32_16x16x32_bf16 v[216:219], v[52:55], v[72:75], v[216:219]
    v_mfma_f32_16x16x32_bf16 v[220:223], v[52:55], v[76:79], v[220:223]
    v_mfma_f32_16x16x32_bf16 v[224:227], v[56:59], v[64:67], v[224:227]
    v_mfma_f32_16x16x32_bf16 v[228:231], v[56:59], v[68:71], v[228:231]
    v_mfma_f32_16x16x32_bf16 v[232:235], v[56:59], v[72:75], v[232:235]
    v_mfma_f32_16x16x32_bf16 v[236:239], v[56:59], v[76:79], v[236:239]
    v_mfma_f32_16x16x32_bf16 v[240:243], v[60:63], v[64:67], v[240:243]
    v_mfma_f32_16x16x32_bf16 v[244:247], v[60:63], v[68:71], v[244:247]
    v_mfma_f32_16x16x32_bf16 v[248:251], v[60:63], v[72:75], v[248:251]
    v_mfma_f32_16x16x32_bf16 v[252:255], v[60:63], v[76:79], v[252:255]
    s_waitcnt lgkmcnt(0)
    v_mfma_f32_16x16x32_bf16 v[128:131], v[80:83], v[112:115], v[128:131]
    v_mfma_f32_16x16x32_bf16 v[132:135], v[80:83], v[116:119], v[132:135]
    v_mfma_f32_16x16x32_bf16 v[136:139], v[80:83], v[120:123], v[136:139]
    v_mfma_f32_16x16x32_bf16 v[140:143], v[80:83], v[124:127], v[140:143]
    v_mfma_f32_16x16x32_bf16 v[144:147], v[84:87], v[112:115], v[144:147]
    v_mfma_f32_16x16x32_bf16 v[148:151], v[84:87], v[116:119], v[148:151]
    v_mfma_f32_16x16x32_bf16 v[152:155], v[84:87], v[120:123], v[152:155]
    v_mfma_f32_16x16x32_bf16 v[156:159], v[84:87], v[124:127], v[156:159]
    v_mfma_f32_16x16x32_bf16 v[160:163], v[88:91], v[112:115], v[160:163]
    v_mfma_f32_16x16x32_bf16 v[164:167], v[88:91], v[116:119], v[164:167]
    v_mfma_f32_16x16x32_bf16 v[168:171], v[88:91], v[120:123], v[168:171]
    v_mfma_f32_16x16x32_bf16 v[172:175], v[88:91], v[124:127], v[172:175]
    v_mfma_f32_16x16x32_bf16 v[176:179], v[92:95], v[112:115], v[176:179]
    v_mfma_f32_16x16x32_bf16 v[180:183], v[92:95], v[116:119], v[180:183]
    v_mfma_f32_16x16x32_bf16 v[184:187], v[92:95], v[120:123], v[184:187]
    v_mfma_f32_16x16x32_bf16 v[188:191], v[92:95], v[124:127], v[188:191]
    v_mfma_f32_16x16x32_bf16 v[192:195], v[96:99], v[112:115], v[192:195]
    v_mfma_f32_16x16x32_bf16 v[196:199], v[96:99], v[116:119], v[196:199]
    v_mfma_f32_16x16x32_bf16 v[200:203], v[96:99], v[120:123], v[200:203]
    v_mfma_f32_16x16x32_bf16 v[204:207], v[96:99], v[124:127], v[204:207]
    v_mfma_f32_16x16x32_bf16 v[208:211], v[100:103], v[112:115], v[208:211]
    v_mfma_f32_16x16x32_bf16 v[212:215], v[100:103], v[116:119], v[212:215]
    v_mfma_f32_16x16x32_bf16 v[216:219], v[100:103], v[120:123], v[216:219]
    v_mfma_f32_16x16x32_bf16 v[220:223], v[100:103], v[124:127], v[220:223]
    v_mfma_f32_16x16x32_bf16 v[224:227], v[104:107], v[112:115], v[224:227]
    v_mfma_f32_16x16x32_bf16 v[228:231], v[104:107], v[116:119], v[228:231]
    v_mfma_f32_16x16x32_bf16 v[232:235], v[104:107], v[120:123], v[232:235]
    v_mfma_f32_16x16x32_bf16 v[236:239], v[104:107], v[124:127], v[236:239]
    v_mfma_f32_16x16x32_bf16 v[240:243], v[108:111], v[112:115], v[240:243]
    v_mfma_f32_16x16x32_bf16 v[244:247], v[108:111], v[116:119], v[244:247]
    v_mfma_f32_16x16x32_bf16 v[248:251], v[108:111], v[120:123], v[248:251]
    v_mfma_f32_16x16x32_bf16 v[252:255], v[108:111], v[124:127], v[252:255]
    s_waitcnt vmcnt(0)
    s_barrier
    s_add_u32 m0, s26, 49152
    s_add_u32 s32, s20, 6144
    buffer_load_dwordx4 v1, s[40:43], s32 offen lds
    buffer_load_dwordx4 v1, s[40:43], s32 offen offset:1024 lds

    s_add_u32 m0, s27, 49152
    s_add_u32 s32, s21, 6144
    buffer_load_dwordx4 v1, s[40:43], s32 offen lds
    buffer_load_dwordx4 v1, s[40:43], s32 offen offset:1024 lds

    s_add_u32 m0, s28, 49152
    s_add_u32 s32, s22, 6144
    buffer_load_dwordx4 v1, s[40:43], s32 offen lds
    buffer_load_dwordx4 v1, s[40:43], s32 offen offset:1024 lds

    s_add_u32 m0, s29, 49152
    s_add_u32 s32, s23, 6144
    buffer_load_dwordx4 v1, s[40:43], s32 offen lds
    buffer_load_dwordx4 v1, s[40:43], s32 offen offset:1024 lds

    s_add_u32 m0, s30, 49152
    s_add_u32 s32, s24, 6144
    buffer_load_dwordx4 v1, s[40:43], s32 offen lds
    buffer_load_dwordx4 v1, s[40:43], s32 offen offset:1024 lds

    s_add_u32 m0, s31, 49152
    s_add_u32 s32, s25, 6144
    buffer_load_dwordx4 v1, s[40:43], s32 offen lds
    buffer_load_dwordx4 v1, s[40:43], s32 offen offset:1024 lds

    ds_read_b128 v[32:35], v3 offset:0
    ds_read_b128 v[36:39], v3 offset:2048
    ds_read_b128 v[40:43], v3 offset:4096
    ds_read_b128 v[44:47], v3 offset:6144
    ds_read_b128 v[48:51], v3 offset:8192
    ds_read_b128 v[52:55], v3 offset:10240
    ds_read_b128 v[56:59], v3 offset:12288
    ds_read_b128 v[60:63], v3 offset:14336
    ds_read_b128 v[64:67], v4 offset:0
    ds_read_b128 v[68:71], v4 offset:2048
    ds_read_b128 v[72:75], v4 offset:4096
    ds_read_b128 v[76:79], v4 offset:6144
    ds_read_b128 v[80:83], v3 offset:1024
    ds_read_b128 v[84:87], v3 offset:3072
    ds_read_b128 v[88:91], v3 offset:5120
    ds_read_b128 v[92:95], v3 offset:7168
    ds_read_b128 v[96:99], v3 offset:9216
    ds_read_b128 v[100:103], v3 offset:11264
    ds_read_b128 v[104:107], v3 offset:13312
    ds_read_b128 v[108:111], v3 offset:15360
    ds_read_b128 v[112:115], v4 offset:1024
    ds_read_b128 v[116:119], v4 offset:3072
    ds_read_b128 v[120:123], v4 offset:5120
    ds_read_b128 v[124:127], v4 offset:7168
    s_waitcnt lgkmcnt(12)
    v_mfma_f32_16x16x32_bf16 v[128:131], v[32:35], v[64:67], v[128:131]
    v_mfma_f32_16x16x32_bf16 v[132:135], v[32:35], v[68:71], v[132:135]
    v_mfma_f32_16x16x32_bf16 v[136:139], v[32:35], v[72:75], v[136:139]
    v_mfma_f32_16x16x32_bf16 v[140:143], v[32:35], v[76:79], v[140:143]
    v_mfma_f32_16x16x32_bf16 v[144:147], v[36:39], v[64:67], v[144:147]
    v_mfma_f32_16x16x32_bf16 v[148:151], v[36:39], v[68:71], v[148:151]
    v_mfma_f32_16x16x32_bf16 v[152:155], v[36:39], v[72:75], v[152:155]
    v_mfma_f32_16x16x32_bf16 v[156:159], v[36:39], v[76:79], v[156:159]
    v_mfma_f32_16x16x32_bf16 v[160:163], v[40:43], v[64:67], v[160:163]
    v_mfma_f32_16x16x32_bf16 v[164:167], v[40:43], v[68:71], v[164:167]
    v_mfma_f32_16x16x32_bf16 v[168:171], v[40:43], v[72:75], v[168:171]
    v_mfma_f32_16x16x32_bf16 v[172:175], v[40:43], v[76:79], v[172:175]
    v_mfma_f32_16x16x32_bf16 v[176:179], v[44:47], v[64:67], v[176:179]
    v_mfma_f32_16x16x32_bf16 v[180:183], v[44:47], v[68:71], v[180:183]
    v_mfma_f32_16x16x32_bf16 v[184:187], v[44:47], v[72:75], v[184:187]
    v_mfma_f32_16x16x32_bf16 v[188:191], v[44:47], v[76:79], v[188:191]
    v_mfma_f32_16x16x32_bf16 v[192:195], v[48:51], v[64:67], v[192:195]
    v_mfma_f32_16x16x32_bf16 v[196:199], v[48:51], v[68:71], v[196:199]
    v_mfma_f32_16x16x32_bf16 v[200:203], v[48:51], v[72:75], v[200:203]
    v_mfma_f32_16x16x32_bf16 v[204:207], v[48:51], v[76:79], v[204:207]
    v_mfma_f32_16x16x32_bf16 v[208:211], v[52:55], v[64:67], v[208:211]
    v_mfma_f32_16x16x32_bf16 v[212:215], v[52:55], v[68:71], v[212:215]
    v_mfma_f32_16x16x32_bf16 v[216:219], v[52:55], v[72:75], v[216:219]
    v_mfma_f32_16x16x32_bf16 v[220:223], v[52:55], v[76:79], v[220:223]
    v_mfma_f32_16x16x32_bf16 v[224:227], v[56:59], v[64:67], v[224:227]
    v_mfma_f32_16x16x32_bf16 v[228:231], v[56:59], v[68:71], v[228:231]
    v_mfma_f32_16x16x32_bf16 v[232:235], v[56:59], v[72:75], v[232:235]
    v_mfma_f32_16x16x32_bf16 v[236:239], v[56:59], v[76:79], v[236:239]
    v_mfma_f32_16x16x32_bf16 v[240:243], v[60:63], v[64:67], v[240:243]
    v_mfma_f32_16x16x32_bf16 v[244:247], v[60:63], v[68:71], v[244:247]
    v_mfma_f32_16x16x32_bf16 v[248:251], v[60:63], v[72:75], v[248:251]
    v_mfma_f32_16x16x32_bf16 v[252:255], v[60:63], v[76:79], v[252:255]
    s_waitcnt lgkmcnt(0)
    v_mfma_f32_16x16x32_bf16 v[128:131], v[80:83], v[112:115], v[128:131]
    v_mfma_f32_16x16x32_bf16 v[132:135], v[80:83], v[116:119], v[132:135]
    v_mfma_f32_16x16x32_bf16 v[136:139], v[80:83], v[120:123], v[136:139]
    v_mfma_f32_16x16x32_bf16 v[140:143], v[80:83], v[124:127], v[140:143]
    v_mfma_f32_16x16x32_bf16 v[144:147], v[84:87], v[112:115], v[144:147]
    v_mfma_f32_16x16x32_bf16 v[148:151], v[84:87], v[116:119], v[148:151]
    v_mfma_f32_16x16x32_bf16 v[152:155], v[84:87], v[120:123], v[152:155]
    v_mfma_f32_16x16x32_bf16 v[156:159], v[84:87], v[124:127], v[156:159]
    v_mfma_f32_16x16x32_bf16 v[160:163], v[88:91], v[112:115], v[160:163]
    v_mfma_f32_16x16x32_bf16 v[164:167], v[88:91], v[116:119], v[164:167]
    v_mfma_f32_16x16x32_bf16 v[168:171], v[88:91], v[120:123], v[168:171]
    v_mfma_f32_16x16x32_bf16 v[172:175], v[88:91], v[124:127], v[172:175]
    v_mfma_f32_16x16x32_bf16 v[176:179], v[92:95], v[112:115], v[176:179]
    v_mfma_f32_16x16x32_bf16 v[180:183], v[92:95], v[116:119], v[180:183]
    v_mfma_f32_16x16x32_bf16 v[184:187], v[92:95], v[120:123], v[184:187]
    v_mfma_f32_16x16x32_bf16 v[188:191], v[92:95], v[124:127], v[188:191]
    v_mfma_f32_16x16x32_bf16 v[192:195], v[96:99], v[112:115], v[192:195]
    v_mfma_f32_16x16x32_bf16 v[196:199], v[96:99], v[116:119], v[196:199]
    v_mfma_f32_16x16x32_bf16 v[200:203], v[96:99], v[120:123], v[200:203]
    v_mfma_f32_16x16x32_bf16 v[204:207], v[96:99], v[124:127], v[204:207]
    v_mfma_f32_16x16x32_bf16 v[208:211], v[100:103], v[112:115], v[208:211]
    v_mfma_f32_16x16x32_bf16 v[212:215], v[100:103], v[116:119], v[212:215]
    v_mfma_f32_16x16x32_bf16 v[216:219], v[100:103], v[120:123], v[216:219]
    v_mfma_f32_16x16x32_bf16 v[220:223], v[100:103], v[124:127], v[220:223]
    v_mfma_f32_16x16x32_bf16 v[224:227], v[104:107], v[112:115], v[224:227]
    v_mfma_f32_16x16x32_bf16 v[228:231], v[104:107], v[116:119], v[228:231]
    v_mfma_f32_16x16x32_bf16 v[232:235], v[104:107], v[120:123], v[232:235]
    v_mfma_f32_16x16x32_bf16 v[236:239], v[104:107], v[124:127], v[236:239]
    v_mfma_f32_16x16x32_bf16 v[240:243], v[108:111], v[112:115], v[240:243]
    v_mfma_f32_16x16x32_bf16 v[244:247], v[108:111], v[116:119], v[244:247]
    v_mfma_f32_16x16x32_bf16 v[248:251], v[108:111], v[120:123], v[248:251]
    v_mfma_f32_16x16x32_bf16 v[252:255], v[108:111], v[124:127], v[252:255]
    s_waitcnt vmcnt(0)
    s_barrier
    s_add_u32 m0, s26, 0
    s_add_u32 s32, s20, 8192
    buffer_load_dwordx4 v1, s[40:43], s32 offen lds
    buffer_load_dwordx4 v1, s[40:43], s32 offen offset:1024 lds

    s_add_u32 m0, s27, 0
    s_add_u32 s32, s21, 8192
    buffer_load_dwordx4 v1, s[40:43], s32 offen lds
    buffer_load_dwordx4 v1, s[40:43], s32 offen offset:1024 lds

    s_add_u32 m0, s28, 0
    s_add_u32 s32, s22, 8192
    buffer_load_dwordx4 v1, s[40:43], s32 offen lds
    buffer_load_dwordx4 v1, s[40:43], s32 offen offset:1024 lds

    s_add_u32 m0, s29, 0
    s_add_u32 s32, s23, 8192
    buffer_load_dwordx4 v1, s[40:43], s32 offen lds
    buffer_load_dwordx4 v1, s[40:43], s32 offen offset:1024 lds

    s_add_u32 m0, s30, 0
    s_add_u32 s32, s24, 8192
    buffer_load_dwordx4 v1, s[40:43], s32 offen lds
    buffer_load_dwordx4 v1, s[40:43], s32 offen offset:1024 lds

    s_add_u32 m0, s31, 0
    s_add_u32 s32, s25, 8192
    buffer_load_dwordx4 v1, s[40:43], s32 offen lds
    buffer_load_dwordx4 v1, s[40:43], s32 offen offset:1024 lds

    ds_read_b128 v[32:35], v3 offset:49152
    ds_read_b128 v[36:39], v3 offset:51200
    ds_read_b128 v[40:43], v3 offset:53248
    ds_read_b128 v[44:47], v3 offset:55296
    ds_read_b128 v[48:51], v3 offset:57344
    ds_read_b128 v[52:55], v3 offset:59392
    ds_read_b128 v[56:59], v3 offset:61440
    ds_read_b128 v[60:63], v3 offset:63488
    ds_read_b128 v[64:67], v4 offset:49152
    ds_read_b128 v[68:71], v4 offset:51200
    ds_read_b128 v[72:75], v4 offset:53248
    ds_read_b128 v[76:79], v4 offset:55296
    ds_read_b128 v[80:83], v3 offset:50176
    ds_read_b128 v[84:87], v3 offset:52224
    ds_read_b128 v[88:91], v3 offset:54272
    ds_read_b128 v[92:95], v3 offset:56320
    ds_read_b128 v[96:99], v3 offset:58368
    ds_read_b128 v[100:103], v3 offset:60416
    ds_read_b128 v[104:107], v3 offset:62464
    ds_read_b128 v[108:111], v3 offset:64512
    ds_read_b128 v[112:115], v4 offset:50176
    ds_read_b128 v[116:119], v4 offset:52224
    ds_read_b128 v[120:123], v4 offset:54272
    ds_read_b128 v[124:127], v4 offset:56320
    s_waitcnt lgkmcnt(12)
    v_mfma_f32_16x16x32_bf16 v[128:131], v[32:35], v[64:67], v[128:131]
    v_mfma_f32_16x16x32_bf16 v[132:135], v[32:35], v[68:71], v[132:135]
    v_mfma_f32_16x16x32_bf16 v[136:139], v[32:35], v[72:75], v[136:139]
    v_mfma_f32_16x16x32_bf16 v[140:143], v[32:35], v[76:79], v[140:143]
    v_mfma_f32_16x16x32_bf16 v[144:147], v[36:39], v[64:67], v[144:147]
    v_mfma_f32_16x16x32_bf16 v[148:151], v[36:39], v[68:71], v[148:151]
    v_mfma_f32_16x16x32_bf16 v[152:155], v[36:39], v[72:75], v[152:155]
    v_mfma_f32_16x16x32_bf16 v[156:159], v[36:39], v[76:79], v[156:159]
    v_mfma_f32_16x16x32_bf16 v[160:163], v[40:43], v[64:67], v[160:163]
    v_mfma_f32_16x16x32_bf16 v[164:167], v[40:43], v[68:71], v[164:167]
    v_mfma_f32_16x16x32_bf16 v[168:171], v[40:43], v[72:75], v[168:171]
    v_mfma_f32_16x16x32_bf16 v[172:175], v[40:43], v[76:79], v[172:175]
    v_mfma_f32_16x16x32_bf16 v[176:179], v[44:47], v[64:67], v[176:179]
    v_mfma_f32_16x16x32_bf16 v[180:183], v[44:47], v[68:71], v[180:183]
    v_mfma_f32_16x16x32_bf16 v[184:187], v[44:47], v[72:75], v[184:187]
    v_mfma_f32_16x16x32_bf16 v[188:191], v[44:47], v[76:79], v[188:191]
    v_mfma_f32_16x16x32_bf16 v[192:195], v[48:51], v[64:67], v[192:195]
    v_mfma_f32_16x16x32_bf16 v[196:199], v[48:51], v[68:71], v[196:199]
    v_mfma_f32_16x16x32_bf16 v[200:203], v[48:51], v[72:75], v[200:203]
    v_mfma_f32_16x16x32_bf16 v[204:207], v[48:51], v[76:79], v[204:207]
    v_mfma_f32_16x16x32_bf16 v[208:211], v[52:55], v[64:67], v[208:211]
    v_mfma_f32_16x16x32_bf16 v[212:215], v[52:55], v[68:71], v[212:215]
    v_mfma_f32_16x16x32_bf16 v[216:219], v[52:55], v[72:75], v[216:219]
    v_mfma_f32_16x16x32_bf16 v[220:223], v[52:55], v[76:79], v[220:223]
    v_mfma_f32_16x16x32_bf16 v[224:227], v[56:59], v[64:67], v[224:227]
    v_mfma_f32_16x16x32_bf16 v[228:231], v[56:59], v[68:71], v[228:231]
    v_mfma_f32_16x16x32_bf16 v[232:235], v[56:59], v[72:75], v[232:235]
    v_mfma_f32_16x16x32_bf16 v[236:239], v[56:59], v[76:79], v[236:239]
    v_mfma_f32_16x16x32_bf16 v[240:243], v[60:63], v[64:67], v[240:243]
    v_mfma_f32_16x16x32_bf16 v[244:247], v[60:63], v[68:71], v[244:247]
    v_mfma_f32_16x16x32_bf16 v[248:251], v[60:63], v[72:75], v[248:251]
    v_mfma_f32_16x16x32_bf16 v[252:255], v[60:63], v[76:79], v[252:255]
    s_waitcnt lgkmcnt(0)
    v_mfma_f32_16x16x32_bf16 v[128:131], v[80:83], v[112:115], v[128:131]
    v_mfma_f32_16x16x32_bf16 v[132:135], v[80:83], v[116:119], v[132:135]
    v_mfma_f32_16x16x32_bf16 v[136:139], v[80:83], v[120:123], v[136:139]
    v_mfma_f32_16x16x32_bf16 v[140:143], v[80:83], v[124:127], v[140:143]
    v_mfma_f32_16x16x32_bf16 v[144:147], v[84:87], v[112:115], v[144:147]
    v_mfma_f32_16x16x32_bf16 v[148:151], v[84:87], v[116:119], v[148:151]
    v_mfma_f32_16x16x32_bf16 v[152:155], v[84:87], v[120:123], v[152:155]
    v_mfma_f32_16x16x32_bf16 v[156:159], v[84:87], v[124:127], v[156:159]
    v_mfma_f32_16x16x32_bf16 v[160:163], v[88:91], v[112:115], v[160:163]
    v_mfma_f32_16x16x32_bf16 v[164:167], v[88:91], v[116:119], v[164:167]
    v_mfma_f32_16x16x32_bf16 v[168:171], v[88:91], v[120:123], v[168:171]
    v_mfma_f32_16x16x32_bf16 v[172:175], v[88:91], v[124:127], v[172:175]
    v_mfma_f32_16x16x32_bf16 v[176:179], v[92:95], v[112:115], v[176:179]
    v_mfma_f32_16x16x32_bf16 v[180:183], v[92:95], v[116:119], v[180:183]
    v_mfma_f32_16x16x32_bf16 v[184:187], v[92:95], v[120:123], v[184:187]
    v_mfma_f32_16x16x32_bf16 v[188:191], v[92:95], v[124:127], v[188:191]
    v_mfma_f32_16x16x32_bf16 v[192:195], v[96:99], v[112:115], v[192:195]
    v_mfma_f32_16x16x32_bf16 v[196:199], v[96:99], v[116:119], v[196:199]
    v_mfma_f32_16x16x32_bf16 v[200:203], v[96:99], v[120:123], v[200:203]
    v_mfma_f32_16x16x32_bf16 v[204:207], v[96:99], v[124:127], v[204:207]
    v_mfma_f32_16x16x32_bf16 v[208:211], v[100:103], v[112:115], v[208:211]
    v_mfma_f32_16x16x32_bf16 v[212:215], v[100:103], v[116:119], v[212:215]
    v_mfma_f32_16x16x32_bf16 v[216:219], v[100:103], v[120:123], v[216:219]
    v_mfma_f32_16x16x32_bf16 v[220:223], v[100:103], v[124:127], v[220:223]
    v_mfma_f32_16x16x32_bf16 v[224:227], v[104:107], v[112:115], v[224:227]
    v_mfma_f32_16x16x32_bf16 v[228:231], v[104:107], v[116:119], v[228:231]
    v_mfma_f32_16x16x32_bf16 v[232:235], v[104:107], v[120:123], v[232:235]
    v_mfma_f32_16x16x32_bf16 v[236:239], v[104:107], v[124:127], v[236:239]
    v_mfma_f32_16x16x32_bf16 v[240:243], v[108:111], v[112:115], v[240:243]
    v_mfma_f32_16x16x32_bf16 v[244:247], v[108:111], v[116:119], v[244:247]
    v_mfma_f32_16x16x32_bf16 v[248:251], v[108:111], v[120:123], v[248:251]
    v_mfma_f32_16x16x32_bf16 v[252:255], v[108:111], v[124:127], v[252:255]
    s_waitcnt vmcnt(0)
    s_barrier
    s_add_u32 m0, s26, 49152
    s_add_u32 s32, s20, 10240
    buffer_load_dwordx4 v1, s[40:43], s32 offen lds
    buffer_load_dwordx4 v1, s[40:43], s32 offen offset:1024 lds

    s_add_u32 m0, s27, 49152
    s_add_u32 s32, s21, 10240
    buffer_load_dwordx4 v1, s[40:43], s32 offen lds
    buffer_load_dwordx4 v1, s[40:43], s32 offen offset:1024 lds

    s_add_u32 m0, s28, 49152
    s_add_u32 s32, s22, 10240
    buffer_load_dwordx4 v1, s[40:43], s32 offen lds
    buffer_load_dwordx4 v1, s[40:43], s32 offen offset:1024 lds

    s_add_u32 m0, s29, 49152
    s_add_u32 s32, s23, 10240
    buffer_load_dwordx4 v1, s[40:43], s32 offen lds
    buffer_load_dwordx4 v1, s[40:43], s32 offen offset:1024 lds

    s_add_u32 m0, s30, 49152
    s_add_u32 s32, s24, 10240
    buffer_load_dwordx4 v1, s[40:43], s32 offen lds
    buffer_load_dwordx4 v1, s[40:43], s32 offen offset:1024 lds

    s_add_u32 m0, s31, 49152
    s_add_u32 s32, s25, 10240
    buffer_load_dwordx4 v1, s[40:43], s32 offen lds
    buffer_load_dwordx4 v1, s[40:43], s32 offen offset:1024 lds

    ds_read_b128 v[32:35], v3 offset:0
    ds_read_b128 v[36:39], v3 offset:2048
    ds_read_b128 v[40:43], v3 offset:4096
    ds_read_b128 v[44:47], v3 offset:6144
    ds_read_b128 v[48:51], v3 offset:8192
    ds_read_b128 v[52:55], v3 offset:10240
    ds_read_b128 v[56:59], v3 offset:12288
    ds_read_b128 v[60:63], v3 offset:14336
    ds_read_b128 v[64:67], v4 offset:0
    ds_read_b128 v[68:71], v4 offset:2048
    ds_read_b128 v[72:75], v4 offset:4096
    ds_read_b128 v[76:79], v4 offset:6144
    ds_read_b128 v[80:83], v3 offset:1024
    ds_read_b128 v[84:87], v3 offset:3072
    ds_read_b128 v[88:91], v3 offset:5120
    ds_read_b128 v[92:95], v3 offset:7168
    ds_read_b128 v[96:99], v3 offset:9216
    ds_read_b128 v[100:103], v3 offset:11264
    ds_read_b128 v[104:107], v3 offset:13312
    ds_read_b128 v[108:111], v3 offset:15360
    ds_read_b128 v[112:115], v4 offset:1024
    ds_read_b128 v[116:119], v4 offset:3072
    ds_read_b128 v[120:123], v4 offset:5120
    ds_read_b128 v[124:127], v4 offset:7168
    s_waitcnt lgkmcnt(12)
    v_mfma_f32_16x16x32_bf16 v[128:131], v[32:35], v[64:67], v[128:131]
    v_mfma_f32_16x16x32_bf16 v[132:135], v[32:35], v[68:71], v[132:135]
    v_mfma_f32_16x16x32_bf16 v[136:139], v[32:35], v[72:75], v[136:139]
    v_mfma_f32_16x16x32_bf16 v[140:143], v[32:35], v[76:79], v[140:143]
    v_mfma_f32_16x16x32_bf16 v[144:147], v[36:39], v[64:67], v[144:147]
    v_mfma_f32_16x16x32_bf16 v[148:151], v[36:39], v[68:71], v[148:151]
    v_mfma_f32_16x16x32_bf16 v[152:155], v[36:39], v[72:75], v[152:155]
    v_mfma_f32_16x16x32_bf16 v[156:159], v[36:39], v[76:79], v[156:159]
    v_mfma_f32_16x16x32_bf16 v[160:163], v[40:43], v[64:67], v[160:163]
    v_mfma_f32_16x16x32_bf16 v[164:167], v[40:43], v[68:71], v[164:167]
    v_mfma_f32_16x16x32_bf16 v[168:171], v[40:43], v[72:75], v[168:171]
    v_mfma_f32_16x16x32_bf16 v[172:175], v[40:43], v[76:79], v[172:175]
    v_mfma_f32_16x16x32_bf16 v[176:179], v[44:47], v[64:67], v[176:179]
    v_mfma_f32_16x16x32_bf16 v[180:183], v[44:47], v[68:71], v[180:183]
    v_mfma_f32_16x16x32_bf16 v[184:187], v[44:47], v[72:75], v[184:187]
    v_mfma_f32_16x16x32_bf16 v[188:191], v[44:47], v[76:79], v[188:191]
    v_mfma_f32_16x16x32_bf16 v[192:195], v[48:51], v[64:67], v[192:195]
    v_mfma_f32_16x16x32_bf16 v[196:199], v[48:51], v[68:71], v[196:199]
    v_mfma_f32_16x16x32_bf16 v[200:203], v[48:51], v[72:75], v[200:203]
    v_mfma_f32_16x16x32_bf16 v[204:207], v[48:51], v[76:79], v[204:207]
    v_mfma_f32_16x16x32_bf16 v[208:211], v[52:55], v[64:67], v[208:211]
    v_mfma_f32_16x16x32_bf16 v[212:215], v[52:55], v[68:71], v[212:215]
    v_mfma_f32_16x16x32_bf16 v[216:219], v[52:55], v[72:75], v[216:219]
    v_mfma_f32_16x16x32_bf16 v[220:223], v[52:55], v[76:79], v[220:223]
    v_mfma_f32_16x16x32_bf16 v[224:227], v[56:59], v[64:67], v[224:227]
    v_mfma_f32_16x16x32_bf16 v[228:231], v[56:59], v[68:71], v[228:231]
    v_mfma_f32_16x16x32_bf16 v[232:235], v[56:59], v[72:75], v[232:235]
    v_mfma_f32_16x16x32_bf16 v[236:239], v[56:59], v[76:79], v[236:239]
    v_mfma_f32_16x16x32_bf16 v[240:243], v[60:63], v[64:67], v[240:243]
    v_mfma_f32_16x16x32_bf16 v[244:247], v[60:63], v[68:71], v[244:247]
    v_mfma_f32_16x16x32_bf16 v[248:251], v[60:63], v[72:75], v[248:251]
    v_mfma_f32_16x16x32_bf16 v[252:255], v[60:63], v[76:79], v[252:255]
    s_waitcnt lgkmcnt(0)
    v_mfma_f32_16x16x32_bf16 v[128:131], v[80:83], v[112:115], v[128:131]
    v_mfma_f32_16x16x32_bf16 v[132:135], v[80:83], v[116:119], v[132:135]
    v_mfma_f32_16x16x32_bf16 v[136:139], v[80:83], v[120:123], v[136:139]
    v_mfma_f32_16x16x32_bf16 v[140:143], v[80:83], v[124:127], v[140:143]
    v_mfma_f32_16x16x32_bf16 v[144:147], v[84:87], v[112:115], v[144:147]
    v_mfma_f32_16x16x32_bf16 v[148:151], v[84:87], v[116:119], v[148:151]
    v_mfma_f32_16x16x32_bf16 v[152:155], v[84:87], v[120:123], v[152:155]
    v_mfma_f32_16x16x32_bf16 v[156:159], v[84:87], v[124:127], v[156:159]
    v_mfma_f32_16x16x32_bf16 v[160:163], v[88:91], v[112:115], v[160:163]
    v_mfma_f32_16x16x32_bf16 v[164:167], v[88:91], v[116:119], v[164:167]
    v_mfma_f32_16x16x32_bf16 v[168:171], v[88:91], v[120:123], v[168:171]
    v_mfma_f32_16x16x32_bf16 v[172:175], v[88:91], v[124:127], v[172:175]
    v_mfma_f32_16x16x32_bf16 v[176:179], v[92:95], v[112:115], v[176:179]
    v_mfma_f32_16x16x32_bf16 v[180:183], v[92:95], v[116:119], v[180:183]
    v_mfma_f32_16x16x32_bf16 v[184:187], v[92:95], v[120:123], v[184:187]
    v_mfma_f32_16x16x32_bf16 v[188:191], v[92:95], v[124:127], v[188:191]
    v_mfma_f32_16x16x32_bf16 v[192:195], v[96:99], v[112:115], v[192:195]
    v_mfma_f32_16x16x32_bf16 v[196:199], v[96:99], v[116:119], v[196:199]
    v_mfma_f32_16x16x32_bf16 v[200:203], v[96:99], v[120:123], v[200:203]
    v_mfma_f32_16x16x32_bf16 v[204:207], v[96:99], v[124:127], v[204:207]
    v_mfma_f32_16x16x32_bf16 v[208:211], v[100:103], v[112:115], v[208:211]
    v_mfma_f32_16x16x32_bf16 v[212:215], v[100:103], v[116:119], v[212:215]
    v_mfma_f32_16x16x32_bf16 v[216:219], v[100:103], v[120:123], v[216:219]
    v_mfma_f32_16x16x32_bf16 v[220:223], v[100:103], v[124:127], v[220:223]
    v_mfma_f32_16x16x32_bf16 v[224:227], v[104:107], v[112:115], v[224:227]
    v_mfma_f32_16x16x32_bf16 v[228:231], v[104:107], v[116:119], v[228:231]
    v_mfma_f32_16x16x32_bf16 v[232:235], v[104:107], v[120:123], v[232:235]
    v_mfma_f32_16x16x32_bf16 v[236:239], v[104:107], v[124:127], v[236:239]
    v_mfma_f32_16x16x32_bf16 v[240:243], v[108:111], v[112:115], v[240:243]
    v_mfma_f32_16x16x32_bf16 v[244:247], v[108:111], v[116:119], v[244:247]
    v_mfma_f32_16x16x32_bf16 v[248:251], v[108:111], v[120:123], v[248:251]
    v_mfma_f32_16x16x32_bf16 v[252:255], v[108:111], v[124:127], v[252:255]
    s_waitcnt vmcnt(0)
    s_barrier
    s_add_u32 m0, s26, 0
    s_add_u32 s32, s20, 12288
    buffer_load_dwordx4 v1, s[40:43], s32 offen lds
    buffer_load_dwordx4 v1, s[40:43], s32 offen offset:1024 lds

    s_add_u32 m0, s27, 0
    s_add_u32 s32, s21, 12288
    buffer_load_dwordx4 v1, s[40:43], s32 offen lds
    buffer_load_dwordx4 v1, s[40:43], s32 offen offset:1024 lds

    s_add_u32 m0, s28, 0
    s_add_u32 s32, s22, 12288
    buffer_load_dwordx4 v1, s[40:43], s32 offen lds
    buffer_load_dwordx4 v1, s[40:43], s32 offen offset:1024 lds

    s_add_u32 m0, s29, 0
    s_add_u32 s32, s23, 12288
    buffer_load_dwordx4 v1, s[40:43], s32 offen lds
    buffer_load_dwordx4 v1, s[40:43], s32 offen offset:1024 lds

    s_add_u32 m0, s30, 0
    s_add_u32 s32, s24, 12288
    buffer_load_dwordx4 v1, s[40:43], s32 offen lds
    buffer_load_dwordx4 v1, s[40:43], s32 offen offset:1024 lds

    s_add_u32 m0, s31, 0
    s_add_u32 s32, s25, 12288
    buffer_load_dwordx4 v1, s[40:43], s32 offen lds
    buffer_load_dwordx4 v1, s[40:43], s32 offen offset:1024 lds

    ds_read_b128 v[32:35], v3 offset:49152
    ds_read_b128 v[36:39], v3 offset:51200
    ds_read_b128 v[40:43], v3 offset:53248
    ds_read_b128 v[44:47], v3 offset:55296
    ds_read_b128 v[48:51], v3 offset:57344
    ds_read_b128 v[52:55], v3 offset:59392
    ds_read_b128 v[56:59], v3 offset:61440
    ds_read_b128 v[60:63], v3 offset:63488
    ds_read_b128 v[64:67], v4 offset:49152
    ds_read_b128 v[68:71], v4 offset:51200
    ds_read_b128 v[72:75], v4 offset:53248
    ds_read_b128 v[76:79], v4 offset:55296
    ds_read_b128 v[80:83], v3 offset:50176
    ds_read_b128 v[84:87], v3 offset:52224
    ds_read_b128 v[88:91], v3 offset:54272
    ds_read_b128 v[92:95], v3 offset:56320
    ds_read_b128 v[96:99], v3 offset:58368
    ds_read_b128 v[100:103], v3 offset:60416
    ds_read_b128 v[104:107], v3 offset:62464
    ds_read_b128 v[108:111], v3 offset:64512
    ds_read_b128 v[112:115], v4 offset:50176
    ds_read_b128 v[116:119], v4 offset:52224
    ds_read_b128 v[120:123], v4 offset:54272
    ds_read_b128 v[124:127], v4 offset:56320
    s_waitcnt lgkmcnt(12)
    v_mfma_f32_16x16x32_bf16 v[128:131], v[32:35], v[64:67], v[128:131]
    v_mfma_f32_16x16x32_bf16 v[132:135], v[32:35], v[68:71], v[132:135]
    v_mfma_f32_16x16x32_bf16 v[136:139], v[32:35], v[72:75], v[136:139]
    v_mfma_f32_16x16x32_bf16 v[140:143], v[32:35], v[76:79], v[140:143]
    v_mfma_f32_16x16x32_bf16 v[144:147], v[36:39], v[64:67], v[144:147]
    v_mfma_f32_16x16x32_bf16 v[148:151], v[36:39], v[68:71], v[148:151]
    v_mfma_f32_16x16x32_bf16 v[152:155], v[36:39], v[72:75], v[152:155]
    v_mfma_f32_16x16x32_bf16 v[156:159], v[36:39], v[76:79], v[156:159]
    v_mfma_f32_16x16x32_bf16 v[160:163], v[40:43], v[64:67], v[160:163]
    v_mfma_f32_16x16x32_bf16 v[164:167], v[40:43], v[68:71], v[164:167]
    v_mfma_f32_16x16x32_bf16 v[168:171], v[40:43], v[72:75], v[168:171]
    v_mfma_f32_16x16x32_bf16 v[172:175], v[40:43], v[76:79], v[172:175]
    v_mfma_f32_16x16x32_bf16 v[176:179], v[44:47], v[64:67], v[176:179]
    v_mfma_f32_16x16x32_bf16 v[180:183], v[44:47], v[68:71], v[180:183]
    v_mfma_f32_16x16x32_bf16 v[184:187], v[44:47], v[72:75], v[184:187]
    v_mfma_f32_16x16x32_bf16 v[188:191], v[44:47], v[76:79], v[188:191]
    v_mfma_f32_16x16x32_bf16 v[192:195], v[48:51], v[64:67], v[192:195]
    v_mfma_f32_16x16x32_bf16 v[196:199], v[48:51], v[68:71], v[196:199]
    v_mfma_f32_16x16x32_bf16 v[200:203], v[48:51], v[72:75], v[200:203]
    v_mfma_f32_16x16x32_bf16 v[204:207], v[48:51], v[76:79], v[204:207]
    v_mfma_f32_16x16x32_bf16 v[208:211], v[52:55], v[64:67], v[208:211]
    v_mfma_f32_16x16x32_bf16 v[212:215], v[52:55], v[68:71], v[212:215]
    v_mfma_f32_16x16x32_bf16 v[216:219], v[52:55], v[72:75], v[216:219]
    v_mfma_f32_16x16x32_bf16 v[220:223], v[52:55], v[76:79], v[220:223]
    v_mfma_f32_16x16x32_bf16 v[224:227], v[56:59], v[64:67], v[224:227]
    v_mfma_f32_16x16x32_bf16 v[228:231], v[56:59], v[68:71], v[228:231]
    v_mfma_f32_16x16x32_bf16 v[232:235], v[56:59], v[72:75], v[232:235]
    v_mfma_f32_16x16x32_bf16 v[236:239], v[56:59], v[76:79], v[236:239]
    v_mfma_f32_16x16x32_bf16 v[240:243], v[60:63], v[64:67], v[240:243]
    v_mfma_f32_16x16x32_bf16 v[244:247], v[60:63], v[68:71], v[244:247]
    v_mfma_f32_16x16x32_bf16 v[248:251], v[60:63], v[72:75], v[248:251]
    v_mfma_f32_16x16x32_bf16 v[252:255], v[60:63], v[76:79], v[252:255]
    s_waitcnt lgkmcnt(0)
    v_mfma_f32_16x16x32_bf16 v[128:131], v[80:83], v[112:115], v[128:131]
    v_mfma_f32_16x16x32_bf16 v[132:135], v[80:83], v[116:119], v[132:135]
    v_mfma_f32_16x16x32_bf16 v[136:139], v[80:83], v[120:123], v[136:139]
    v_mfma_f32_16x16x32_bf16 v[140:143], v[80:83], v[124:127], v[140:143]
    v_mfma_f32_16x16x32_bf16 v[144:147], v[84:87], v[112:115], v[144:147]
    v_mfma_f32_16x16x32_bf16 v[148:151], v[84:87], v[116:119], v[148:151]
    v_mfma_f32_16x16x32_bf16 v[152:155], v[84:87], v[120:123], v[152:155]
    v_mfma_f32_16x16x32_bf16 v[156:159], v[84:87], v[124:127], v[156:159]
    v_mfma_f32_16x16x32_bf16 v[160:163], v[88:91], v[112:115], v[160:163]
    v_mfma_f32_16x16x32_bf16 v[164:167], v[88:91], v[116:119], v[164:167]
    v_mfma_f32_16x16x32_bf16 v[168:171], v[88:91], v[120:123], v[168:171]
    v_mfma_f32_16x16x32_bf16 v[172:175], v[88:91], v[124:127], v[172:175]
    v_mfma_f32_16x16x32_bf16 v[176:179], v[92:95], v[112:115], v[176:179]
    v_mfma_f32_16x16x32_bf16 v[180:183], v[92:95], v[116:119], v[180:183]
    v_mfma_f32_16x16x32_bf16 v[184:187], v[92:95], v[120:123], v[184:187]
    v_mfma_f32_16x16x32_bf16 v[188:191], v[92:95], v[124:127], v[188:191]
    v_mfma_f32_16x16x32_bf16 v[192:195], v[96:99], v[112:115], v[192:195]
    v_mfma_f32_16x16x32_bf16 v[196:199], v[96:99], v[116:119], v[196:199]
    v_mfma_f32_16x16x32_bf16 v[200:203], v[96:99], v[120:123], v[200:203]
    v_mfma_f32_16x16x32_bf16 v[204:207], v[96:99], v[124:127], v[204:207]
    v_mfma_f32_16x16x32_bf16 v[208:211], v[100:103], v[112:115], v[208:211]
    v_mfma_f32_16x16x32_bf16 v[212:215], v[100:103], v[116:119], v[212:215]
    v_mfma_f32_16x16x32_bf16 v[216:219], v[100:103], v[120:123], v[216:219]
    v_mfma_f32_16x16x32_bf16 v[220:223], v[100:103], v[124:127], v[220:223]
    v_mfma_f32_16x16x32_bf16 v[224:227], v[104:107], v[112:115], v[224:227]
    v_mfma_f32_16x16x32_bf16 v[228:231], v[104:107], v[116:119], v[228:231]
    v_mfma_f32_16x16x32_bf16 v[232:235], v[104:107], v[120:123], v[232:235]
    v_mfma_f32_16x16x32_bf16 v[236:239], v[104:107], v[124:127], v[236:239]
    v_mfma_f32_16x16x32_bf16 v[240:243], v[108:111], v[112:115], v[240:243]
    v_mfma_f32_16x16x32_bf16 v[244:247], v[108:111], v[116:119], v[244:247]
    v_mfma_f32_16x16x32_bf16 v[248:251], v[108:111], v[120:123], v[248:251]
    v_mfma_f32_16x16x32_bf16 v[252:255], v[108:111], v[124:127], v[252:255]
    s_waitcnt vmcnt(0)
    s_barrier
    s_add_u32 m0, s26, 49152
    s_add_u32 s32, s20, 14336
    buffer_load_dwordx4 v1, s[40:43], s32 offen lds
    buffer_load_dwordx4 v1, s[40:43], s32 offen offset:1024 lds

    s_add_u32 m0, s27, 49152
    s_add_u32 s32, s21, 14336
    buffer_load_dwordx4 v1, s[40:43], s32 offen lds
    buffer_load_dwordx4 v1, s[40:43], s32 offen offset:1024 lds

    s_add_u32 m0, s28, 49152
    s_add_u32 s32, s22, 14336
    buffer_load_dwordx4 v1, s[40:43], s32 offen lds
    buffer_load_dwordx4 v1, s[40:43], s32 offen offset:1024 lds

    s_add_u32 m0, s29, 49152
    s_add_u32 s32, s23, 14336
    buffer_load_dwordx4 v1, s[40:43], s32 offen lds
    buffer_load_dwordx4 v1, s[40:43], s32 offen offset:1024 lds

    s_add_u32 m0, s30, 49152
    s_add_u32 s32, s24, 14336
    buffer_load_dwordx4 v1, s[40:43], s32 offen lds
    buffer_load_dwordx4 v1, s[40:43], s32 offen offset:1024 lds

    s_add_u32 m0, s31, 49152
    s_add_u32 s32, s25, 14336
    buffer_load_dwordx4 v1, s[40:43], s32 offen lds
    buffer_load_dwordx4 v1, s[40:43], s32 offen offset:1024 lds

    ds_read_b128 v[32:35], v3 offset:0
    ds_read_b128 v[36:39], v3 offset:2048
    ds_read_b128 v[40:43], v3 offset:4096
    ds_read_b128 v[44:47], v3 offset:6144
    ds_read_b128 v[48:51], v3 offset:8192
    ds_read_b128 v[52:55], v3 offset:10240
    ds_read_b128 v[56:59], v3 offset:12288
    ds_read_b128 v[60:63], v3 offset:14336
    ds_read_b128 v[64:67], v4 offset:0
    ds_read_b128 v[68:71], v4 offset:2048
    ds_read_b128 v[72:75], v4 offset:4096
    ds_read_b128 v[76:79], v4 offset:6144
    ds_read_b128 v[80:83], v3 offset:1024
    ds_read_b128 v[84:87], v3 offset:3072
    ds_read_b128 v[88:91], v3 offset:5120
    ds_read_b128 v[92:95], v3 offset:7168
    ds_read_b128 v[96:99], v3 offset:9216
    ds_read_b128 v[100:103], v3 offset:11264
    ds_read_b128 v[104:107], v3 offset:13312
    ds_read_b128 v[108:111], v3 offset:15360
    ds_read_b128 v[112:115], v4 offset:1024
    ds_read_b128 v[116:119], v4 offset:3072
    ds_read_b128 v[120:123], v4 offset:5120
    ds_read_b128 v[124:127], v4 offset:7168
    s_waitcnt lgkmcnt(12)
    v_mfma_f32_16x16x32_bf16 v[128:131], v[32:35], v[64:67], v[128:131]
    v_mfma_f32_16x16x32_bf16 v[132:135], v[32:35], v[68:71], v[132:135]
    v_mfma_f32_16x16x32_bf16 v[136:139], v[32:35], v[72:75], v[136:139]
    v_mfma_f32_16x16x32_bf16 v[140:143], v[32:35], v[76:79], v[140:143]
    v_mfma_f32_16x16x32_bf16 v[144:147], v[36:39], v[64:67], v[144:147]
    v_mfma_f32_16x16x32_bf16 v[148:151], v[36:39], v[68:71], v[148:151]
    v_mfma_f32_16x16x32_bf16 v[152:155], v[36:39], v[72:75], v[152:155]
    v_mfma_f32_16x16x32_bf16 v[156:159], v[36:39], v[76:79], v[156:159]
    v_mfma_f32_16x16x32_bf16 v[160:163], v[40:43], v[64:67], v[160:163]
    v_mfma_f32_16x16x32_bf16 v[164:167], v[40:43], v[68:71], v[164:167]
    v_mfma_f32_16x16x32_bf16 v[168:171], v[40:43], v[72:75], v[168:171]
    v_mfma_f32_16x16x32_bf16 v[172:175], v[40:43], v[76:79], v[172:175]
    v_mfma_f32_16x16x32_bf16 v[176:179], v[44:47], v[64:67], v[176:179]
    v_mfma_f32_16x16x32_bf16 v[180:183], v[44:47], v[68:71], v[180:183]
    v_mfma_f32_16x16x32_bf16 v[184:187], v[44:47], v[72:75], v[184:187]
    v_mfma_f32_16x16x32_bf16 v[188:191], v[44:47], v[76:79], v[188:191]
    v_mfma_f32_16x16x32_bf16 v[192:195], v[48:51], v[64:67], v[192:195]
    v_mfma_f32_16x16x32_bf16 v[196:199], v[48:51], v[68:71], v[196:199]
    v_mfma_f32_16x16x32_bf16 v[200:203], v[48:51], v[72:75], v[200:203]
    v_mfma_f32_16x16x32_bf16 v[204:207], v[48:51], v[76:79], v[204:207]
    v_mfma_f32_16x16x32_bf16 v[208:211], v[52:55], v[64:67], v[208:211]
    v_mfma_f32_16x16x32_bf16 v[212:215], v[52:55], v[68:71], v[212:215]
    v_mfma_f32_16x16x32_bf16 v[216:219], v[52:55], v[72:75], v[216:219]
    v_mfma_f32_16x16x32_bf16 v[220:223], v[52:55], v[76:79], v[220:223]
    v_mfma_f32_16x16x32_bf16 v[224:227], v[56:59], v[64:67], v[224:227]
    v_mfma_f32_16x16x32_bf16 v[228:231], v[56:59], v[68:71], v[228:231]
    v_mfma_f32_16x16x32_bf16 v[232:235], v[56:59], v[72:75], v[232:235]
    v_mfma_f32_16x16x32_bf16 v[236:239], v[56:59], v[76:79], v[236:239]
    v_mfma_f32_16x16x32_bf16 v[240:243], v[60:63], v[64:67], v[240:243]
    v_mfma_f32_16x16x32_bf16 v[244:247], v[60:63], v[68:71], v[244:247]
    v_mfma_f32_16x16x32_bf16 v[248:251], v[60:63], v[72:75], v[248:251]
    v_mfma_f32_16x16x32_bf16 v[252:255], v[60:63], v[76:79], v[252:255]
    s_waitcnt lgkmcnt(0)
    v_mfma_f32_16x16x32_bf16 v[128:131], v[80:83], v[112:115], v[128:131]
    v_mfma_f32_16x16x32_bf16 v[132:135], v[80:83], v[116:119], v[132:135]
    v_mfma_f32_16x16x32_bf16 v[136:139], v[80:83], v[120:123], v[136:139]
    v_mfma_f32_16x16x32_bf16 v[140:143], v[80:83], v[124:127], v[140:143]
    v_mfma_f32_16x16x32_bf16 v[144:147], v[84:87], v[112:115], v[144:147]
    v_mfma_f32_16x16x32_bf16 v[148:151], v[84:87], v[116:119], v[148:151]
    v_mfma_f32_16x16x32_bf16 v[152:155], v[84:87], v[120:123], v[152:155]
    v_mfma_f32_16x16x32_bf16 v[156:159], v[84:87], v[124:127], v[156:159]
    v_mfma_f32_16x16x32_bf16 v[160:163], v[88:91], v[112:115], v[160:163]
    v_mfma_f32_16x16x32_bf16 v[164:167], v[88:91], v[116:119], v[164:167]
    v_mfma_f32_16x16x32_bf16 v[168:171], v[88:91], v[120:123], v[168:171]
    v_mfma_f32_16x16x32_bf16 v[172:175], v[88:91], v[124:127], v[172:175]
    v_mfma_f32_16x16x32_bf16 v[176:179], v[92:95], v[112:115], v[176:179]
    v_mfma_f32_16x16x32_bf16 v[180:183], v[92:95], v[116:119], v[180:183]
    v_mfma_f32_16x16x32_bf16 v[184:187], v[92:95], v[120:123], v[184:187]
    v_mfma_f32_16x16x32_bf16 v[188:191], v[92:95], v[124:127], v[188:191]
    v_mfma_f32_16x16x32_bf16 v[192:195], v[96:99], v[112:115], v[192:195]
    v_mfma_f32_16x16x32_bf16 v[196:199], v[96:99], v[116:119], v[196:199]
    v_mfma_f32_16x16x32_bf16 v[200:203], v[96:99], v[120:123], v[200:203]
    v_mfma_f32_16x16x32_bf16 v[204:207], v[96:99], v[124:127], v[204:207]
    v_mfma_f32_16x16x32_bf16 v[208:211], v[100:103], v[112:115], v[208:211]
    v_mfma_f32_16x16x32_bf16 v[212:215], v[100:103], v[116:119], v[212:215]
    v_mfma_f32_16x16x32_bf16 v[216:219], v[100:103], v[120:123], v[216:219]
    v_mfma_f32_16x16x32_bf16 v[220:223], v[100:103], v[124:127], v[220:223]
    v_mfma_f32_16x16x32_bf16 v[224:227], v[104:107], v[112:115], v[224:227]
    v_mfma_f32_16x16x32_bf16 v[228:231], v[104:107], v[116:119], v[228:231]
    v_mfma_f32_16x16x32_bf16 v[232:235], v[104:107], v[120:123], v[232:235]
    v_mfma_f32_16x16x32_bf16 v[236:239], v[104:107], v[124:127], v[236:239]
    v_mfma_f32_16x16x32_bf16 v[240:243], v[108:111], v[112:115], v[240:243]
    v_mfma_f32_16x16x32_bf16 v[244:247], v[108:111], v[116:119], v[244:247]
    v_mfma_f32_16x16x32_bf16 v[248:251], v[108:111], v[120:123], v[248:251]
    v_mfma_f32_16x16x32_bf16 v[252:255], v[108:111], v[124:127], v[252:255]
    s_waitcnt vmcnt(0)
    s_barrier
    ds_read_b128 v[32:35], v3 offset:49152
    ds_read_b128 v[36:39], v3 offset:51200
    ds_read_b128 v[40:43], v3 offset:53248
    ds_read_b128 v[44:47], v3 offset:55296
    ds_read_b128 v[48:51], v3 offset:57344
    ds_read_b128 v[52:55], v3 offset:59392
    ds_read_b128 v[56:59], v3 offset:61440
    ds_read_b128 v[60:63], v3 offset:63488
    ds_read_b128 v[64:67], v4 offset:49152
    ds_read_b128 v[68:71], v4 offset:51200
    ds_read_b128 v[72:75], v4 offset:53248
    ds_read_b128 v[76:79], v4 offset:55296
    ds_read_b128 v[80:83], v3 offset:50176
    ds_read_b128 v[84:87], v3 offset:52224
    ds_read_b128 v[88:91], v3 offset:54272
    ds_read_b128 v[92:95], v3 offset:56320
    ds_read_b128 v[96:99], v3 offset:58368
    ds_read_b128 v[100:103], v3 offset:60416
    ds_read_b128 v[104:107], v3 offset:62464
    ds_read_b128 v[108:111], v3 offset:64512
    ds_read_b128 v[112:115], v4 offset:50176
    ds_read_b128 v[116:119], v4 offset:52224
    ds_read_b128 v[120:123], v4 offset:54272
    ds_read_b128 v[124:127], v4 offset:56320
    s_waitcnt lgkmcnt(12)
    v_mfma_f32_16x16x32_bf16 v[128:131], v[32:35], v[64:67], v[128:131]
    v_mfma_f32_16x16x32_bf16 v[132:135], v[32:35], v[68:71], v[132:135]
    v_mfma_f32_16x16x32_bf16 v[136:139], v[32:35], v[72:75], v[136:139]
    v_mfma_f32_16x16x32_bf16 v[140:143], v[32:35], v[76:79], v[140:143]
    v_mfma_f32_16x16x32_bf16 v[144:147], v[36:39], v[64:67], v[144:147]
    v_mfma_f32_16x16x32_bf16 v[148:151], v[36:39], v[68:71], v[148:151]
    v_mfma_f32_16x16x32_bf16 v[152:155], v[36:39], v[72:75], v[152:155]
    v_mfma_f32_16x16x32_bf16 v[156:159], v[36:39], v[76:79], v[156:159]
    v_mfma_f32_16x16x32_bf16 v[160:163], v[40:43], v[64:67], v[160:163]
    v_mfma_f32_16x16x32_bf16 v[164:167], v[40:43], v[68:71], v[164:167]
    v_mfma_f32_16x16x32_bf16 v[168:171], v[40:43], v[72:75], v[168:171]
    v_mfma_f32_16x16x32_bf16 v[172:175], v[40:43], v[76:79], v[172:175]
    v_mfma_f32_16x16x32_bf16 v[176:179], v[44:47], v[64:67], v[176:179]
    v_mfma_f32_16x16x32_bf16 v[180:183], v[44:47], v[68:71], v[180:183]
    v_mfma_f32_16x16x32_bf16 v[184:187], v[44:47], v[72:75], v[184:187]
    v_mfma_f32_16x16x32_bf16 v[188:191], v[44:47], v[76:79], v[188:191]
    v_mfma_f32_16x16x32_bf16 v[192:195], v[48:51], v[64:67], v[192:195]
    v_mfma_f32_16x16x32_bf16 v[196:199], v[48:51], v[68:71], v[196:199]
    v_mfma_f32_16x16x32_bf16 v[200:203], v[48:51], v[72:75], v[200:203]
    v_mfma_f32_16x16x32_bf16 v[204:207], v[48:51], v[76:79], v[204:207]
    v_mfma_f32_16x16x32_bf16 v[208:211], v[52:55], v[64:67], v[208:211]
    v_mfma_f32_16x16x32_bf16 v[212:215], v[52:55], v[68:71], v[212:215]
    v_mfma_f32_16x16x32_bf16 v[216:219], v[52:55], v[72:75], v[216:219]
    v_mfma_f32_16x16x32_bf16 v[220:223], v[52:55], v[76:79], v[220:223]
    v_mfma_f32_16x16x32_bf16 v[224:227], v[56:59], v[64:67], v[224:227]
    v_mfma_f32_16x16x32_bf16 v[228:231], v[56:59], v[68:71], v[228:231]
    v_mfma_f32_16x16x32_bf16 v[232:235], v[56:59], v[72:75], v[232:235]
    v_mfma_f32_16x16x32_bf16 v[236:239], v[56:59], v[76:79], v[236:239]
    v_mfma_f32_16x16x32_bf16 v[240:243], v[60:63], v[64:67], v[240:243]
    v_mfma_f32_16x16x32_bf16 v[244:247], v[60:63], v[68:71], v[244:247]
    v_mfma_f32_16x16x32_bf16 v[248:251], v[60:63], v[72:75], v[248:251]
    v_mfma_f32_16x16x32_bf16 v[252:255], v[60:63], v[76:79], v[252:255]
    s_waitcnt lgkmcnt(0)
    v_mfma_f32_16x16x32_bf16 v[128:131], v[80:83], v[112:115], v[128:131]
    v_mfma_f32_16x16x32_bf16 v[132:135], v[80:83], v[116:119], v[132:135]
    v_mfma_f32_16x16x32_bf16 v[136:139], v[80:83], v[120:123], v[136:139]
    v_mfma_f32_16x16x32_bf16 v[140:143], v[80:83], v[124:127], v[140:143]
    v_mfma_f32_16x16x32_bf16 v[144:147], v[84:87], v[112:115], v[144:147]
    v_mfma_f32_16x16x32_bf16 v[148:151], v[84:87], v[116:119], v[148:151]
    v_mfma_f32_16x16x32_bf16 v[152:155], v[84:87], v[120:123], v[152:155]
    v_mfma_f32_16x16x32_bf16 v[156:159], v[84:87], v[124:127], v[156:159]
    v_mfma_f32_16x16x32_bf16 v[160:163], v[88:91], v[112:115], v[160:163]
    v_mfma_f32_16x16x32_bf16 v[164:167], v[88:91], v[116:119], v[164:167]
    v_mfma_f32_16x16x32_bf16 v[168:171], v[88:91], v[120:123], v[168:171]
    v_mfma_f32_16x16x32_bf16 v[172:175], v[88:91], v[124:127], v[172:175]
    v_mfma_f32_16x16x32_bf16 v[176:179], v[92:95], v[112:115], v[176:179]
    v_mfma_f32_16x16x32_bf16 v[180:183], v[92:95], v[116:119], v[180:183]
    v_mfma_f32_16x16x32_bf16 v[184:187], v[92:95], v[120:123], v[184:187]
    v_mfma_f32_16x16x32_bf16 v[188:191], v[92:95], v[124:127], v[188:191]
    v_mfma_f32_16x16x32_bf16 v[192:195], v[96:99], v[112:115], v[192:195]
    v_mfma_f32_16x16x32_bf16 v[196:199], v[96:99], v[116:119], v[196:199]
    v_mfma_f32_16x16x32_bf16 v[200:203], v[96:99], v[120:123], v[200:203]
    v_mfma_f32_16x16x32_bf16 v[204:207], v[96:99], v[124:127], v[204:207]
    v_mfma_f32_16x16x32_bf16 v[208:211], v[100:103], v[112:115], v[208:211]
    v_mfma_f32_16x16x32_bf16 v[212:215], v[100:103], v[116:119], v[212:215]
    v_mfma_f32_16x16x32_bf16 v[216:219], v[100:103], v[120:123], v[216:219]
    v_mfma_f32_16x16x32_bf16 v[220:223], v[100:103], v[124:127], v[220:223]
    v_mfma_f32_16x16x32_bf16 v[224:227], v[104:107], v[112:115], v[224:227]
    v_mfma_f32_16x16x32_bf16 v[228:231], v[104:107], v[116:119], v[228:231]
    v_mfma_f32_16x16x32_bf16 v[232:235], v[104:107], v[120:123], v[232:235]
    v_mfma_f32_16x16x32_bf16 v[236:239], v[104:107], v[124:127], v[236:239]
    v_mfma_f32_16x16x32_bf16 v[240:243], v[108:111], v[112:115], v[240:243]
    v_mfma_f32_16x16x32_bf16 v[244:247], v[108:111], v[116:119], v[244:247]
    v_mfma_f32_16x16x32_bf16 v[248:251], v[108:111], v[120:123], v[248:251]
    v_mfma_f32_16x16x32_bf16 v[252:255], v[108:111], v[124:127], v[252:255]
    s_nop 7
    s_nop 7
    s_cmp_ge_u32 s4, 48
    s_cbranch_scc1 L_g1_epi_glu

    s_lshl_b32 s33, s5, 3
    s_lshl_b32 s34, s15, 2
    s_add_u32 s33, s33, s34
    s_lshl_b32 s33, s33, 7
    s_and_b32 s34, s4, 15
    s_lshl_b32 s34, s34, 3
    s_add_u32 s33, s33, s34
    s_lshl_b32 s34, s14, 2
    s_add_u32 s33, s33, s34
    s_lshl_b32 s33, s33, 10
    s_add_u32 s33, s33, 25165824
    s_cmp_ge_u32 s4, 16
    s_cselect_b32 s34, 16777216, 0
    s_add_u32 s33, s33, s34
    v_add_u32 v5, s33, v1

    v_cvt_pk_bf16_f32 v32, v128, v129
    v_cvt_pk_bf16_f32 v33, v130, v131
    v_cvt_pk_bf16_f32 v34, v144, v145
    v_cvt_pk_bf16_f32 v35, v146, v147
    buffer_store_dwordx4 v[32:35], v5, s[40:43], 0 offen offset:0 sc0 sc1

    v_cvt_pk_bf16_f32 v36, v160, v161
    v_cvt_pk_bf16_f32 v37, v162, v163
    v_cvt_pk_bf16_f32 v38, v176, v177
    v_cvt_pk_bf16_f32 v39, v178, v179
    buffer_store_dwordx4 v[36:39], v5, s[40:43], 0 offen offset:1024 sc0 sc1

    v_cvt_pk_bf16_f32 v40, v192, v193
    v_cvt_pk_bf16_f32 v41, v194, v195
    v_cvt_pk_bf16_f32 v42, v208, v209
    v_cvt_pk_bf16_f32 v43, v210, v211
    buffer_store_dwordx4 v[40:43], v5, s[40:43], 0 offen offset:2048 sc0 sc1

    v_cvt_pk_bf16_f32 v44, v224, v225
    v_cvt_pk_bf16_f32 v45, v226, v227
    v_cvt_pk_bf16_f32 v46, v240, v241
    v_cvt_pk_bf16_f32 v47, v242, v243
    buffer_store_dwordx4 v[44:47], v5, s[40:43], 0 offen offset:3072 sc0 sc1

    v_add_u32 v5, 131072, v5
    v_cvt_pk_bf16_f32 v48, v132, v133
    v_cvt_pk_bf16_f32 v49, v134, v135
    v_cvt_pk_bf16_f32 v50, v148, v149
    v_cvt_pk_bf16_f32 v51, v150, v151
    buffer_store_dwordx4 v[48:51], v5, s[40:43], 0 offen offset:0 sc0 sc1

    v_cvt_pk_bf16_f32 v52, v164, v165
    v_cvt_pk_bf16_f32 v53, v166, v167
    v_cvt_pk_bf16_f32 v54, v180, v181
    v_cvt_pk_bf16_f32 v55, v182, v183
    buffer_store_dwordx4 v[52:55], v5, s[40:43], 0 offen offset:1024 sc0 sc1

    v_cvt_pk_bf16_f32 v56, v196, v197
    v_cvt_pk_bf16_f32 v57, v198, v199
    v_cvt_pk_bf16_f32 v58, v212, v213
    v_cvt_pk_bf16_f32 v59, v214, v215
    buffer_store_dwordx4 v[56:59], v5, s[40:43], 0 offen offset:2048 sc0 sc1

    v_cvt_pk_bf16_f32 v60, v228, v229
    v_cvt_pk_bf16_f32 v61, v230, v231
    v_cvt_pk_bf16_f32 v62, v244, v245
    v_cvt_pk_bf16_f32 v63, v246, v247
    buffer_store_dwordx4 v[60:63], v5, s[40:43], 0 offen offset:3072 sc0 sc1

    v_add_u32 v5, 131072, v5
    v_cvt_pk_bf16_f32 v32, v136, v137
    v_cvt_pk_bf16_f32 v33, v138, v139
    v_cvt_pk_bf16_f32 v34, v152, v153
    v_cvt_pk_bf16_f32 v35, v154, v155
    buffer_store_dwordx4 v[32:35], v5, s[40:43], 0 offen offset:0 sc0 sc1

    v_cvt_pk_bf16_f32 v36, v168, v169
    v_cvt_pk_bf16_f32 v37, v170, v171
    v_cvt_pk_bf16_f32 v38, v184, v185
    v_cvt_pk_bf16_f32 v39, v186, v187
    buffer_store_dwordx4 v[36:39], v5, s[40:43], 0 offen offset:1024 sc0 sc1

    v_cvt_pk_bf16_f32 v40, v200, v201
    v_cvt_pk_bf16_f32 v41, v202, v203
    v_cvt_pk_bf16_f32 v42, v216, v217
    v_cvt_pk_bf16_f32 v43, v218, v219
    buffer_store_dwordx4 v[40:43], v5, s[40:43], 0 offen offset:2048 sc0 sc1

    v_cvt_pk_bf16_f32 v44, v232, v233
    v_cvt_pk_bf16_f32 v45, v234, v235
    v_cvt_pk_bf16_f32 v46, v248, v249
    v_cvt_pk_bf16_f32 v47, v250, v251
    buffer_store_dwordx4 v[44:47], v5, s[40:43], 0 offen offset:3072 sc0 sc1

    v_add_u32 v5, 131072, v5
    v_cvt_pk_bf16_f32 v48, v140, v141
    v_cvt_pk_bf16_f32 v49, v142, v143
    v_cvt_pk_bf16_f32 v50, v156, v157
    v_cvt_pk_bf16_f32 v51, v158, v159
    buffer_store_dwordx4 v[48:51], v5, s[40:43], 0 offen offset:0 sc0 sc1

    v_cvt_pk_bf16_f32 v52, v172, v173
    v_cvt_pk_bf16_f32 v53, v174, v175
    v_cvt_pk_bf16_f32 v54, v188, v189
    v_cvt_pk_bf16_f32 v55, v190, v191
    buffer_store_dwordx4 v[52:55], v5, s[40:43], 0 offen offset:1024 sc0 sc1

    v_cvt_pk_bf16_f32 v56, v204, v205
    v_cvt_pk_bf16_f32 v57, v206, v207
    v_cvt_pk_bf16_f32 v58, v220, v221
    v_cvt_pk_bf16_f32 v59, v222, v223
    buffer_store_dwordx4 v[56:59], v5, s[40:43], 0 offen offset:2048 sc0 sc1

    v_cvt_pk_bf16_f32 v60, v236, v237
    v_cvt_pk_bf16_f32 v61, v238, v239
    v_cvt_pk_bf16_f32 v62, v252, v253
    v_cvt_pk_bf16_f32 v63, v254, v255
    buffer_store_dwordx4 v[60:63], v5, s[40:43], 0 offen offset:3072 sc0 sc1

    v_add_u32 v5, 131072, v5
    s_branch L_g1_done
L_g1_epi_glu:
    s_lshl_b32 s33, s5, 3
    s_lshl_b32 s34, s15, 2
    s_add_u32 s33, s33, s34
    s_mul_i32 s33, s33, 56
    s_sub_u32 s34, s4, 48
    s_lshl_b32 s34, s34, 1
    s_add_u32 s34, s34, s14
    s_lshl_b32 s34, s34, 1
    s_add_u32 s33, s33, s34
    s_lshl_b32 s33, s33, 10
    s_add_u32 s33, s33, 75497472
    v_add_u32 v5, s33, v1
    s_mov_b32 s35, 0xbfb8aa3b

    v_cvt_pk_bf16_f32 v10, v128, v129
    v_cvt_pk_bf16_f32 v11, v192, v193
    v_lshlrev_b32 v12, 16, v10
    v_and_b32 v13, 0xffff0000, v10
    v_mul_f32 v12, s35, v12
    v_mul_f32 v13, s35, v13
    v_exp_f32 v12, v12
    v_exp_f32 v13, v13
    v_lshlrev_b32 v14, 16, v11
    v_add_f32 v12, 1.0, v12
    v_add_f32 v13, 1.0, v13
    v_rcp_f32 v12, v12
    v_rcp_f32 v13, v13
    v_and_b32 v15, 0xffff0000, v11
    v_cvt_pk_bf16_f32 v10, v12, v13
    v_lshlrev_b32 v12, 16, v10
    v_and_b32 v13, 0xffff0000, v10
    v_mul_f32 v12, v12, v14
    v_mul_f32 v13, v13, v15
    v_cvt_pk_bf16_f32 v32, v12, v13

    v_cvt_pk_bf16_f32 v10, v130, v131
    v_cvt_pk_bf16_f32 v11, v194, v195
    v_lshlrev_b32 v12, 16, v10
    v_and_b32 v13, 0xffff0000, v10
    v_mul_f32 v12, s35, v12
    v_mul_f32 v13, s35, v13
    v_exp_f32 v12, v12
    v_exp_f32 v13, v13
    v_lshlrev_b32 v14, 16, v11
    v_add_f32 v12, 1.0, v12
    v_add_f32 v13, 1.0, v13
    v_rcp_f32 v12, v12
    v_rcp_f32 v13, v13
    v_and_b32 v15, 0xffff0000, v11
    v_cvt_pk_bf16_f32 v10, v12, v13
    v_lshlrev_b32 v12, 16, v10
    v_and_b32 v13, 0xffff0000, v10
    v_mul_f32 v12, v12, v14
    v_mul_f32 v13, v13, v15
    v_cvt_pk_bf16_f32 v33, v12, v13

    v_cvt_pk_bf16_f32 v10, v144, v145
    v_cvt_pk_bf16_f32 v11, v208, v209
    v_lshlrev_b32 v12, 16, v10
    v_and_b32 v13, 0xffff0000, v10
    v_mul_f32 v12, s35, v12
    v_mul_f32 v13, s35, v13
    v_exp_f32 v12, v12
    v_exp_f32 v13, v13
    v_lshlrev_b32 v14, 16, v11
    v_add_f32 v12, 1.0, v12
    v_add_f32 v13, 1.0, v13
    v_rcp_f32 v12, v12
    v_rcp_f32 v13, v13
    v_and_b32 v15, 0xffff0000, v11
    v_cvt_pk_bf16_f32 v10, v12, v13
    v_lshlrev_b32 v12, 16, v10
    v_and_b32 v13, 0xffff0000, v10
    v_mul_f32 v12, v12, v14
    v_mul_f32 v13, v13, v15
    v_cvt_pk_bf16_f32 v34, v12, v13

    v_cvt_pk_bf16_f32 v10, v146, v147
    v_cvt_pk_bf16_f32 v11, v210, v211
    v_lshlrev_b32 v12, 16, v10
    v_and_b32 v13, 0xffff0000, v10
    v_mul_f32 v12, s35, v12
    v_mul_f32 v13, s35, v13
    v_exp_f32 v12, v12
    v_exp_f32 v13, v13
    v_lshlrev_b32 v14, 16, v11
    v_add_f32 v12, 1.0, v12
    v_add_f32 v13, 1.0, v13
    v_rcp_f32 v12, v12
    v_rcp_f32 v13, v13
    v_and_b32 v15, 0xffff0000, v11
    v_cvt_pk_bf16_f32 v10, v12, v13
    v_lshlrev_b32 v12, 16, v10
    v_and_b32 v13, 0xffff0000, v10
    v_mul_f32 v12, v12, v14
    v_mul_f32 v13, v13, v15
    v_cvt_pk_bf16_f32 v35, v12, v13

    buffer_store_dwordx4 v[32:35], v5, s[40:43], 0 offen offset:0 sc0 sc1
    v_cvt_pk_bf16_f32 v10, v160, v161
    v_cvt_pk_bf16_f32 v11, v224, v225
    v_lshlrev_b32 v12, 16, v10
    v_and_b32 v13, 0xffff0000, v10
    v_mul_f32 v12, s35, v12
    v_mul_f32 v13, s35, v13
    v_exp_f32 v12, v12
    v_exp_f32 v13, v13
    v_lshlrev_b32 v14, 16, v11
    v_add_f32 v12, 1.0, v12
    v_add_f32 v13, 1.0, v13
    v_rcp_f32 v12, v12
    v_rcp_f32 v13, v13
    v_and_b32 v15, 0xffff0000, v11
    v_cvt_pk_bf16_f32 v10, v12, v13
    v_lshlrev_b32 v12, 16, v10
    v_and_b32 v13, 0xffff0000, v10
    v_mul_f32 v12, v12, v14
    v_mul_f32 v13, v13, v15
    v_cvt_pk_bf16_f32 v36, v12, v13

    v_cvt_pk_bf16_f32 v10, v162, v163
    v_cvt_pk_bf16_f32 v11, v226, v227
    v_lshlrev_b32 v12, 16, v10
    v_and_b32 v13, 0xffff0000, v10
    v_mul_f32 v12, s35, v12
    v_mul_f32 v13, s35, v13
    v_exp_f32 v12, v12
    v_exp_f32 v13, v13
    v_lshlrev_b32 v14, 16, v11
    v_add_f32 v12, 1.0, v12
    v_add_f32 v13, 1.0, v13
    v_rcp_f32 v12, v12
    v_rcp_f32 v13, v13
    v_and_b32 v15, 0xffff0000, v11
    v_cvt_pk_bf16_f32 v10, v12, v13
    v_lshlrev_b32 v12, 16, v10
    v_and_b32 v13, 0xffff0000, v10
    v_mul_f32 v12, v12, v14
    v_mul_f32 v13, v13, v15
    v_cvt_pk_bf16_f32 v37, v12, v13

    v_cvt_pk_bf16_f32 v10, v176, v177
    v_cvt_pk_bf16_f32 v11, v240, v241
    v_lshlrev_b32 v12, 16, v10
    v_and_b32 v13, 0xffff0000, v10
    v_mul_f32 v12, s35, v12
    v_mul_f32 v13, s35, v13
    v_exp_f32 v12, v12
    v_exp_f32 v13, v13
    v_lshlrev_b32 v14, 16, v11
    v_add_f32 v12, 1.0, v12
    v_add_f32 v13, 1.0, v13
    v_rcp_f32 v12, v12
    v_rcp_f32 v13, v13
    v_and_b32 v15, 0xffff0000, v11
    v_cvt_pk_bf16_f32 v10, v12, v13
    v_lshlrev_b32 v12, 16, v10
    v_and_b32 v13, 0xffff0000, v10
    v_mul_f32 v12, v12, v14
    v_mul_f32 v13, v13, v15
    v_cvt_pk_bf16_f32 v38, v12, v13

    v_cvt_pk_bf16_f32 v10, v178, v179
    v_cvt_pk_bf16_f32 v11, v242, v243
    v_lshlrev_b32 v12, 16, v10
    v_and_b32 v13, 0xffff0000, v10
    v_mul_f32 v12, s35, v12
    v_mul_f32 v13, s35, v13
    v_exp_f32 v12, v12
    v_exp_f32 v13, v13
    v_lshlrev_b32 v14, 16, v11
    v_add_f32 v12, 1.0, v12
    v_add_f32 v13, 1.0, v13
    v_rcp_f32 v12, v12
    v_rcp_f32 v13, v13
    v_and_b32 v15, 0xffff0000, v11
    v_cvt_pk_bf16_f32 v10, v12, v13
    v_lshlrev_b32 v12, 16, v10
    v_and_b32 v13, 0xffff0000, v10
    v_mul_f32 v12, v12, v14
    v_mul_f32 v13, v13, v15
    v_cvt_pk_bf16_f32 v39, v12, v13

    buffer_store_dwordx4 v[36:39], v5, s[40:43], 0 offen offset:1024 sc0 sc1
    v_add_u32 v5, 57344, v5
    v_cvt_pk_bf16_f32 v10, v132, v133
    v_cvt_pk_bf16_f32 v11, v196, v197
    v_lshlrev_b32 v12, 16, v10
    v_and_b32 v13, 0xffff0000, v10
    v_mul_f32 v12, s35, v12
    v_mul_f32 v13, s35, v13
    v_exp_f32 v12, v12
    v_exp_f32 v13, v13
    v_lshlrev_b32 v14, 16, v11
    v_add_f32 v12, 1.0, v12
    v_add_f32 v13, 1.0, v13
    v_rcp_f32 v12, v12
    v_rcp_f32 v13, v13
    v_and_b32 v15, 0xffff0000, v11
    v_cvt_pk_bf16_f32 v10, v12, v13
    v_lshlrev_b32 v12, 16, v10
    v_and_b32 v13, 0xffff0000, v10
    v_mul_f32 v12, v12, v14
    v_mul_f32 v13, v13, v15
    v_cvt_pk_bf16_f32 v40, v12, v13

    v_cvt_pk_bf16_f32 v10, v134, v135
    v_cvt_pk_bf16_f32 v11, v198, v199
    v_lshlrev_b32 v12, 16, v10
    v_and_b32 v13, 0xffff0000, v10
    v_mul_f32 v12, s35, v12
    v_mul_f32 v13, s35, v13
    v_exp_f32 v12, v12
    v_exp_f32 v13, v13
    v_lshlrev_b32 v14, 16, v11
    v_add_f32 v12, 1.0, v12
    v_add_f32 v13, 1.0, v13
    v_rcp_f32 v12, v12
    v_rcp_f32 v13, v13
    v_and_b32 v15, 0xffff0000, v11
    v_cvt_pk_bf16_f32 v10, v12, v13
    v_lshlrev_b32 v12, 16, v10
    v_and_b32 v13, 0xffff0000, v10
    v_mul_f32 v12, v12, v14
    v_mul_f32 v13, v13, v15
    v_cvt_pk_bf16_f32 v41, v12, v13

    v_cvt_pk_bf16_f32 v10, v148, v149
    v_cvt_pk_bf16_f32 v11, v212, v213
    v_lshlrev_b32 v12, 16, v10
    v_and_b32 v13, 0xffff0000, v10
    v_mul_f32 v12, s35, v12
    v_mul_f32 v13, s35, v13
    v_exp_f32 v12, v12
    v_exp_f32 v13, v13
    v_lshlrev_b32 v14, 16, v11
    v_add_f32 v12, 1.0, v12
    v_add_f32 v13, 1.0, v13
    v_rcp_f32 v12, v12
    v_rcp_f32 v13, v13
    v_and_b32 v15, 0xffff0000, v11
    v_cvt_pk_bf16_f32 v10, v12, v13
    v_lshlrev_b32 v12, 16, v10
    v_and_b32 v13, 0xffff0000, v10
    v_mul_f32 v12, v12, v14
    v_mul_f32 v13, v13, v15
    v_cvt_pk_bf16_f32 v42, v12, v13

    v_cvt_pk_bf16_f32 v10, v150, v151
    v_cvt_pk_bf16_f32 v11, v214, v215
    v_lshlrev_b32 v12, 16, v10
    v_and_b32 v13, 0xffff0000, v10
    v_mul_f32 v12, s35, v12
    v_mul_f32 v13, s35, v13
    v_exp_f32 v12, v12
    v_exp_f32 v13, v13
    v_lshlrev_b32 v14, 16, v11
    v_add_f32 v12, 1.0, v12
    v_add_f32 v13, 1.0, v13
    v_rcp_f32 v12, v12
    v_rcp_f32 v13, v13
    v_and_b32 v15, 0xffff0000, v11
    v_cvt_pk_bf16_f32 v10, v12, v13
    v_lshlrev_b32 v12, 16, v10
    v_and_b32 v13, 0xffff0000, v10
    v_mul_f32 v12, v12, v14
    v_mul_f32 v13, v13, v15
    v_cvt_pk_bf16_f32 v43, v12, v13

    buffer_store_dwordx4 v[40:43], v5, s[40:43], 0 offen offset:0 sc0 sc1
    v_cvt_pk_bf16_f32 v10, v164, v165
    v_cvt_pk_bf16_f32 v11, v228, v229
    v_lshlrev_b32 v12, 16, v10
    v_and_b32 v13, 0xffff0000, v10
    v_mul_f32 v12, s35, v12
    v_mul_f32 v13, s35, v13
    v_exp_f32 v12, v12
    v_exp_f32 v13, v13
    v_lshlrev_b32 v14, 16, v11
    v_add_f32 v12, 1.0, v12
    v_add_f32 v13, 1.0, v13
    v_rcp_f32 v12, v12
    v_rcp_f32 v13, v13
    v_and_b32 v15, 0xffff0000, v11
    v_cvt_pk_bf16_f32 v10, v12, v13
    v_lshlrev_b32 v12, 16, v10
    v_and_b32 v13, 0xffff0000, v10
    v_mul_f32 v12, v12, v14
    v_mul_f32 v13, v13, v15
    v_cvt_pk_bf16_f32 v44, v12, v13

    v_cvt_pk_bf16_f32 v10, v166, v167
    v_cvt_pk_bf16_f32 v11, v230, v231
    v_lshlrev_b32 v12, 16, v10
    v_and_b32 v13, 0xffff0000, v10
    v_mul_f32 v12, s35, v12
    v_mul_f32 v13, s35, v13
    v_exp_f32 v12, v12
    v_exp_f32 v13, v13
    v_lshlrev_b32 v14, 16, v11
    v_add_f32 v12, 1.0, v12
    v_add_f32 v13, 1.0, v13
    v_rcp_f32 v12, v12
    v_rcp_f32 v13, v13
    v_and_b32 v15, 0xffff0000, v11
    v_cvt_pk_bf16_f32 v10, v12, v13
    v_lshlrev_b32 v12, 16, v10
    v_and_b32 v13, 0xffff0000, v10
    v_mul_f32 v12, v12, v14
    v_mul_f32 v13, v13, v15
    v_cvt_pk_bf16_f32 v45, v12, v13

    v_cvt_pk_bf16_f32 v10, v180, v181
    v_cvt_pk_bf16_f32 v11, v244, v245
    v_lshlrev_b32 v12, 16, v10
    v_and_b32 v13, 0xffff0000, v10
    v_mul_f32 v12, s35, v12
    v_mul_f32 v13, s35, v13
    v_exp_f32 v12, v12
    v_exp_f32 v13, v13
    v_lshlrev_b32 v14, 16, v11
    v_add_f32 v12, 1.0, v12
    v_add_f32 v13, 1.0, v13
    v_rcp_f32 v12, v12
    v_rcp_f32 v13, v13
    v_and_b32 v15, 0xffff0000, v11
    v_cvt_pk_bf16_f32 v10, v12, v13
    v_lshlrev_b32 v12, 16, v10
    v_and_b32 v13, 0xffff0000, v10
    v_mul_f32 v12, v12, v14
    v_mul_f32 v13, v13, v15
    v_cvt_pk_bf16_f32 v46, v12, v13

    v_cvt_pk_bf16_f32 v10, v182, v183
    v_cvt_pk_bf16_f32 v11, v246, v247
    v_lshlrev_b32 v12, 16, v10
    v_and_b32 v13, 0xffff0000, v10
    v_mul_f32 v12, s35, v12
    v_mul_f32 v13, s35, v13
    v_exp_f32 v12, v12
    v_exp_f32 v13, v13
    v_lshlrev_b32 v14, 16, v11
    v_add_f32 v12, 1.0, v12
    v_add_f32 v13, 1.0, v13
    v_rcp_f32 v12, v12
    v_rcp_f32 v13, v13
    v_and_b32 v15, 0xffff0000, v11
    v_cvt_pk_bf16_f32 v10, v12, v13
    v_lshlrev_b32 v12, 16, v10
    v_and_b32 v13, 0xffff0000, v10
    v_mul_f32 v12, v12, v14
    v_mul_f32 v13, v13, v15
    v_cvt_pk_bf16_f32 v47, v12, v13

    buffer_store_dwordx4 v[44:47], v5, s[40:43], 0 offen offset:1024 sc0 sc1
    v_add_u32 v5, 57344, v5
    v_cvt_pk_bf16_f32 v10, v136, v137
    v_cvt_pk_bf16_f32 v11, v200, v201
    v_lshlrev_b32 v12, 16, v10
    v_and_b32 v13, 0xffff0000, v10
    v_mul_f32 v12, s35, v12
    v_mul_f32 v13, s35, v13
    v_exp_f32 v12, v12
    v_exp_f32 v13, v13
    v_lshlrev_b32 v14, 16, v11
    v_add_f32 v12, 1.0, v12
    v_add_f32 v13, 1.0, v13
    v_rcp_f32 v12, v12
    v_rcp_f32 v13, v13
    v_and_b32 v15, 0xffff0000, v11
    v_cvt_pk_bf16_f32 v10, v12, v13
    v_lshlrev_b32 v12, 16, v10
    v_and_b32 v13, 0xffff0000, v10
    v_mul_f32 v12, v12, v14
    v_mul_f32 v13, v13, v15
    v_cvt_pk_bf16_f32 v48, v12, v13

    v_cvt_pk_bf16_f32 v10, v138, v139
    v_cvt_pk_bf16_f32 v11, v202, v203
    v_lshlrev_b32 v12, 16, v10
    v_and_b32 v13, 0xffff0000, v10
    v_mul_f32 v12, s35, v12
    v_mul_f32 v13, s35, v13
    v_exp_f32 v12, v12
    v_exp_f32 v13, v13
    v_lshlrev_b32 v14, 16, v11
    v_add_f32 v12, 1.0, v12
    v_add_f32 v13, 1.0, v13
    v_rcp_f32 v12, v12
    v_rcp_f32 v13, v13
    v_and_b32 v15, 0xffff0000, v11
    v_cvt_pk_bf16_f32 v10, v12, v13
    v_lshlrev_b32 v12, 16, v10
    v_and_b32 v13, 0xffff0000, v10
    v_mul_f32 v12, v12, v14
    v_mul_f32 v13, v13, v15
    v_cvt_pk_bf16_f32 v49, v12, v13

    v_cvt_pk_bf16_f32 v10, v152, v153
    v_cvt_pk_bf16_f32 v11, v216, v217
    v_lshlrev_b32 v12, 16, v10
    v_and_b32 v13, 0xffff0000, v10
    v_mul_f32 v12, s35, v12
    v_mul_f32 v13, s35, v13
    v_exp_f32 v12, v12
    v_exp_f32 v13, v13
    v_lshlrev_b32 v14, 16, v11
    v_add_f32 v12, 1.0, v12
    v_add_f32 v13, 1.0, v13
    v_rcp_f32 v12, v12
    v_rcp_f32 v13, v13
    v_and_b32 v15, 0xffff0000, v11
    v_cvt_pk_bf16_f32 v10, v12, v13
    v_lshlrev_b32 v12, 16, v10
    v_and_b32 v13, 0xffff0000, v10
    v_mul_f32 v12, v12, v14
    v_mul_f32 v13, v13, v15
    v_cvt_pk_bf16_f32 v50, v12, v13

    v_cvt_pk_bf16_f32 v10, v154, v155
    v_cvt_pk_bf16_f32 v11, v218, v219
    v_lshlrev_b32 v12, 16, v10
    v_and_b32 v13, 0xffff0000, v10
    v_mul_f32 v12, s35, v12
    v_mul_f32 v13, s35, v13
    v_exp_f32 v12, v12
    v_exp_f32 v13, v13
    v_lshlrev_b32 v14, 16, v11
    v_add_f32 v12, 1.0, v12
    v_add_f32 v13, 1.0, v13
    v_rcp_f32 v12, v12
    v_rcp_f32 v13, v13
    v_and_b32 v15, 0xffff0000, v11
    v_cvt_pk_bf16_f32 v10, v12, v13
    v_lshlrev_b32 v12, 16, v10
    v_and_b32 v13, 0xffff0000, v10
    v_mul_f32 v12, v12, v14
    v_mul_f32 v13, v13, v15
    v_cvt_pk_bf16_f32 v51, v12, v13

    buffer_store_dwordx4 v[48:51], v5, s[40:43], 0 offen offset:0 sc0 sc1
    v_cvt_pk_bf16_f32 v10, v168, v169
    v_cvt_pk_bf16_f32 v11, v232, v233
    v_lshlrev_b32 v12, 16, v10
    v_and_b32 v13, 0xffff0000, v10
    v_mul_f32 v12, s35, v12
    v_mul_f32 v13, s35, v13
    v_exp_f32 v12, v12
    v_exp_f32 v13, v13
    v_lshlrev_b32 v14, 16, v11
    v_add_f32 v12, 1.0, v12
    v_add_f32 v13, 1.0, v13
    v_rcp_f32 v12, v12
    v_rcp_f32 v13, v13
    v_and_b32 v15, 0xffff0000, v11
    v_cvt_pk_bf16_f32 v10, v12, v13
    v_lshlrev_b32 v12, 16, v10
    v_and_b32 v13, 0xffff0000, v10
    v_mul_f32 v12, v12, v14
    v_mul_f32 v13, v13, v15
    v_cvt_pk_bf16_f32 v52, v12, v13

    v_cvt_pk_bf16_f32 v10, v170, v171
    v_cvt_pk_bf16_f32 v11, v234, v235
    v_lshlrev_b32 v12, 16, v10
    v_and_b32 v13, 0xffff0000, v10
    v_mul_f32 v12, s35, v12
    v_mul_f32 v13, s35, v13
    v_exp_f32 v12, v12
    v_exp_f32 v13, v13
    v_lshlrev_b32 v14, 16, v11
    v_add_f32 v12, 1.0, v12
    v_add_f32 v13, 1.0, v13
    v_rcp_f32 v12, v12
    v_rcp_f32 v13, v13
    v_and_b32 v15, 0xffff0000, v11
    v_cvt_pk_bf16_f32 v10, v12, v13
    v_lshlrev_b32 v12, 16, v10
    v_and_b32 v13, 0xffff0000, v10
    v_mul_f32 v12, v12, v14
    v_mul_f32 v13, v13, v15
    v_cvt_pk_bf16_f32 v53, v12, v13

    v_cvt_pk_bf16_f32 v10, v184, v185
    v_cvt_pk_bf16_f32 v11, v248, v249
    v_lshlrev_b32 v12, 16, v10
    v_and_b32 v13, 0xffff0000, v10
    v_mul_f32 v12, s35, v12
    v_mul_f32 v13, s35, v13
    v_exp_f32 v12, v12
    v_exp_f32 v13, v13
    v_lshlrev_b32 v14, 16, v11
    v_add_f32 v12, 1.0, v12
    v_add_f32 v13, 1.0, v13
    v_rcp_f32 v12, v12
    v_rcp_f32 v13, v13
    v_and_b32 v15, 0xffff0000, v11
    v_cvt_pk_bf16_f32 v10, v12, v13
    v_lshlrev_b32 v12, 16, v10
    v_and_b32 v13, 0xffff0000, v10
    v_mul_f32 v12, v12, v14
    v_mul_f32 v13, v13, v15
    v_cvt_pk_bf16_f32 v54, v12, v13

    v_cvt_pk_bf16_f32 v10, v186, v187
    v_cvt_pk_bf16_f32 v11, v250, v251
    v_lshlrev_b32 v12, 16, v10
    v_and_b32 v13, 0xffff0000, v10
    v_mul_f32 v12, s35, v12
    v_mul_f32 v13, s35, v13
    v_exp_f32 v12, v12
    v_exp_f32 v13, v13
    v_lshlrev_b32 v14, 16, v11
    v_add_f32 v12, 1.0, v12
    v_add_f32 v13, 1.0, v13
    v_rcp_f32 v12, v12
    v_rcp_f32 v13, v13
    v_and_b32 v15, 0xffff0000, v11
    v_cvt_pk_bf16_f32 v10, v12, v13
    v_lshlrev_b32 v12, 16, v10
    v_and_b32 v13, 0xffff0000, v10
    v_mul_f32 v12, v12, v14
    v_mul_f32 v13, v13, v15
    v_cvt_pk_bf16_f32 v55, v12, v13

    buffer_store_dwordx4 v[52:55], v5, s[40:43], 0 offen offset:1024 sc0 sc1
    v_add_u32 v5, 57344, v5
    v_cvt_pk_bf16_f32 v10, v140, v141
    v_cvt_pk_bf16_f32 v11, v204, v205
    v_lshlrev_b32 v12, 16, v10
    v_and_b32 v13, 0xffff0000, v10
    v_mul_f32 v12, s35, v12
    v_mul_f32 v13, s35, v13
    v_exp_f32 v12, v12
    v_exp_f32 v13, v13
    v_lshlrev_b32 v14, 16, v11
    v_add_f32 v12, 1.0, v12
    v_add_f32 v13, 1.0, v13
    v_rcp_f32 v12, v12
    v_rcp_f32 v13, v13
    v_and_b32 v15, 0xffff0000, v11
    v_cvt_pk_bf16_f32 v10, v12, v13
    v_lshlrev_b32 v12, 16, v10
    v_and_b32 v13, 0xffff0000, v10
    v_mul_f32 v12, v12, v14
    v_mul_f32 v13, v13, v15
    v_cvt_pk_bf16_f32 v56, v12, v13

    v_cvt_pk_bf16_f32 v10, v142, v143
    v_cvt_pk_bf16_f32 v11, v206, v207
    v_lshlrev_b32 v12, 16, v10
    v_and_b32 v13, 0xffff0000, v10
    v_mul_f32 v12, s35, v12
    v_mul_f32 v13, s35, v13
    v_exp_f32 v12, v12
    v_exp_f32 v13, v13
    v_lshlrev_b32 v14, 16, v11
    v_add_f32 v12, 1.0, v12
    v_add_f32 v13, 1.0, v13
    v_rcp_f32 v12, v12
    v_rcp_f32 v13, v13
    v_and_b32 v15, 0xffff0000, v11
    v_cvt_pk_bf16_f32 v10, v12, v13
    v_lshlrev_b32 v12, 16, v10
    v_and_b32 v13, 0xffff0000, v10
    v_mul_f32 v12, v12, v14
    v_mul_f32 v13, v13, v15
    v_cvt_pk_bf16_f32 v57, v12, v13

    v_cvt_pk_bf16_f32 v10, v156, v157
    v_cvt_pk_bf16_f32 v11, v220, v221
    v_lshlrev_b32 v12, 16, v10
    v_and_b32 v13, 0xffff0000, v10
    v_mul_f32 v12, s35, v12
    v_mul_f32 v13, s35, v13
    v_exp_f32 v12, v12
    v_exp_f32 v13, v13
    v_lshlrev_b32 v14, 16, v11
    v_add_f32 v12, 1.0, v12
    v_add_f32 v13, 1.0, v13
    v_rcp_f32 v12, v12
    v_rcp_f32 v13, v13
    v_and_b32 v15, 0xffff0000, v11
    v_cvt_pk_bf16_f32 v10, v12, v13
    v_lshlrev_b32 v12, 16, v10
    v_and_b32 v13, 0xffff0000, v10
    v_mul_f32 v12, v12, v14
    v_mul_f32 v13, v13, v15
    v_cvt_pk_bf16_f32 v58, v12, v13

    v_cvt_pk_bf16_f32 v10, v158, v159
    v_cvt_pk_bf16_f32 v11, v222, v223
    v_lshlrev_b32 v12, 16, v10
    v_and_b32 v13, 0xffff0000, v10
    v_mul_f32 v12, s35, v12
    v_mul_f32 v13, s35, v13
    v_exp_f32 v12, v12
    v_exp_f32 v13, v13
    v_lshlrev_b32 v14, 16, v11
    v_add_f32 v12, 1.0, v12
    v_add_f32 v13, 1.0, v13
    v_rcp_f32 v12, v12
    v_rcp_f32 v13, v13
    v_and_b32 v15, 0xffff0000, v11
    v_cvt_pk_bf16_f32 v10, v12, v13
    v_lshlrev_b32 v12, 16, v10
    v_and_b32 v13, 0xffff0000, v10
    v_mul_f32 v12, v12, v14
    v_mul_f32 v13, v13, v15
    v_cvt_pk_bf16_f32 v59, v12, v13

    buffer_store_dwordx4 v[56:59], v5, s[40:43], 0 offen offset:0 sc0 sc1
    v_cvt_pk_bf16_f32 v10, v172, v173
    v_cvt_pk_bf16_f32 v11, v236, v237
    v_lshlrev_b32 v12, 16, v10
    v_and_b32 v13, 0xffff0000, v10
    v_mul_f32 v12, s35, v12
    v_mul_f32 v13, s35, v13
    v_exp_f32 v12, v12
    v_exp_f32 v13, v13
    v_lshlrev_b32 v14, 16, v11
    v_add_f32 v12, 1.0, v12
    v_add_f32 v13, 1.0, v13
    v_rcp_f32 v12, v12
    v_rcp_f32 v13, v13
    v_and_b32 v15, 0xffff0000, v11
    v_cvt_pk_bf16_f32 v10, v12, v13
    v_lshlrev_b32 v12, 16, v10
    v_and_b32 v13, 0xffff0000, v10
    v_mul_f32 v12, v12, v14
    v_mul_f32 v13, v13, v15
    v_cvt_pk_bf16_f32 v60, v12, v13

    v_cvt_pk_bf16_f32 v10, v174, v175
    v_cvt_pk_bf16_f32 v11, v238, v239
    v_lshlrev_b32 v12, 16, v10
    v_and_b32 v13, 0xffff0000, v10
    v_mul_f32 v12, s35, v12
    v_mul_f32 v13, s35, v13
    v_exp_f32 v12, v12
    v_exp_f32 v13, v13
    v_lshlrev_b32 v14, 16, v11
    v_add_f32 v12, 1.0, v12
    v_add_f32 v13, 1.0, v13
    v_rcp_f32 v12, v12
    v_rcp_f32 v13, v13
    v_and_b32 v15, 0xffff0000, v11
    v_cvt_pk_bf16_f32 v10, v12, v13
    v_lshlrev_b32 v12, 16, v10
    v_and_b32 v13, 0xffff0000, v10
    v_mul_f32 v12, v12, v14
    v_mul_f32 v13, v13, v15
    v_cvt_pk_bf16_f32 v61, v12, v13

    v_cvt_pk_bf16_f32 v10, v188, v189
    v_cvt_pk_bf16_f32 v11, v252, v253
    v_lshlrev_b32 v12, 16, v10
    v_and_b32 v13, 0xffff0000, v10
    v_mul_f32 v12, s35, v12
    v_mul_f32 v13, s35, v13
    v_exp_f32 v12, v12
    v_exp_f32 v13, v13
    v_lshlrev_b32 v14, 16, v11
    v_add_f32 v12, 1.0, v12
    v_add_f32 v13, 1.0, v13
    v_rcp_f32 v12, v12
    v_rcp_f32 v13, v13
    v_and_b32 v15, 0xffff0000, v11
    v_cvt_pk_bf16_f32 v10, v12, v13
    v_lshlrev_b32 v12, 16, v10
    v_and_b32 v13, 0xffff0000, v10
    v_mul_f32 v12, v12, v14
    v_mul_f32 v13, v13, v15
    v_cvt_pk_bf16_f32 v62, v12, v13

    v_cvt_pk_bf16_f32 v10, v190, v191
    v_cvt_pk_bf16_f32 v11, v254, v255
    v_lshlrev_b32 v12, 16, v10
    v_and_b32 v13, 0xffff0000, v10
    v_mul_f32 v12, s35, v12
    v_mul_f32 v13, s35, v13
    v_exp_f32 v12, v12
    v_exp_f32 v13, v13
    v_lshlrev_b32 v14, 16, v11
    v_add_f32 v12, 1.0, v12
    v_add_f32 v13, 1.0, v13
    v_rcp_f32 v12, v12
    v_rcp_f32 v13, v13
    v_and_b32 v15, 0xffff0000, v11
    v_cvt_pk_bf16_f32 v10, v12, v13
    v_lshlrev_b32 v12, 16, v10
    v_and_b32 v13, 0xffff0000, v10
    v_mul_f32 v12, v12, v14
    v_mul_f32 v13, v13, v15
    v_cvt_pk_bf16_f32 v63, v12, v13

    buffer_store_dwordx4 v[60:63], v5, s[40:43], 0 offen offset:1024 sc0 sc1
    v_add_u32 v5, 57344, v5
    s_branch L_g1_done
L_g1_main_v:
    s_waitcnt vmcnt(0)
    s_barrier
    s_add_u32 m0, s26, 49152
    s_add_u32 s32, s20, 2048
    buffer_load_dwordx4 v1, s[40:43], s32 offen lds
    buffer_load_dwordx4 v1, s[40:43], s32 offen offset:1024 lds

    s_add_u32 m0, s27, 49152
    s_add_u32 s32, s21, 2048
    buffer_load_dwordx4 v1, s[40:43], s32 offen lds
    buffer_load_dwordx4 v1, s[40:43], s32 offen offset:1024 lds

    s_add_u32 m0, s28, 49152
    s_add_u32 s32, s22, 2048
    buffer_load_dwordx4 v1, s[40:43], s32 offen lds
    buffer_load_dwordx4 v1, s[40:43], s32 offen offset:1024 lds

    s_add_u32 m0, s29, 49152
    s_add_u32 s32, s23, 2048
    buffer_load_dwordx4 v1, s[40:43], s32 offen lds
    buffer_load_dwordx4 v1, s[40:43], s32 offen offset:1024 lds

    s_add_u32 m0, s30, 49152
    s_add_u32 s32, s24, 2048
    buffer_load_dwordx4 v1, s[40:43], s32 offen lds
    buffer_load_dwordx4 v1, s[40:43], s32 offen offset:1024 lds

    s_add_u32 m0, s31, 49152
    s_add_u32 s32, s25, 2048
    buffer_load_dwordx4 v1, s[40:43], s32 offen lds
    buffer_load_dwordx4 v1, s[40:43], s32 offen offset:1024 lds

    ds_read_b128 v[32:35], v3 offset:0
    ds_read_b128 v[36:39], v3 offset:2048
    ds_read_b128 v[40:43], v3 offset:4096
    ds_read_b128 v[44:47], v3 offset:6144
    ds_read_b128 v[48:51], v3 offset:8192
    ds_read_b128 v[52:55], v3 offset:10240
    ds_read_b128 v[56:59], v3 offset:12288
    ds_read_b128 v[60:63], v3 offset:14336
    ds_read_b128 v[64:67], v4 offset:0
    ds_read_b128 v[68:71], v4 offset:2048
    ds_read_b128 v[72:75], v4 offset:4096
    ds_read_b128 v[76:79], v4 offset:6144
    ds_read_b128 v[80:83], v3 offset:1024
    ds_read_b128 v[84:87], v3 offset:3072
    ds_read_b128 v[88:91], v3 offset:5120
    ds_read_b128 v[92:95], v3 offset:7168
    ds_read_b128 v[96:99], v3 offset:9216
    ds_read_b128 v[100:103], v3 offset:11264
    ds_read_b128 v[104:107], v3 offset:13312
    ds_read_b128 v[108:111], v3 offset:15360
    ds_read_b128 v[112:115], v4 offset:1024
    ds_read_b128 v[116:119], v4 offset:3072
    ds_read_b128 v[120:123], v4 offset:5120
    ds_read_b128 v[124:127], v4 offset:7168
    s_waitcnt lgkmcnt(12)
    v_mfma_f32_16x16x32_bf16 v[128:131], v[64:67], v[32:35], v[128:131]
    v_mfma_f32_16x16x32_bf16 v[132:135], v[68:71], v[32:35], v[132:135]
    v_mfma_f32_16x16x32_bf16 v[136:139], v[72:75], v[32:35], v[136:139]
    v_mfma_f32_16x16x32_bf16 v[140:143], v[76:79], v[32:35], v[140:143]
    v_mfma_f32_16x16x32_bf16 v[144:147], v[64:67], v[36:39], v[144:147]
    v_mfma_f32_16x16x32_bf16 v[148:151], v[68:71], v[36:39], v[148:151]
    v_mfma_f32_16x16x32_bf16 v[152:155], v[72:75], v[36:39], v[152:155]
    v_mfma_f32_16x16x32_bf16 v[156:159], v[76:79], v[36:39], v[156:159]
    v_mfma_f32_16x16x32_bf16 v[160:163], v[64:67], v[40:43], v[160:163]
    v_mfma_f32_16x16x32_bf16 v[164:167], v[68:71], v[40:43], v[164:167]
    v_mfma_f32_16x16x32_bf16 v[168:171], v[72:75], v[40:43], v[168:171]
    v_mfma_f32_16x16x32_bf16 v[172:175], v[76:79], v[40:43], v[172:175]
    v_mfma_f32_16x16x32_bf16 v[176:179], v[64:67], v[44:47], v[176:179]
    v_mfma_f32_16x16x32_bf16 v[180:183], v[68:71], v[44:47], v[180:183]
    v_mfma_f32_16x16x32_bf16 v[184:187], v[72:75], v[44:47], v[184:187]
    v_mfma_f32_16x16x32_bf16 v[188:191], v[76:79], v[44:47], v[188:191]
    v_mfma_f32_16x16x32_bf16 v[192:195], v[64:67], v[48:51], v[192:195]
    v_mfma_f32_16x16x32_bf16 v[196:199], v[68:71], v[48:51], v[196:199]
    v_mfma_f32_16x16x32_bf16 v[200:203], v[72:75], v[48:51], v[200:203]
    v_mfma_f32_16x16x32_bf16 v[204:207], v[76:79], v[48:51], v[204:207]
    v_mfma_f32_16x16x32_bf16 v[208:211], v[64:67], v[52:55], v[208:211]
    v_mfma_f32_16x16x32_bf16 v[212:215], v[68:71], v[52:55], v[212:215]
    v_mfma_f32_16x16x32_bf16 v[216:219], v[72:75], v[52:55], v[216:219]
    v_mfma_f32_16x16x32_bf16 v[220:223], v[76:79], v[52:55], v[220:223]
    v_mfma_f32_16x16x32_bf16 v[224:227], v[64:67], v[56:59], v[224:227]
    v_mfma_f32_16x16x32_bf16 v[228:231], v[68:71], v[56:59], v[228:231]
    v_mfma_f32_16x16x32_bf16 v[232:235], v[72:75], v[56:59], v[232:235]
    v_mfma_f32_16x16x32_bf16 v[236:239], v[76:79], v[56:59], v[236:239]
    v_mfma_f32_16x16x32_bf16 v[240:243], v[64:67], v[60:63], v[240:243]
    v_mfma_f32_16x16x32_bf16 v[244:247], v[68:71], v[60:63], v[244:247]
    v_mfma_f32_16x16x32_bf16 v[248:251], v[72:75], v[60:63], v[248:251]
    v_mfma_f32_16x16x32_bf16 v[252:255], v[76:79], v[60:63], v[252:255]
    s_waitcnt lgkmcnt(0)
    v_mfma_f32_16x16x32_bf16 v[128:131], v[112:115], v[80:83], v[128:131]
    v_mfma_f32_16x16x32_bf16 v[132:135], v[116:119], v[80:83], v[132:135]
    v_mfma_f32_16x16x32_bf16 v[136:139], v[120:123], v[80:83], v[136:139]
    v_mfma_f32_16x16x32_bf16 v[140:143], v[124:127], v[80:83], v[140:143]
    v_mfma_f32_16x16x32_bf16 v[144:147], v[112:115], v[84:87], v[144:147]
    v_mfma_f32_16x16x32_bf16 v[148:151], v[116:119], v[84:87], v[148:151]
    v_mfma_f32_16x16x32_bf16 v[152:155], v[120:123], v[84:87], v[152:155]
    v_mfma_f32_16x16x32_bf16 v[156:159], v[124:127], v[84:87], v[156:159]
    v_mfma_f32_16x16x32_bf16 v[160:163], v[112:115], v[88:91], v[160:163]
    v_mfma_f32_16x16x32_bf16 v[164:167], v[116:119], v[88:91], v[164:167]
    v_mfma_f32_16x16x32_bf16 v[168:171], v[120:123], v[88:91], v[168:171]
    v_mfma_f32_16x16x32_bf16 v[172:175], v[124:127], v[88:91], v[172:175]
    v_mfma_f32_16x16x32_bf16 v[176:179], v[112:115], v[92:95], v[176:179]
    v_mfma_f32_16x16x32_bf16 v[180:183], v[116:119], v[92:95], v[180:183]
    v_mfma_f32_16x16x32_bf16 v[184:187], v[120:123], v[92:95], v[184:187]
    v_mfma_f32_16x16x32_bf16 v[188:191], v[124:127], v[92:95], v[188:191]
    v_mfma_f32_16x16x32_bf16 v[192:195], v[112:115], v[96:99], v[192:195]
    v_mfma_f32_16x16x32_bf16 v[196:199], v[116:119], v[96:99], v[196:199]
    v_mfma_f32_16x16x32_bf16 v[200:203], v[120:123], v[96:99], v[200:203]
    v_mfma_f32_16x16x32_bf16 v[204:207], v[124:127], v[96:99], v[204:207]
    v_mfma_f32_16x16x32_bf16 v[208:211], v[112:115], v[100:103], v[208:211]
    v_mfma_f32_16x16x32_bf16 v[212:215], v[116:119], v[100:103], v[212:215]
    v_mfma_f32_16x16x32_bf16 v[216:219], v[120:123], v[100:103], v[216:219]
    v_mfma_f32_16x16x32_bf16 v[220:223], v[124:127], v[100:103], v[220:223]
    v_mfma_f32_16x16x32_bf16 v[224:227], v[112:115], v[104:107], v[224:227]
    v_mfma_f32_16x16x32_bf16 v[228:231], v[116:119], v[104:107], v[228:231]
    v_mfma_f32_16x16x32_bf16 v[232:235], v[120:123], v[104:107], v[232:235]
    v_mfma_f32_16x16x32_bf16 v[236:239], v[124:127], v[104:107], v[236:239]
    v_mfma_f32_16x16x32_bf16 v[240:243], v[112:115], v[108:111], v[240:243]
    v_mfma_f32_16x16x32_bf16 v[244:247], v[116:119], v[108:111], v[244:247]
    v_mfma_f32_16x16x32_bf16 v[248:251], v[120:123], v[108:111], v[248:251]
    v_mfma_f32_16x16x32_bf16 v[252:255], v[124:127], v[108:111], v[252:255]
    s_waitcnt vmcnt(0)
    s_barrier
    s_add_u32 m0, s26, 0
    s_add_u32 s32, s20, 4096
    buffer_load_dwordx4 v1, s[40:43], s32 offen lds
    buffer_load_dwordx4 v1, s[40:43], s32 offen offset:1024 lds

    s_add_u32 m0, s27, 0
    s_add_u32 s32, s21, 4096
    buffer_load_dwordx4 v1, s[40:43], s32 offen lds
    buffer_load_dwordx4 v1, s[40:43], s32 offen offset:1024 lds

    s_add_u32 m0, s28, 0
    s_add_u32 s32, s22, 4096
    buffer_load_dwordx4 v1, s[40:43], s32 offen lds
    buffer_load_dwordx4 v1, s[40:43], s32 offen offset:1024 lds

    s_add_u32 m0, s29, 0
    s_add_u32 s32, s23, 4096
    buffer_load_dwordx4 v1, s[40:43], s32 offen lds
    buffer_load_dwordx4 v1, s[40:43], s32 offen offset:1024 lds

    s_add_u32 m0, s30, 0
    s_add_u32 s32, s24, 4096
    buffer_load_dwordx4 v1, s[40:43], s32 offen lds
    buffer_load_dwordx4 v1, s[40:43], s32 offen offset:1024 lds

    s_add_u32 m0, s31, 0
    s_add_u32 s32, s25, 4096
    buffer_load_dwordx4 v1, s[40:43], s32 offen lds
    buffer_load_dwordx4 v1, s[40:43], s32 offen offset:1024 lds

    ds_read_b128 v[32:35], v3 offset:49152
    ds_read_b128 v[36:39], v3 offset:51200
    ds_read_b128 v[40:43], v3 offset:53248
    ds_read_b128 v[44:47], v3 offset:55296
    ds_read_b128 v[48:51], v3 offset:57344
    ds_read_b128 v[52:55], v3 offset:59392
    ds_read_b128 v[56:59], v3 offset:61440
    ds_read_b128 v[60:63], v3 offset:63488
    ds_read_b128 v[64:67], v4 offset:49152
    ds_read_b128 v[68:71], v4 offset:51200
    ds_read_b128 v[72:75], v4 offset:53248
    ds_read_b128 v[76:79], v4 offset:55296
    ds_read_b128 v[80:83], v3 offset:50176
    ds_read_b128 v[84:87], v3 offset:52224
    ds_read_b128 v[88:91], v3 offset:54272
    ds_read_b128 v[92:95], v3 offset:56320
    ds_read_b128 v[96:99], v3 offset:58368
    ds_read_b128 v[100:103], v3 offset:60416
    ds_read_b128 v[104:107], v3 offset:62464
    ds_read_b128 v[108:111], v3 offset:64512
    ds_read_b128 v[112:115], v4 offset:50176
    ds_read_b128 v[116:119], v4 offset:52224
    ds_read_b128 v[120:123], v4 offset:54272
    ds_read_b128 v[124:127], v4 offset:56320
    s_waitcnt lgkmcnt(12)
    v_mfma_f32_16x16x32_bf16 v[128:131], v[64:67], v[32:35], v[128:131]
    v_mfma_f32_16x16x32_bf16 v[132:135], v[68:71], v[32:35], v[132:135]
    v_mfma_f32_16x16x32_bf16 v[136:139], v[72:75], v[32:35], v[136:139]
    v_mfma_f32_16x16x32_bf16 v[140:143], v[76:79], v[32:35], v[140:143]
    v_mfma_f32_16x16x32_bf16 v[144:147], v[64:67], v[36:39], v[144:147]
    v_mfma_f32_16x16x32_bf16 v[148:151], v[68:71], v[36:39], v[148:151]
    v_mfma_f32_16x16x32_bf16 v[152:155], v[72:75], v[36:39], v[152:155]
    v_mfma_f32_16x16x32_bf16 v[156:159], v[76:79], v[36:39], v[156:159]
    v_mfma_f32_16x16x32_bf16 v[160:163], v[64:67], v[40:43], v[160:163]
    v_mfma_f32_16x16x32_bf16 v[164:167], v[68:71], v[40:43], v[164:167]
    v_mfma_f32_16x16x32_bf16 v[168:171], v[72:75], v[40:43], v[168:171]
    v_mfma_f32_16x16x32_bf16 v[172:175], v[76:79], v[40:43], v[172:175]
    v_mfma_f32_16x16x32_bf16 v[176:179], v[64:67], v[44:47], v[176:179]
    v_mfma_f32_16x16x32_bf16 v[180:183], v[68:71], v[44:47], v[180:183]
    v_mfma_f32_16x16x32_bf16 v[184:187], v[72:75], v[44:47], v[184:187]
    v_mfma_f32_16x16x32_bf16 v[188:191], v[76:79], v[44:47], v[188:191]
    v_mfma_f32_16x16x32_bf16 v[192:195], v[64:67], v[48:51], v[192:195]
    v_mfma_f32_16x16x32_bf16 v[196:199], v[68:71], v[48:51], v[196:199]
    v_mfma_f32_16x16x32_bf16 v[200:203], v[72:75], v[48:51], v[200:203]
    v_mfma_f32_16x16x32_bf16 v[204:207], v[76:79], v[48:51], v[204:207]
    v_mfma_f32_16x16x32_bf16 v[208:211], v[64:67], v[52:55], v[208:211]
    v_mfma_f32_16x16x32_bf16 v[212:215], v[68:71], v[52:55], v[212:215]
    v_mfma_f32_16x16x32_bf16 v[216:219], v[72:75], v[52:55], v[216:219]
    v_mfma_f32_16x16x32_bf16 v[220:223], v[76:79], v[52:55], v[220:223]
    v_mfma_f32_16x16x32_bf16 v[224:227], v[64:67], v[56:59], v[224:227]
    v_mfma_f32_16x16x32_bf16 v[228:231], v[68:71], v[56:59], v[228:231]
    v_mfma_f32_16x16x32_bf16 v[232:235], v[72:75], v[56:59], v[232:235]
    v_mfma_f32_16x16x32_bf16 v[236:239], v[76:79], v[56:59], v[236:239]
    v_mfma_f32_16x16x32_bf16 v[240:243], v[64:67], v[60:63], v[240:243]
    v_mfma_f32_16x16x32_bf16 v[244:247], v[68:71], v[60:63], v[244:247]
    v_mfma_f32_16x16x32_bf16 v[248:251], v[72:75], v[60:63], v[248:251]
    v_mfma_f32_16x16x32_bf16 v[252:255], v[76:79], v[60:63], v[252:255]
    s_waitcnt lgkmcnt(0)
    v_mfma_f32_16x16x32_bf16 v[128:131], v[112:115], v[80:83], v[128:131]
    v_mfma_f32_16x16x32_bf16 v[132:135], v[116:119], v[80:83], v[132:135]
    v_mfma_f32_16x16x32_bf16 v[136:139], v[120:123], v[80:83], v[136:139]
    v_mfma_f32_16x16x32_bf16 v[140:143], v[124:127], v[80:83], v[140:143]
    v_mfma_f32_16x16x32_bf16 v[144:147], v[112:115], v[84:87], v[144:147]
    v_mfma_f32_16x16x32_bf16 v[148:151], v[116:119], v[84:87], v[148:151]
    v_mfma_f32_16x16x32_bf16 v[152:155], v[120:123], v[84:87], v[152:155]
    v_mfma_f32_16x16x32_bf16 v[156:159], v[124:127], v[84:87], v[156:159]
    v_mfma_f32_16x16x32_bf16 v[160:163], v[112:115], v[88:91], v[160:163]
    v_mfma_f32_16x16x32_bf16 v[164:167], v[116:119], v[88:91], v[164:167]
    v_mfma_f32_16x16x32_bf16 v[168:171], v[120:123], v[88:91], v[168:171]
    v_mfma_f32_16x16x32_bf16 v[172:175], v[124:127], v[88:91], v[172:175]
    v_mfma_f32_16x16x32_bf16 v[176:179], v[112:115], v[92:95], v[176:179]
    v_mfma_f32_16x16x32_bf16 v[180:183], v[116:119], v[92:95], v[180:183]
    v_mfma_f32_16x16x32_bf16 v[184:187], v[120:123], v[92:95], v[184:187]
    v_mfma_f32_16x16x32_bf16 v[188:191], v[124:127], v[92:95], v[188:191]
    v_mfma_f32_16x16x32_bf16 v[192:195], v[112:115], v[96:99], v[192:195]
    v_mfma_f32_16x16x32_bf16 v[196:199], v[116:119], v[96:99], v[196:199]
    v_mfma_f32_16x16x32_bf16 v[200:203], v[120:123], v[96:99], v[200:203]
    v_mfma_f32_16x16x32_bf16 v[204:207], v[124:127], v[96:99], v[204:207]
    v_mfma_f32_16x16x32_bf16 v[208:211], v[112:115], v[100:103], v[208:211]
    v_mfma_f32_16x16x32_bf16 v[212:215], v[116:119], v[100:103], v[212:215]
    v_mfma_f32_16x16x32_bf16 v[216:219], v[120:123], v[100:103], v[216:219]
    v_mfma_f32_16x16x32_bf16 v[220:223], v[124:127], v[100:103], v[220:223]
    v_mfma_f32_16x16x32_bf16 v[224:227], v[112:115], v[104:107], v[224:227]
    v_mfma_f32_16x16x32_bf16 v[228:231], v[116:119], v[104:107], v[228:231]
    v_mfma_f32_16x16x32_bf16 v[232:235], v[120:123], v[104:107], v[232:235]
    v_mfma_f32_16x16x32_bf16 v[236:239], v[124:127], v[104:107], v[236:239]
    v_mfma_f32_16x16x32_bf16 v[240:243], v[112:115], v[108:111], v[240:243]
    v_mfma_f32_16x16x32_bf16 v[244:247], v[116:119], v[108:111], v[244:247]
    v_mfma_f32_16x16x32_bf16 v[248:251], v[120:123], v[108:111], v[248:251]
    v_mfma_f32_16x16x32_bf16 v[252:255], v[124:127], v[108:111], v[252:255]
    s_waitcnt vmcnt(0)
    s_barrier
    s_add_u32 m0, s26, 49152
    s_add_u32 s32, s20, 6144
    buffer_load_dwordx4 v1, s[40:43], s32 offen lds
    buffer_load_dwordx4 v1, s[40:43], s32 offen offset:1024 lds

    s_add_u32 m0, s27, 49152
    s_add_u32 s32, s21, 6144
    buffer_load_dwordx4 v1, s[40:43], s32 offen lds
    buffer_load_dwordx4 v1, s[40:43], s32 offen offset:1024 lds

    s_add_u32 m0, s28, 49152
    s_add_u32 s32, s22, 6144
    buffer_load_dwordx4 v1, s[40:43], s32 offen lds
    buffer_load_dwordx4 v1, s[40:43], s32 offen offset:1024 lds

    s_add_u32 m0, s29, 49152
    s_add_u32 s32, s23, 6144
    buffer_load_dwordx4 v1, s[40:43], s32 offen lds
    buffer_load_dwordx4 v1, s[40:43], s32 offen offset:1024 lds

    s_add_u32 m0, s30, 49152
    s_add_u32 s32, s24, 6144
    buffer_load_dwordx4 v1, s[40:43], s32 offen lds
    buffer_load_dwordx4 v1, s[40:43], s32 offen offset:1024 lds

    s_add_u32 m0, s31, 49152
    s_add_u32 s32, s25, 6144
    buffer_load_dwordx4 v1, s[40:43], s32 offen lds
    buffer_load_dwordx4 v1, s[40:43], s32 offen offset:1024 lds

    ds_read_b128 v[32:35], v3 offset:0
    ds_read_b128 v[36:39], v3 offset:2048
    ds_read_b128 v[40:43], v3 offset:4096
    ds_read_b128 v[44:47], v3 offset:6144
    ds_read_b128 v[48:51], v3 offset:8192
    ds_read_b128 v[52:55], v3 offset:10240
    ds_read_b128 v[56:59], v3 offset:12288
    ds_read_b128 v[60:63], v3 offset:14336
    ds_read_b128 v[64:67], v4 offset:0
    ds_read_b128 v[68:71], v4 offset:2048
    ds_read_b128 v[72:75], v4 offset:4096
    ds_read_b128 v[76:79], v4 offset:6144
    ds_read_b128 v[80:83], v3 offset:1024
    ds_read_b128 v[84:87], v3 offset:3072
    ds_read_b128 v[88:91], v3 offset:5120
    ds_read_b128 v[92:95], v3 offset:7168
    ds_read_b128 v[96:99], v3 offset:9216
    ds_read_b128 v[100:103], v3 offset:11264
    ds_read_b128 v[104:107], v3 offset:13312
    ds_read_b128 v[108:111], v3 offset:15360
    ds_read_b128 v[112:115], v4 offset:1024
    ds_read_b128 v[116:119], v4 offset:3072
    ds_read_b128 v[120:123], v4 offset:5120
    ds_read_b128 v[124:127], v4 offset:7168
    s_waitcnt lgkmcnt(12)
    v_mfma_f32_16x16x32_bf16 v[128:131], v[64:67], v[32:35], v[128:131]
    v_mfma_f32_16x16x32_bf16 v[132:135], v[68:71], v[32:35], v[132:135]
    v_mfma_f32_16x16x32_bf16 v[136:139], v[72:75], v[32:35], v[136:139]
    v_mfma_f32_16x16x32_bf16 v[140:143], v[76:79], v[32:35], v[140:143]
    v_mfma_f32_16x16x32_bf16 v[144:147], v[64:67], v[36:39], v[144:147]
    v_mfma_f32_16x16x32_bf16 v[148:151], v[68:71], v[36:39], v[148:151]
    v_mfma_f32_16x16x32_bf16 v[152:155], v[72:75], v[36:39], v[152:155]
    v_mfma_f32_16x16x32_bf16 v[156:159], v[76:79], v[36:39], v[156:159]
    v_mfma_f32_16x16x32_bf16 v[160:163], v[64:67], v[40:43], v[160:163]
    v_mfma_f32_16x16x32_bf16 v[164:167], v[68:71], v[40:43], v[164:167]
    v_mfma_f32_16x16x32_bf16 v[168:171], v[72:75], v[40:43], v[168:171]
    v_mfma_f32_16x16x32_bf16 v[172:175], v[76:79], v[40:43], v[172:175]
    v_mfma_f32_16x16x32_bf16 v[176:179], v[64:67], v[44:47], v[176:179]
    v_mfma_f32_16x16x32_bf16 v[180:183], v[68:71], v[44:47], v[180:183]
    v_mfma_f32_16x16x32_bf16 v[184:187], v[72:75], v[44:47], v[184:187]
    v_mfma_f32_16x16x32_bf16 v[188:191], v[76:79], v[44:47], v[188:191]
    v_mfma_f32_16x16x32_bf16 v[192:195], v[64:67], v[48:51], v[192:195]
    v_mfma_f32_16x16x32_bf16 v[196:199], v[68:71], v[48:51], v[196:199]
    v_mfma_f32_16x16x32_bf16 v[200:203], v[72:75], v[48:51], v[200:203]
    v_mfma_f32_16x16x32_bf16 v[204:207], v[76:79], v[48:51], v[204:207]
    v_mfma_f32_16x16x32_bf16 v[208:211], v[64:67], v[52:55], v[208:211]
    v_mfma_f32_16x16x32_bf16 v[212:215], v[68:71], v[52:55], v[212:215]
    v_mfma_f32_16x16x32_bf16 v[216:219], v[72:75], v[52:55], v[216:219]
    v_mfma_f32_16x16x32_bf16 v[220:223], v[76:79], v[52:55], v[220:223]
    v_mfma_f32_16x16x32_bf16 v[224:227], v[64:67], v[56:59], v[224:227]
    v_mfma_f32_16x16x32_bf16 v[228:231], v[68:71], v[56:59], v[228:231]
    v_mfma_f32_16x16x32_bf16 v[232:235], v[72:75], v[56:59], v[232:235]
    v_mfma_f32_16x16x32_bf16 v[236:239], v[76:79], v[56:59], v[236:239]
    v_mfma_f32_16x16x32_bf16 v[240:243], v[64:67], v[60:63], v[240:243]
    v_mfma_f32_16x16x32_bf16 v[244:247], v[68:71], v[60:63], v[244:247]
    v_mfma_f32_16x16x32_bf16 v[248:251], v[72:75], v[60:63], v[248:251]
    v_mfma_f32_16x16x32_bf16 v[252:255], v[76:79], v[60:63], v[252:255]
    s_waitcnt lgkmcnt(0)
    v_mfma_f32_16x16x32_bf16 v[128:131], v[112:115], v[80:83], v[128:131]
    v_mfma_f32_16x16x32_bf16 v[132:135], v[116:119], v[80:83], v[132:135]
    v_mfma_f32_16x16x32_bf16 v[136:139], v[120:123], v[80:83], v[136:139]
    v_mfma_f32_16x16x32_bf16 v[140:143], v[124:127], v[80:83], v[140:143]
    v_mfma_f32_16x16x32_bf16 v[144:147], v[112:115], v[84:87], v[144:147]
    v_mfma_f32_16x16x32_bf16 v[148:151], v[116:119], v[84:87], v[148:151]
    v_mfma_f32_16x16x32_bf16 v[152:155], v[120:123], v[84:87], v[152:155]
    v_mfma_f32_16x16x32_bf16 v[156:159], v[124:127], v[84:87], v[156:159]
    v_mfma_f32_16x16x32_bf16 v[160:163], v[112:115], v[88:91], v[160:163]
    v_mfma_f32_16x16x32_bf16 v[164:167], v[116:119], v[88:91], v[164:167]
    v_mfma_f32_16x16x32_bf16 v[168:171], v[120:123], v[88:91], v[168:171]
    v_mfma_f32_16x16x32_bf16 v[172:175], v[124:127], v[88:91], v[172:175]
    v_mfma_f32_16x16x32_bf16 v[176:179], v[112:115], v[92:95], v[176:179]
    v_mfma_f32_16x16x32_bf16 v[180:183], v[116:119], v[92:95], v[180:183]
    v_mfma_f32_16x16x32_bf16 v[184:187], v[120:123], v[92:95], v[184:187]
    v_mfma_f32_16x16x32_bf16 v[188:191], v[124:127], v[92:95], v[188:191]
    v_mfma_f32_16x16x32_bf16 v[192:195], v[112:115], v[96:99], v[192:195]
    v_mfma_f32_16x16x32_bf16 v[196:199], v[116:119], v[96:99], v[196:199]
    v_mfma_f32_16x16x32_bf16 v[200:203], v[120:123], v[96:99], v[200:203]
    v_mfma_f32_16x16x32_bf16 v[204:207], v[124:127], v[96:99], v[204:207]
    v_mfma_f32_16x16x32_bf16 v[208:211], v[112:115], v[100:103], v[208:211]
    v_mfma_f32_16x16x32_bf16 v[212:215], v[116:119], v[100:103], v[212:215]
    v_mfma_f32_16x16x32_bf16 v[216:219], v[120:123], v[100:103], v[216:219]
    v_mfma_f32_16x16x32_bf16 v[220:223], v[124:127], v[100:103], v[220:223]
    v_mfma_f32_16x16x32_bf16 v[224:227], v[112:115], v[104:107], v[224:227]
    v_mfma_f32_16x16x32_bf16 v[228:231], v[116:119], v[104:107], v[228:231]
    v_mfma_f32_16x16x32_bf16 v[232:235], v[120:123], v[104:107], v[232:235]
    v_mfma_f32_16x16x32_bf16 v[236:239], v[124:127], v[104:107], v[236:239]
    v_mfma_f32_16x16x32_bf16 v[240:243], v[112:115], v[108:111], v[240:243]
    v_mfma_f32_16x16x32_bf16 v[244:247], v[116:119], v[108:111], v[244:247]
    v_mfma_f32_16x16x32_bf16 v[248:251], v[120:123], v[108:111], v[248:251]
    v_mfma_f32_16x16x32_bf16 v[252:255], v[124:127], v[108:111], v[252:255]
    s_waitcnt vmcnt(0)
    s_barrier
    s_add_u32 m0, s26, 0
    s_add_u32 s32, s20, 8192
    buffer_load_dwordx4 v1, s[40:43], s32 offen lds
    buffer_load_dwordx4 v1, s[40:43], s32 offen offset:1024 lds

    s_add_u32 m0, s27, 0
    s_add_u32 s32, s21, 8192
    buffer_load_dwordx4 v1, s[40:43], s32 offen lds
    buffer_load_dwordx4 v1, s[40:43], s32 offen offset:1024 lds

    s_add_u32 m0, s28, 0
    s_add_u32 s32, s22, 8192
    buffer_load_dwordx4 v1, s[40:43], s32 offen lds
    buffer_load_dwordx4 v1, s[40:43], s32 offen offset:1024 lds

    s_add_u32 m0, s29, 0
    s_add_u32 s32, s23, 8192
    buffer_load_dwordx4 v1, s[40:43], s32 offen lds
    buffer_load_dwordx4 v1, s[40:43], s32 offen offset:1024 lds

    s_add_u32 m0, s30, 0
    s_add_u32 s32, s24, 8192
    buffer_load_dwordx4 v1, s[40:43], s32 offen lds
    buffer_load_dwordx4 v1, s[40:43], s32 offen offset:1024 lds

    s_add_u32 m0, s31, 0
    s_add_u32 s32, s25, 8192
    buffer_load_dwordx4 v1, s[40:43], s32 offen lds
    buffer_load_dwordx4 v1, s[40:43], s32 offen offset:1024 lds

    ds_read_b128 v[32:35], v3 offset:49152
    ds_read_b128 v[36:39], v3 offset:51200
    ds_read_b128 v[40:43], v3 offset:53248
    ds_read_b128 v[44:47], v3 offset:55296
    ds_read_b128 v[48:51], v3 offset:57344
    ds_read_b128 v[52:55], v3 offset:59392
    ds_read_b128 v[56:59], v3 offset:61440
    ds_read_b128 v[60:63], v3 offset:63488
    ds_read_b128 v[64:67], v4 offset:49152
    ds_read_b128 v[68:71], v4 offset:51200
    ds_read_b128 v[72:75], v4 offset:53248
    ds_read_b128 v[76:79], v4 offset:55296
    ds_read_b128 v[80:83], v3 offset:50176
    ds_read_b128 v[84:87], v3 offset:52224
    ds_read_b128 v[88:91], v3 offset:54272
    ds_read_b128 v[92:95], v3 offset:56320
    ds_read_b128 v[96:99], v3 offset:58368
    ds_read_b128 v[100:103], v3 offset:60416
    ds_read_b128 v[104:107], v3 offset:62464
    ds_read_b128 v[108:111], v3 offset:64512
    ds_read_b128 v[112:115], v4 offset:50176
    ds_read_b128 v[116:119], v4 offset:52224
    ds_read_b128 v[120:123], v4 offset:54272
    ds_read_b128 v[124:127], v4 offset:56320
    s_waitcnt lgkmcnt(12)
    v_mfma_f32_16x16x32_bf16 v[128:131], v[64:67], v[32:35], v[128:131]
    v_mfma_f32_16x16x32_bf16 v[132:135], v[68:71], v[32:35], v[132:135]
    v_mfma_f32_16x16x32_bf16 v[136:139], v[72:75], v[32:35], v[136:139]
    v_mfma_f32_16x16x32_bf16 v[140:143], v[76:79], v[32:35], v[140:143]
    v_mfma_f32_16x16x32_bf16 v[144:147], v[64:67], v[36:39], v[144:147]
    v_mfma_f32_16x16x32_bf16 v[148:151], v[68:71], v[36:39], v[148:151]
    v_mfma_f32_16x16x32_bf16 v[152:155], v[72:75], v[36:39], v[152:155]
    v_mfma_f32_16x16x32_bf16 v[156:159], v[76:79], v[36:39], v[156:159]
    v_mfma_f32_16x16x32_bf16 v[160:163], v[64:67], v[40:43], v[160:163]
    v_mfma_f32_16x16x32_bf16 v[164:167], v[68:71], v[40:43], v[164:167]
    v_mfma_f32_16x16x32_bf16 v[168:171], v[72:75], v[40:43], v[168:171]
    v_mfma_f32_16x16x32_bf16 v[172:175], v[76:79], v[40:43], v[172:175]
    v_mfma_f32_16x16x32_bf16 v[176:179], v[64:67], v[44:47], v[176:179]
    v_mfma_f32_16x16x32_bf16 v[180:183], v[68:71], v[44:47], v[180:183]
    v_mfma_f32_16x16x32_bf16 v[184:187], v[72:75], v[44:47], v[184:187]
    v_mfma_f32_16x16x32_bf16 v[188:191], v[76:79], v[44:47], v[188:191]
    v_mfma_f32_16x16x32_bf16 v[192:195], v[64:67], v[48:51], v[192:195]
    v_mfma_f32_16x16x32_bf16 v[196:199], v[68:71], v[48:51], v[196:199]
    v_mfma_f32_16x16x32_bf16 v[200:203], v[72:75], v[48:51], v[200:203]
    v_mfma_f32_16x16x32_bf16 v[204:207], v[76:79], v[48:51], v[204:207]
    v_mfma_f32_16x16x32_bf16 v[208:211], v[64:67], v[52:55], v[208:211]
    v_mfma_f32_16x16x32_bf16 v[212:215], v[68:71], v[52:55], v[212:215]
    v_mfma_f32_16x16x32_bf16 v[216:219], v[72:75], v[52:55], v[216:219]
    v_mfma_f32_16x16x32_bf16 v[220:223], v[76:79], v[52:55], v[220:223]
    v_mfma_f32_16x16x32_bf16 v[224:227], v[64:67], v[56:59], v[224:227]
    v_mfma_f32_16x16x32_bf16 v[228:231], v[68:71], v[56:59], v[228:231]
    v_mfma_f32_16x16x32_bf16 v[232:235], v[72:75], v[56:59], v[232:235]
    v_mfma_f32_16x16x32_bf16 v[236:239], v[76:79], v[56:59], v[236:239]
    v_mfma_f32_16x16x32_bf16 v[240:243], v[64:67], v[60:63], v[240:243]
    v_mfma_f32_16x16x32_bf16 v[244:247], v[68:71], v[60:63], v[244:247]
    v_mfma_f32_16x16x32_bf16 v[248:251], v[72:75], v[60:63], v[248:251]
    v_mfma_f32_16x16x32_bf16 v[252:255], v[76:79], v[60:63], v[252:255]
    s_waitcnt lgkmcnt(0)
    v_mfma_f32_16x16x32_bf16 v[128:131], v[112:115], v[80:83], v[128:131]
    v_mfma_f32_16x16x32_bf16 v[132:135], v[116:119], v[80:83], v[132:135]
    v_mfma_f32_16x16x32_bf16 v[136:139], v[120:123], v[80:83], v[136:139]
    v_mfma_f32_16x16x32_bf16 v[140:143], v[124:127], v[80:83], v[140:143]
    v_mfma_f32_16x16x32_bf16 v[144:147], v[112:115], v[84:87], v[144:147]
    v_mfma_f32_16x16x32_bf16 v[148:151], v[116:119], v[84:87], v[148:151]
    v_mfma_f32_16x16x32_bf16 v[152:155], v[120:123], v[84:87], v[152:155]
    v_mfma_f32_16x16x32_bf16 v[156:159], v[124:127], v[84:87], v[156:159]
    v_mfma_f32_16x16x32_bf16 v[160:163], v[112:115], v[88:91], v[160:163]
    v_mfma_f32_16x16x32_bf16 v[164:167], v[116:119], v[88:91], v[164:167]
    v_mfma_f32_16x16x32_bf16 v[168:171], v[120:123], v[88:91], v[168:171]
    v_mfma_f32_16x16x32_bf16 v[172:175], v[124:127], v[88:91], v[172:175]
    v_mfma_f32_16x16x32_bf16 v[176:179], v[112:115], v[92:95], v[176:179]
    v_mfma_f32_16x16x32_bf16 v[180:183], v[116:119], v[92:95], v[180:183]
    v_mfma_f32_16x16x32_bf16 v[184:187], v[120:123], v[92:95], v[184:187]
    v_mfma_f32_16x16x32_bf16 v[188:191], v[124:127], v[92:95], v[188:191]
    v_mfma_f32_16x16x32_bf16 v[192:195], v[112:115], v[96:99], v[192:195]
    v_mfma_f32_16x16x32_bf16 v[196:199], v[116:119], v[96:99], v[196:199]
    v_mfma_f32_16x16x32_bf16 v[200:203], v[120:123], v[96:99], v[200:203]
    v_mfma_f32_16x16x32_bf16 v[204:207], v[124:127], v[96:99], v[204:207]
    v_mfma_f32_16x16x32_bf16 v[208:211], v[112:115], v[100:103], v[208:211]
    v_mfma_f32_16x16x32_bf16 v[212:215], v[116:119], v[100:103], v[212:215]
    v_mfma_f32_16x16x32_bf16 v[216:219], v[120:123], v[100:103], v[216:219]
    v_mfma_f32_16x16x32_bf16 v[220:223], v[124:127], v[100:103], v[220:223]
    v_mfma_f32_16x16x32_bf16 v[224:227], v[112:115], v[104:107], v[224:227]
    v_mfma_f32_16x16x32_bf16 v[228:231], v[116:119], v[104:107], v[228:231]
    v_mfma_f32_16x16x32_bf16 v[232:235], v[120:123], v[104:107], v[232:235]
    v_mfma_f32_16x16x32_bf16 v[236:239], v[124:127], v[104:107], v[236:239]
    v_mfma_f32_16x16x32_bf16 v[240:243], v[112:115], v[108:111], v[240:243]
    v_mfma_f32_16x16x32_bf16 v[244:247], v[116:119], v[108:111], v[244:247]
    v_mfma_f32_16x16x32_bf16 v[248:251], v[120:123], v[108:111], v[248:251]
    v_mfma_f32_16x16x32_bf16 v[252:255], v[124:127], v[108:111], v[252:255]
    s_waitcnt vmcnt(0)
    s_barrier
    s_add_u32 m0, s26, 49152
    s_add_u32 s32, s20, 10240
    buffer_load_dwordx4 v1, s[40:43], s32 offen lds
    buffer_load_dwordx4 v1, s[40:43], s32 offen offset:1024 lds

    s_add_u32 m0, s27, 49152
    s_add_u32 s32, s21, 10240
    buffer_load_dwordx4 v1, s[40:43], s32 offen lds
    buffer_load_dwordx4 v1, s[40:43], s32 offen offset:1024 lds

    s_add_u32 m0, s28, 49152
    s_add_u32 s32, s22, 10240
    buffer_load_dwordx4 v1, s[40:43], s32 offen lds
    buffer_load_dwordx4 v1, s[40:43], s32 offen offset:1024 lds

    s_add_u32 m0, s29, 49152
    s_add_u32 s32, s23, 10240
    buffer_load_dwordx4 v1, s[40:43], s32 offen lds
    buffer_load_dwordx4 v1, s[40:43], s32 offen offset:1024 lds

    s_add_u32 m0, s30, 49152
    s_add_u32 s32, s24, 10240
    buffer_load_dwordx4 v1, s[40:43], s32 offen lds
    buffer_load_dwordx4 v1, s[40:43], s32 offen offset:1024 lds

    s_add_u32 m0, s31, 49152
    s_add_u32 s32, s25, 10240
    buffer_load_dwordx4 v1, s[40:43], s32 offen lds
    buffer_load_dwordx4 v1, s[40:43], s32 offen offset:1024 lds

    ds_read_b128 v[32:35], v3 offset:0
    ds_read_b128 v[36:39], v3 offset:2048
    ds_read_b128 v[40:43], v3 offset:4096
    ds_read_b128 v[44:47], v3 offset:6144
    ds_read_b128 v[48:51], v3 offset:8192
    ds_read_b128 v[52:55], v3 offset:10240
    ds_read_b128 v[56:59], v3 offset:12288
    ds_read_b128 v[60:63], v3 offset:14336
    ds_read_b128 v[64:67], v4 offset:0
    ds_read_b128 v[68:71], v4 offset:2048
    ds_read_b128 v[72:75], v4 offset:4096
    ds_read_b128 v[76:79], v4 offset:6144
    ds_read_b128 v[80:83], v3 offset:1024
    ds_read_b128 v[84:87], v3 offset:3072
    ds_read_b128 v[88:91], v3 offset:5120
    ds_read_b128 v[92:95], v3 offset:7168
    ds_read_b128 v[96:99], v3 offset:9216
    ds_read_b128 v[100:103], v3 offset:11264
    ds_read_b128 v[104:107], v3 offset:13312
    ds_read_b128 v[108:111], v3 offset:15360
    ds_read_b128 v[112:115], v4 offset:1024
    ds_read_b128 v[116:119], v4 offset:3072
    ds_read_b128 v[120:123], v4 offset:5120
    ds_read_b128 v[124:127], v4 offset:7168
    s_waitcnt lgkmcnt(12)
    v_mfma_f32_16x16x32_bf16 v[128:131], v[64:67], v[32:35], v[128:131]
    v_mfma_f32_16x16x32_bf16 v[132:135], v[68:71], v[32:35], v[132:135]
    v_mfma_f32_16x16x32_bf16 v[136:139], v[72:75], v[32:35], v[136:139]
    v_mfma_f32_16x16x32_bf16 v[140:143], v[76:79], v[32:35], v[140:143]
    v_mfma_f32_16x16x32_bf16 v[144:147], v[64:67], v[36:39], v[144:147]
    v_mfma_f32_16x16x32_bf16 v[148:151], v[68:71], v[36:39], v[148:151]
    v_mfma_f32_16x16x32_bf16 v[152:155], v[72:75], v[36:39], v[152:155]
    v_mfma_f32_16x16x32_bf16 v[156:159], v[76:79], v[36:39], v[156:159]
    v_mfma_f32_16x16x32_bf16 v[160:163], v[64:67], v[40:43], v[160:163]
    v_mfma_f32_16x16x32_bf16 v[164:167], v[68:71], v[40:43], v[164:167]
    v_mfma_f32_16x16x32_bf16 v[168:171], v[72:75], v[40:43], v[168:171]
    v_mfma_f32_16x16x32_bf16 v[172:175], v[76:79], v[40:43], v[172:175]
    v_mfma_f32_16x16x32_bf16 v[176:179], v[64:67], v[44:47], v[176:179]
    v_mfma_f32_16x16x32_bf16 v[180:183], v[68:71], v[44:47], v[180:183]
    v_mfma_f32_16x16x32_bf16 v[184:187], v[72:75], v[44:47], v[184:187]
    v_mfma_f32_16x16x32_bf16 v[188:191], v[76:79], v[44:47], v[188:191]
    v_mfma_f32_16x16x32_bf16 v[192:195], v[64:67], v[48:51], v[192:195]
    v_mfma_f32_16x16x32_bf16 v[196:199], v[68:71], v[48:51], v[196:199]
    v_mfma_f32_16x16x32_bf16 v[200:203], v[72:75], v[48:51], v[200:203]
    v_mfma_f32_16x16x32_bf16 v[204:207], v[76:79], v[48:51], v[204:207]
    v_mfma_f32_16x16x32_bf16 v[208:211], v[64:67], v[52:55], v[208:211]
    v_mfma_f32_16x16x32_bf16 v[212:215], v[68:71], v[52:55], v[212:215]
    v_mfma_f32_16x16x32_bf16 v[216:219], v[72:75], v[52:55], v[216:219]
    v_mfma_f32_16x16x32_bf16 v[220:223], v[76:79], v[52:55], v[220:223]
    v_mfma_f32_16x16x32_bf16 v[224:227], v[64:67], v[56:59], v[224:227]
    v_mfma_f32_16x16x32_bf16 v[228:231], v[68:71], v[56:59], v[228:231]
    v_mfma_f32_16x16x32_bf16 v[232:235], v[72:75], v[56:59], v[232:235]
    v_mfma_f32_16x16x32_bf16 v[236:239], v[76:79], v[56:59], v[236:239]
    v_mfma_f32_16x16x32_bf16 v[240:243], v[64:67], v[60:63], v[240:243]
    v_mfma_f32_16x16x32_bf16 v[244:247], v[68:71], v[60:63], v[244:247]
    v_mfma_f32_16x16x32_bf16 v[248:251], v[72:75], v[60:63], v[248:251]
    v_mfma_f32_16x16x32_bf16 v[252:255], v[76:79], v[60:63], v[252:255]
    s_waitcnt lgkmcnt(0)
    v_mfma_f32_16x16x32_bf16 v[128:131], v[112:115], v[80:83], v[128:131]
    v_mfma_f32_16x16x32_bf16 v[132:135], v[116:119], v[80:83], v[132:135]
    v_mfma_f32_16x16x32_bf16 v[136:139], v[120:123], v[80:83], v[136:139]
    v_mfma_f32_16x16x32_bf16 v[140:143], v[124:127], v[80:83], v[140:143]
    v_mfma_f32_16x16x32_bf16 v[144:147], v[112:115], v[84:87], v[144:147]
    v_mfma_f32_16x16x32_bf16 v[148:151], v[116:119], v[84:87], v[148:151]
    v_mfma_f32_16x16x32_bf16 v[152:155], v[120:123], v[84:87], v[152:155]
    v_mfma_f32_16x16x32_bf16 v[156:159], v[124:127], v[84:87], v[156:159]
    v_mfma_f32_16x16x32_bf16 v[160:163], v[112:115], v[88:91], v[160:163]
    v_mfma_f32_16x16x32_bf16 v[164:167], v[116:119], v[88:91], v[164:167]
    v_mfma_f32_16x16x32_bf16 v[168:171], v[120:123], v[88:91], v[168:171]
    v_mfma_f32_16x16x32_bf16 v[172:175], v[124:127], v[88:91], v[172:175]
    v_mfma_f32_16x16x32_bf16 v[176:179], v[112:115], v[92:95], v[176:179]
    v_mfma_f32_16x16x32_bf16 v[180:183], v[116:119], v[92:95], v[180:183]
    v_mfma_f32_16x16x32_bf16 v[184:187], v[120:123], v[92:95], v[184:187]
    v_mfma_f32_16x16x32_bf16 v[188:191], v[124:127], v[92:95], v[188:191]
    v_mfma_f32_16x16x32_bf16 v[192:195], v[112:115], v[96:99], v[192:195]
    v_mfma_f32_16x16x32_bf16 v[196:199], v[116:119], v[96:99], v[196:199]
    v_mfma_f32_16x16x32_bf16 v[200:203], v[120:123], v[96:99], v[200:203]
    v_mfma_f32_16x16x32_bf16 v[204:207], v[124:127], v[96:99], v[204:207]
    v_mfma_f32_16x16x32_bf16 v[208:211], v[112:115], v[100:103], v[208:211]
    v_mfma_f32_16x16x32_bf16 v[212:215], v[116:119], v[100:103], v[212:215]
    v_mfma_f32_16x16x32_bf16 v[216:219], v[120:123], v[100:103], v[216:219]
    v_mfma_f32_16x16x32_bf16 v[220:223], v[124:127], v[100:103], v[220:223]
    v_mfma_f32_16x16x32_bf16 v[224:227], v[112:115], v[104:107], v[224:227]
    v_mfma_f32_16x16x32_bf16 v[228:231], v[116:119], v[104:107], v[228:231]
    v_mfma_f32_16x16x32_bf16 v[232:235], v[120:123], v[104:107], v[232:235]
    v_mfma_f32_16x16x32_bf16 v[236:239], v[124:127], v[104:107], v[236:239]
    v_mfma_f32_16x16x32_bf16 v[240:243], v[112:115], v[108:111], v[240:243]
    v_mfma_f32_16x16x32_bf16 v[244:247], v[116:119], v[108:111], v[244:247]
    v_mfma_f32_16x16x32_bf16 v[248:251], v[120:123], v[108:111], v[248:251]
    v_mfma_f32_16x16x32_bf16 v[252:255], v[124:127], v[108:111], v[252:255]
    s_waitcnt vmcnt(0)
    s_barrier
    s_add_u32 m0, s26, 0
    s_add_u32 s32, s20, 12288
    buffer_load_dwordx4 v1, s[40:43], s32 offen lds
    buffer_load_dwordx4 v1, s[40:43], s32 offen offset:1024 lds

    s_add_u32 m0, s27, 0
    s_add_u32 s32, s21, 12288
    buffer_load_dwordx4 v1, s[40:43], s32 offen lds
    buffer_load_dwordx4 v1, s[40:43], s32 offen offset:1024 lds

    s_add_u32 m0, s28, 0
    s_add_u32 s32, s22, 12288
    buffer_load_dwordx4 v1, s[40:43], s32 offen lds
    buffer_load_dwordx4 v1, s[40:43], s32 offen offset:1024 lds

    s_add_u32 m0, s29, 0
    s_add_u32 s32, s23, 12288
    buffer_load_dwordx4 v1, s[40:43], s32 offen lds
    buffer_load_dwordx4 v1, s[40:43], s32 offen offset:1024 lds

    s_add_u32 m0, s30, 0
    s_add_u32 s32, s24, 12288
    buffer_load_dwordx4 v1, s[40:43], s32 offen lds
    buffer_load_dwordx4 v1, s[40:43], s32 offen offset:1024 lds

    s_add_u32 m0, s31, 0
    s_add_u32 s32, s25, 12288
    buffer_load_dwordx4 v1, s[40:43], s32 offen lds
    buffer_load_dwordx4 v1, s[40:43], s32 offen offset:1024 lds

    ds_read_b128 v[32:35], v3 offset:49152
    ds_read_b128 v[36:39], v3 offset:51200
    ds_read_b128 v[40:43], v3 offset:53248
    ds_read_b128 v[44:47], v3 offset:55296
    ds_read_b128 v[48:51], v3 offset:57344
    ds_read_b128 v[52:55], v3 offset:59392
    ds_read_b128 v[56:59], v3 offset:61440
    ds_read_b128 v[60:63], v3 offset:63488
    ds_read_b128 v[64:67], v4 offset:49152
    ds_read_b128 v[68:71], v4 offset:51200
    ds_read_b128 v[72:75], v4 offset:53248
    ds_read_b128 v[76:79], v4 offset:55296
    ds_read_b128 v[80:83], v3 offset:50176
    ds_read_b128 v[84:87], v3 offset:52224
    ds_read_b128 v[88:91], v3 offset:54272
    ds_read_b128 v[92:95], v3 offset:56320
    ds_read_b128 v[96:99], v3 offset:58368
    ds_read_b128 v[100:103], v3 offset:60416
    ds_read_b128 v[104:107], v3 offset:62464
    ds_read_b128 v[108:111], v3 offset:64512
    ds_read_b128 v[112:115], v4 offset:50176
    ds_read_b128 v[116:119], v4 offset:52224
    ds_read_b128 v[120:123], v4 offset:54272
    ds_read_b128 v[124:127], v4 offset:56320
    s_waitcnt lgkmcnt(12)
    v_mfma_f32_16x16x32_bf16 v[128:131], v[64:67], v[32:35], v[128:131]
    v_mfma_f32_16x16x32_bf16 v[132:135], v[68:71], v[32:35], v[132:135]
    v_mfma_f32_16x16x32_bf16 v[136:139], v[72:75], v[32:35], v[136:139]
    v_mfma_f32_16x16x32_bf16 v[140:143], v[76:79], v[32:35], v[140:143]
    v_mfma_f32_16x16x32_bf16 v[144:147], v[64:67], v[36:39], v[144:147]
    v_mfma_f32_16x16x32_bf16 v[148:151], v[68:71], v[36:39], v[148:151]
    v_mfma_f32_16x16x32_bf16 v[152:155], v[72:75], v[36:39], v[152:155]
    v_mfma_f32_16x16x32_bf16 v[156:159], v[76:79], v[36:39], v[156:159]
    v_mfma_f32_16x16x32_bf16 v[160:163], v[64:67], v[40:43], v[160:163]
    v_mfma_f32_16x16x32_bf16 v[164:167], v[68:71], v[40:43], v[164:167]
    v_mfma_f32_16x16x32_bf16 v[168:171], v[72:75], v[40:43], v[168:171]
    v_mfma_f32_16x16x32_bf16 v[172:175], v[76:79], v[40:43], v[172:175]
    v_mfma_f32_16x16x32_bf16 v[176:179], v[64:67], v[44:47], v[176:179]
    v_mfma_f32_16x16x32_bf16 v[180:183], v[68:71], v[44:47], v[180:183]
    v_mfma_f32_16x16x32_bf16 v[184:187], v[72:75], v[44:47], v[184:187]
    v_mfma_f32_16x16x32_bf16 v[188:191], v[76:79], v[44:47], v[188:191]
    v_mfma_f32_16x16x32_bf16 v[192:195], v[64:67], v[48:51], v[192:195]
    v_mfma_f32_16x16x32_bf16 v[196:199], v[68:71], v[48:51], v[196:199]
    v_mfma_f32_16x16x32_bf16 v[200:203], v[72:75], v[48:51], v[200:203]
    v_mfma_f32_16x16x32_bf16 v[204:207], v[76:79], v[48:51], v[204:207]
    v_mfma_f32_16x16x32_bf16 v[208:211], v[64:67], v[52:55], v[208:211]
    v_mfma_f32_16x16x32_bf16 v[212:215], v[68:71], v[52:55], v[212:215]
    v_mfma_f32_16x16x32_bf16 v[216:219], v[72:75], v[52:55], v[216:219]
    v_mfma_f32_16x16x32_bf16 v[220:223], v[76:79], v[52:55], v[220:223]
    v_mfma_f32_16x16x32_bf16 v[224:227], v[64:67], v[56:59], v[224:227]
    v_mfma_f32_16x16x32_bf16 v[228:231], v[68:71], v[56:59], v[228:231]
    v_mfma_f32_16x16x32_bf16 v[232:235], v[72:75], v[56:59], v[232:235]
    v_mfma_f32_16x16x32_bf16 v[236:239], v[76:79], v[56:59], v[236:239]
    v_mfma_f32_16x16x32_bf16 v[240:243], v[64:67], v[60:63], v[240:243]
    v_mfma_f32_16x16x32_bf16 v[244:247], v[68:71], v[60:63], v[244:247]
    v_mfma_f32_16x16x32_bf16 v[248:251], v[72:75], v[60:63], v[248:251]
    v_mfma_f32_16x16x32_bf16 v[252:255], v[76:79], v[60:63], v[252:255]
    s_waitcnt lgkmcnt(0)
    v_mfma_f32_16x16x32_bf16 v[128:131], v[112:115], v[80:83], v[128:131]
    v_mfma_f32_16x16x32_bf16 v[132:135], v[116:119], v[80:83], v[132:135]
    v_mfma_f32_16x16x32_bf16 v[136:139], v[120:123], v[80:83], v[136:139]
    v_mfma_f32_16x16x32_bf16 v[140:143], v[124:127], v[80:83], v[140:143]
    v_mfma_f32_16x16x32_bf16 v[144:147], v[112:115], v[84:87], v[144:147]
    v_mfma_f32_16x16x32_bf16 v[148:151], v[116:119], v[84:87], v[148:151]
    v_mfma_f32_16x16x32_bf16 v[152:155], v[120:123], v[84:87], v[152:155]
    v_mfma_f32_16x16x32_bf16 v[156:159], v[124:127], v[84:87], v[156:159]
    v_mfma_f32_16x16x32_bf16 v[160:163], v[112:115], v[88:91], v[160:163]
    v_mfma_f32_16x16x32_bf16 v[164:167], v[116:119], v[88:91], v[164:167]
    v_mfma_f32_16x16x32_bf16 v[168:171], v[120:123], v[88:91], v[168:171]
    v_mfma_f32_16x16x32_bf16 v[172:175], v[124:127], v[88:91], v[172:175]
    v_mfma_f32_16x16x32_bf16 v[176:179], v[112:115], v[92:95], v[176:179]
    v_mfma_f32_16x16x32_bf16 v[180:183], v[116:119], v[92:95], v[180:183]
    v_mfma_f32_16x16x32_bf16 v[184:187], v[120:123], v[92:95], v[184:187]
    v_mfma_f32_16x16x32_bf16 v[188:191], v[124:127], v[92:95], v[188:191]
    v_mfma_f32_16x16x32_bf16 v[192:195], v[112:115], v[96:99], v[192:195]
    v_mfma_f32_16x16x32_bf16 v[196:199], v[116:119], v[96:99], v[196:199]
    v_mfma_f32_16x16x32_bf16 v[200:203], v[120:123], v[96:99], v[200:203]
    v_mfma_f32_16x16x32_bf16 v[204:207], v[124:127], v[96:99], v[204:207]
    v_mfma_f32_16x16x32_bf16 v[208:211], v[112:115], v[100:103], v[208:211]
    v_mfma_f32_16x16x32_bf16 v[212:215], v[116:119], v[100:103], v[212:215]
    v_mfma_f32_16x16x32_bf16 v[216:219], v[120:123], v[100:103], v[216:219]
    v_mfma_f32_16x16x32_bf16 v[220:223], v[124:127], v[100:103], v[220:223]
    v_mfma_f32_16x16x32_bf16 v[224:227], v[112:115], v[104:107], v[224:227]
    v_mfma_f32_16x16x32_bf16 v[228:231], v[116:119], v[104:107], v[228:231]
    v_mfma_f32_16x16x32_bf16 v[232:235], v[120:123], v[104:107], v[232:235]
    v_mfma_f32_16x16x32_bf16 v[236:239], v[124:127], v[104:107], v[236:239]
    v_mfma_f32_16x16x32_bf16 v[240:243], v[112:115], v[108:111], v[240:243]
    v_mfma_f32_16x16x32_bf16 v[244:247], v[116:119], v[108:111], v[244:247]
    v_mfma_f32_16x16x32_bf16 v[248:251], v[120:123], v[108:111], v[248:251]
    v_mfma_f32_16x16x32_bf16 v[252:255], v[124:127], v[108:111], v[252:255]
    s_waitcnt vmcnt(0)
    s_barrier
    s_add_u32 m0, s26, 49152
    s_add_u32 s32, s20, 14336
    buffer_load_dwordx4 v1, s[40:43], s32 offen lds
    buffer_load_dwordx4 v1, s[40:43], s32 offen offset:1024 lds

    s_add_u32 m0, s27, 49152
    s_add_u32 s32, s21, 14336
    buffer_load_dwordx4 v1, s[40:43], s32 offen lds
    buffer_load_dwordx4 v1, s[40:43], s32 offen offset:1024 lds

    s_add_u32 m0, s28, 49152
    s_add_u32 s32, s22, 14336
    buffer_load_dwordx4 v1, s[40:43], s32 offen lds
    buffer_load_dwordx4 v1, s[40:43], s32 offen offset:1024 lds

    s_add_u32 m0, s29, 49152
    s_add_u32 s32, s23, 14336
    buffer_load_dwordx4 v1, s[40:43], s32 offen lds
    buffer_load_dwordx4 v1, s[40:43], s32 offen offset:1024 lds

    s_add_u32 m0, s30, 49152
    s_add_u32 s32, s24, 14336
    buffer_load_dwordx4 v1, s[40:43], s32 offen lds
    buffer_load_dwordx4 v1, s[40:43], s32 offen offset:1024 lds

    s_add_u32 m0, s31, 49152
    s_add_u32 s32, s25, 14336
    buffer_load_dwordx4 v1, s[40:43], s32 offen lds
    buffer_load_dwordx4 v1, s[40:43], s32 offen offset:1024 lds

    ds_read_b128 v[32:35], v3 offset:0
    ds_read_b128 v[36:39], v3 offset:2048
    ds_read_b128 v[40:43], v3 offset:4096
    ds_read_b128 v[44:47], v3 offset:6144
    ds_read_b128 v[48:51], v3 offset:8192
    ds_read_b128 v[52:55], v3 offset:10240
    ds_read_b128 v[56:59], v3 offset:12288
    ds_read_b128 v[60:63], v3 offset:14336
    ds_read_b128 v[64:67], v4 offset:0
    ds_read_b128 v[68:71], v4 offset:2048
    ds_read_b128 v[72:75], v4 offset:4096
    ds_read_b128 v[76:79], v4 offset:6144
    ds_read_b128 v[80:83], v3 offset:1024
    ds_read_b128 v[84:87], v3 offset:3072
    ds_read_b128 v[88:91], v3 offset:5120
    ds_read_b128 v[92:95], v3 offset:7168
    ds_read_b128 v[96:99], v3 offset:9216
    ds_read_b128 v[100:103], v3 offset:11264
    ds_read_b128 v[104:107], v3 offset:13312
    ds_read_b128 v[108:111], v3 offset:15360
    ds_read_b128 v[112:115], v4 offset:1024
    ds_read_b128 v[116:119], v4 offset:3072
    ds_read_b128 v[120:123], v4 offset:5120
    ds_read_b128 v[124:127], v4 offset:7168
    s_waitcnt lgkmcnt(12)
    v_mfma_f32_16x16x32_bf16 v[128:131], v[64:67], v[32:35], v[128:131]
    v_mfma_f32_16x16x32_bf16 v[132:135], v[68:71], v[32:35], v[132:135]
    v_mfma_f32_16x16x32_bf16 v[136:139], v[72:75], v[32:35], v[136:139]
    v_mfma_f32_16x16x32_bf16 v[140:143], v[76:79], v[32:35], v[140:143]
    v_mfma_f32_16x16x32_bf16 v[144:147], v[64:67], v[36:39], v[144:147]
    v_mfma_f32_16x16x32_bf16 v[148:151], v[68:71], v[36:39], v[148:151]
    v_mfma_f32_16x16x32_bf16 v[152:155], v[72:75], v[36:39], v[152:155]
    v_mfma_f32_16x16x32_bf16 v[156:159], v[76:79], v[36:39], v[156:159]
    v_mfma_f32_16x16x32_bf16 v[160:163], v[64:67], v[40:43], v[160:163]
    v_mfma_f32_16x16x32_bf16 v[164:167], v[68:71], v[40:43], v[164:167]
    v_mfma_f32_16x16x32_bf16 v[168:171], v[72:75], v[40:43], v[168:171]
    v_mfma_f32_16x16x32_bf16 v[172:175], v[76:79], v[40:43], v[172:175]
    v_mfma_f32_16x16x32_bf16 v[176:179], v[64:67], v[44:47], v[176:179]
    v_mfma_f32_16x16x32_bf16 v[180:183], v[68:71], v[44:47], v[180:183]
    v_mfma_f32_16x16x32_bf16 v[184:187], v[72:75], v[44:47], v[184:187]
    v_mfma_f32_16x16x32_bf16 v[188:191], v[76:79], v[44:47], v[188:191]
    v_mfma_f32_16x16x32_bf16 v[192:195], v[64:67], v[48:51], v[192:195]
    v_mfma_f32_16x16x32_bf16 v[196:199], v[68:71], v[48:51], v[196:199]
    v_mfma_f32_16x16x32_bf16 v[200:203], v[72:75], v[48:51], v[200:203]
    v_mfma_f32_16x16x32_bf16 v[204:207], v[76:79], v[48:51], v[204:207]
    v_mfma_f32_16x16x32_bf16 v[208:211], v[64:67], v[52:55], v[208:211]
    v_mfma_f32_16x16x32_bf16 v[212:215], v[68:71], v[52:55], v[212:215]
    v_mfma_f32_16x16x32_bf16 v[216:219], v[72:75], v[52:55], v[216:219]
    v_mfma_f32_16x16x32_bf16 v[220:223], v[76:79], v[52:55], v[220:223]
    v_mfma_f32_16x16x32_bf16 v[224:227], v[64:67], v[56:59], v[224:227]
    v_mfma_f32_16x16x32_bf16 v[228:231], v[68:71], v[56:59], v[228:231]
    v_mfma_f32_16x16x32_bf16 v[232:235], v[72:75], v[56:59], v[232:235]
    v_mfma_f32_16x16x32_bf16 v[236:239], v[76:79], v[56:59], v[236:239]
    v_mfma_f32_16x16x32_bf16 v[240:243], v[64:67], v[60:63], v[240:243]
    v_mfma_f32_16x16x32_bf16 v[244:247], v[68:71], v[60:63], v[244:247]
    v_mfma_f32_16x16x32_bf16 v[248:251], v[72:75], v[60:63], v[248:251]
    v_mfma_f32_16x16x32_bf16 v[252:255], v[76:79], v[60:63], v[252:255]
    s_waitcnt lgkmcnt(0)
    v_mfma_f32_16x16x32_bf16 v[128:131], v[112:115], v[80:83], v[128:131]
    v_mfma_f32_16x16x32_bf16 v[132:135], v[116:119], v[80:83], v[132:135]
    v_mfma_f32_16x16x32_bf16 v[136:139], v[120:123], v[80:83], v[136:139]
    v_mfma_f32_16x16x32_bf16 v[140:143], v[124:127], v[80:83], v[140:143]
    v_mfma_f32_16x16x32_bf16 v[144:147], v[112:115], v[84:87], v[144:147]
    v_mfma_f32_16x16x32_bf16 v[148:151], v[116:119], v[84:87], v[148:151]
    v_mfma_f32_16x16x32_bf16 v[152:155], v[120:123], v[84:87], v[152:155]
    v_mfma_f32_16x16x32_bf16 v[156:159], v[124:127], v[84:87], v[156:159]
    v_mfma_f32_16x16x32_bf16 v[160:163], v[112:115], v[88:91], v[160:163]
    v_mfma_f32_16x16x32_bf16 v[164:167], v[116:119], v[88:91], v[164:167]
    v_mfma_f32_16x16x32_bf16 v[168:171], v[120:123], v[88:91], v[168:171]
    v_mfma_f32_16x16x32_bf16 v[172:175], v[124:127], v[88:91], v[172:175]
    v_mfma_f32_16x16x32_bf16 v[176:179], v[112:115], v[92:95], v[176:179]
    v_mfma_f32_16x16x32_bf16 v[180:183], v[116:119], v[92:95], v[180:183]
    v_mfma_f32_16x16x32_bf16 v[184:187], v[120:123], v[92:95], v[184:187]
    v_mfma_f32_16x16x32_bf16 v[188:191], v[124:127], v[92:95], v[188:191]
    v_mfma_f32_16x16x32_bf16 v[192:195], v[112:115], v[96:99], v[192:195]
    v_mfma_f32_16x16x32_bf16 v[196:199], v[116:119], v[96:99], v[196:199]
    v_mfma_f32_16x16x32_bf16 v[200:203], v[120:123], v[96:99], v[200:203]
    v_mfma_f32_16x16x32_bf16 v[204:207], v[124:127], v[96:99], v[204:207]
    v_mfma_f32_16x16x32_bf16 v[208:211], v[112:115], v[100:103], v[208:211]
    v_mfma_f32_16x16x32_bf16 v[212:215], v[116:119], v[100:103], v[212:215]
    v_mfma_f32_16x16x32_bf16 v[216:219], v[120:123], v[100:103], v[216:219]
    v_mfma_f32_16x16x32_bf16 v[220:223], v[124:127], v[100:103], v[220:223]
    v_mfma_f32_16x16x32_bf16 v[224:227], v[112:115], v[104:107], v[224:227]
    v_mfma_f32_16x16x32_bf16 v[228:231], v[116:119], v[104:107], v[228:231]
    v_mfma_f32_16x16x32_bf16 v[232:235], v[120:123], v[104:107], v[232:235]
    v_mfma_f32_16x16x32_bf16 v[236:239], v[124:127], v[104:107], v[236:239]
    v_mfma_f32_16x16x32_bf16 v[240:243], v[112:115], v[108:111], v[240:243]
    v_mfma_f32_16x16x32_bf16 v[244:247], v[116:119], v[108:111], v[244:247]
    v_mfma_f32_16x16x32_bf16 v[248:251], v[120:123], v[108:111], v[248:251]
    v_mfma_f32_16x16x32_bf16 v[252:255], v[124:127], v[108:111], v[252:255]
    s_waitcnt vmcnt(0)
    s_barrier
    ds_read_b128 v[32:35], v3 offset:49152
    ds_read_b128 v[36:39], v3 offset:51200
    ds_read_b128 v[40:43], v3 offset:53248
    ds_read_b128 v[44:47], v3 offset:55296
    ds_read_b128 v[48:51], v3 offset:57344
    ds_read_b128 v[52:55], v3 offset:59392
    ds_read_b128 v[56:59], v3 offset:61440
    ds_read_b128 v[60:63], v3 offset:63488
    ds_read_b128 v[64:67], v4 offset:49152
    ds_read_b128 v[68:71], v4 offset:51200
    ds_read_b128 v[72:75], v4 offset:53248
    ds_read_b128 v[76:79], v4 offset:55296
    ds_read_b128 v[80:83], v3 offset:50176
    ds_read_b128 v[84:87], v3 offset:52224
    ds_read_b128 v[88:91], v3 offset:54272
    ds_read_b128 v[92:95], v3 offset:56320
    ds_read_b128 v[96:99], v3 offset:58368
    ds_read_b128 v[100:103], v3 offset:60416
    ds_read_b128 v[104:107], v3 offset:62464
    ds_read_b128 v[108:111], v3 offset:64512
    ds_read_b128 v[112:115], v4 offset:50176
    ds_read_b128 v[116:119], v4 offset:52224
    ds_read_b128 v[120:123], v4 offset:54272
    ds_read_b128 v[124:127], v4 offset:56320
    s_waitcnt lgkmcnt(12)
    v_mfma_f32_16x16x32_bf16 v[128:131], v[64:67], v[32:35], v[128:131]
    v_mfma_f32_16x16x32_bf16 v[132:135], v[68:71], v[32:35], v[132:135]
    v_mfma_f32_16x16x32_bf16 v[136:139], v[72:75], v[32:35], v[136:139]
    v_mfma_f32_16x16x32_bf16 v[140:143], v[76:79], v[32:35], v[140:143]
    v_mfma_f32_16x16x32_bf16 v[144:147], v[64:67], v[36:39], v[144:147]
    v_mfma_f32_16x16x32_bf16 v[148:151], v[68:71], v[36:39], v[148:151]
    v_mfma_f32_16x16x32_bf16 v[152:155], v[72:75], v[36:39], v[152:155]
    v_mfma_f32_16x16x32_bf16 v[156:159], v[76:79], v[36:39], v[156:159]
    v_mfma_f32_16x16x32_bf16 v[160:163], v[64:67], v[40:43], v[160:163]
    v_mfma_f32_16x16x32_bf16 v[164:167], v[68:71], v[40:43], v[164:167]
    v_mfma_f32_16x16x32_bf16 v[168:171], v[72:75], v[40:43], v[168:171]
    v_mfma_f32_16x16x32_bf16 v[172:175], v[76:79], v[40:43], v[172:175]
    v_mfma_f32_16x16x32_bf16 v[176:179], v[64:67], v[44:47], v[176:179]
    v_mfma_f32_16x16x32_bf16 v[180:183], v[68:71], v[44:47], v[180:183]
    v_mfma_f32_16x16x32_bf16 v[184:187], v[72:75], v[44:47], v[184:187]
    v_mfma_f32_16x16x32_bf16 v[188:191], v[76:79], v[44:47], v[188:191]
    v_mfma_f32_16x16x32_bf16 v[192:195], v[64:67], v[48:51], v[192:195]
    v_mfma_f32_16x16x32_bf16 v[196:199], v[68:71], v[48:51], v[196:199]
    v_mfma_f32_16x16x32_bf16 v[200:203], v[72:75], v[48:51], v[200:203]
    v_mfma_f32_16x16x32_bf16 v[204:207], v[76:79], v[48:51], v[204:207]
    v_mfma_f32_16x16x32_bf16 v[208:211], v[64:67], v[52:55], v[208:211]
    v_mfma_f32_16x16x32_bf16 v[212:215], v[68:71], v[52:55], v[212:215]
    v_mfma_f32_16x16x32_bf16 v[216:219], v[72:75], v[52:55], v[216:219]
    v_mfma_f32_16x16x32_bf16 v[220:223], v[76:79], v[52:55], v[220:223]
    v_mfma_f32_16x16x32_bf16 v[224:227], v[64:67], v[56:59], v[224:227]
    v_mfma_f32_16x16x32_bf16 v[228:231], v[68:71], v[56:59], v[228:231]
    v_mfma_f32_16x16x32_bf16 v[232:235], v[72:75], v[56:59], v[232:235]
    v_mfma_f32_16x16x32_bf16 v[236:239], v[76:79], v[56:59], v[236:239]
    v_mfma_f32_16x16x32_bf16 v[240:243], v[64:67], v[60:63], v[240:243]
    v_mfma_f32_16x16x32_bf16 v[244:247], v[68:71], v[60:63], v[244:247]
    v_mfma_f32_16x16x32_bf16 v[248:251], v[72:75], v[60:63], v[248:251]
    v_mfma_f32_16x16x32_bf16 v[252:255], v[76:79], v[60:63], v[252:255]
    s_waitcnt lgkmcnt(0)
    v_mfma_f32_16x16x32_bf16 v[128:131], v[112:115], v[80:83], v[128:131]
    v_mfma_f32_16x16x32_bf16 v[132:135], v[116:119], v[80:83], v[132:135]
    v_mfma_f32_16x16x32_bf16 v[136:139], v[120:123], v[80:83], v[136:139]
    v_mfma_f32_16x16x32_bf16 v[140:143], v[124:127], v[80:83], v[140:143]
    v_mfma_f32_16x16x32_bf16 v[144:147], v[112:115], v[84:87], v[144:147]
    v_mfma_f32_16x16x32_bf16 v[148:151], v[116:119], v[84:87], v[148:151]
    v_mfma_f32_16x16x32_bf16 v[152:155], v[120:123], v[84:87], v[152:155]
    v_mfma_f32_16x16x32_bf16 v[156:159], v[124:127], v[84:87], v[156:159]
    v_mfma_f32_16x16x32_bf16 v[160:163], v[112:115], v[88:91], v[160:163]
    v_mfma_f32_16x16x32_bf16 v[164:167], v[116:119], v[88:91], v[164:167]
    v_mfma_f32_16x16x32_bf16 v[168:171], v[120:123], v[88:91], v[168:171]
    v_mfma_f32_16x16x32_bf16 v[172:175], v[124:127], v[88:91], v[172:175]
    v_mfma_f32_16x16x32_bf16 v[176:179], v[112:115], v[92:95], v[176:179]
    v_mfma_f32_16x16x32_bf16 v[180:183], v[116:119], v[92:95], v[180:183]
    v_mfma_f32_16x16x32_bf16 v[184:187], v[120:123], v[92:95], v[184:187]
    v_mfma_f32_16x16x32_bf16 v[188:191], v[124:127], v[92:95], v[188:191]
    v_mfma_f32_16x16x32_bf16 v[192:195], v[112:115], v[96:99], v[192:195]
    v_mfma_f32_16x16x32_bf16 v[196:199], v[116:119], v[96:99], v[196:199]
    v_mfma_f32_16x16x32_bf16 v[200:203], v[120:123], v[96:99], v[200:203]
    v_mfma_f32_16x16x32_bf16 v[204:207], v[124:127], v[96:99], v[204:207]
    v_mfma_f32_16x16x32_bf16 v[208:211], v[112:115], v[100:103], v[208:211]
    v_mfma_f32_16x16x32_bf16 v[212:215], v[116:119], v[100:103], v[212:215]
    v_mfma_f32_16x16x32_bf16 v[216:219], v[120:123], v[100:103], v[216:219]
    v_mfma_f32_16x16x32_bf16 v[220:223], v[124:127], v[100:103], v[220:223]
    v_mfma_f32_16x16x32_bf16 v[224:227], v[112:115], v[104:107], v[224:227]
    v_mfma_f32_16x16x32_bf16 v[228:231], v[116:119], v[104:107], v[228:231]
    v_mfma_f32_16x16x32_bf16 v[232:235], v[120:123], v[104:107], v[232:235]
    v_mfma_f32_16x16x32_bf16 v[236:239], v[124:127], v[104:107], v[236:239]
    v_mfma_f32_16x16x32_bf16 v[240:243], v[112:115], v[108:111], v[240:243]
    v_mfma_f32_16x16x32_bf16 v[244:247], v[116:119], v[108:111], v[244:247]
    v_mfma_f32_16x16x32_bf16 v[248:251], v[120:123], v[108:111], v[248:251]
    v_mfma_f32_16x16x32_bf16 v[252:255], v[124:127], v[108:111], v[252:255]
    s_nop 7
    s_nop 7
    s_lshl_b32 s33, s5, 2
    s_lshl_b32 s34, s15, 1
    s_add_u32 s33, s33, s34
    s_lshl_b32 s33, s33, 8
    s_sub_u32 s34, s4, 32
    s_lshl_b32 s34, s34, 4
    s_add_u32 s33, s33, s34
    s_lshl_b32 s34, s14, 3
    s_add_u32 s33, s33, s34
    s_lshl_b32 s33, s33, 10
    s_add_u32 s33, s33, 58720256
    v_add_u32 v5, s33, v1
    v_add_u32 v6, 262144, v5

    v_cvt_pk_bf16_f32 v32, v128, v129
    v_cvt_pk_bf16_f32 v33, v130, v131
    v_cvt_pk_bf16_f32 v34, v132, v133
    v_cvt_pk_bf16_f32 v35, v134, v135

    buffer_store_dwordx4 v[32:35], v5, s[40:43], 0 offen offset:0 sc0 sc1
    v_cvt_pk_bf16_f32 v36, v144, v145
    v_cvt_pk_bf16_f32 v37, v146, v147
    v_cvt_pk_bf16_f32 v38, v148, v149
    v_cvt_pk_bf16_f32 v39, v150, v151

    buffer_store_dwordx4 v[36:39], v5, s[40:43], 0 offen offset:1024 sc0 sc1
    v_cvt_pk_bf16_f32 v40, v160, v161
    v_cvt_pk_bf16_f32 v41, v162, v163
    v_cvt_pk_bf16_f32 v42, v164, v165
    v_cvt_pk_bf16_f32 v43, v166, v167

    buffer_store_dwordx4 v[40:43], v5, s[40:43], 0 offen offset:2048 sc0 sc1
    v_cvt_pk_bf16_f32 v44, v176, v177
    v_cvt_pk_bf16_f32 v45, v178, v179
    v_cvt_pk_bf16_f32 v46, v180, v181
    v_cvt_pk_bf16_f32 v47, v182, v183

    buffer_store_dwordx4 v[44:47], v5, s[40:43], 0 offen offset:3072 sc0 sc1
    v_cvt_pk_bf16_f32 v48, v192, v193
    v_cvt_pk_bf16_f32 v49, v194, v195
    v_cvt_pk_bf16_f32 v50, v196, v197
    v_cvt_pk_bf16_f32 v51, v198, v199

    v_add_u32 v5, 4096, v5
    buffer_store_dwordx4 v[48:51], v5, s[40:43], 0 offen offset:0 sc0 sc1
    v_cvt_pk_bf16_f32 v52, v208, v209
    v_cvt_pk_bf16_f32 v53, v210, v211
    v_cvt_pk_bf16_f32 v54, v212, v213
    v_cvt_pk_bf16_f32 v55, v214, v215

    buffer_store_dwordx4 v[52:55], v5, s[40:43], 0 offen offset:1024 sc0 sc1
    v_cvt_pk_bf16_f32 v56, v224, v225
    v_cvt_pk_bf16_f32 v57, v226, v227
    v_cvt_pk_bf16_f32 v58, v228, v229
    v_cvt_pk_bf16_f32 v59, v230, v231

    buffer_store_dwordx4 v[56:59], v5, s[40:43], 0 offen offset:2048 sc0 sc1
    v_cvt_pk_bf16_f32 v60, v240, v241
    v_cvt_pk_bf16_f32 v61, v242, v243
    v_cvt_pk_bf16_f32 v62, v244, v245
    v_cvt_pk_bf16_f32 v63, v246, v247

    buffer_store_dwordx4 v[60:63], v5, s[40:43], 0 offen offset:3072 sc0 sc1
    v_cvt_pk_bf16_f32 v32, v136, v137
    v_cvt_pk_bf16_f32 v33, v138, v139
    v_cvt_pk_bf16_f32 v34, v140, v141
    v_cvt_pk_bf16_f32 v35, v142, v143

    buffer_store_dwordx4 v[32:35], v6, s[40:43], 0 offen offset:0 sc0 sc1
    v_cvt_pk_bf16_f32 v36, v152, v153
    v_cvt_pk_bf16_f32 v37, v154, v155
    v_cvt_pk_bf16_f32 v38, v156, v157
    v_cvt_pk_bf16_f32 v39, v158, v159

    buffer_store_dwordx4 v[36:39], v6, s[40:43], 0 offen offset:1024 sc0 sc1
    v_cvt_pk_bf16_f32 v40, v168, v169
    v_cvt_pk_bf16_f32 v41, v170, v171
    v_cvt_pk_bf16_f32 v42, v172, v173
    v_cvt_pk_bf16_f32 v43, v174, v175

    buffer_store_dwordx4 v[40:43], v6, s[40:43], 0 offen offset:2048 sc0 sc1
    v_cvt_pk_bf16_f32 v44, v184, v185
    v_cvt_pk_bf16_f32 v45, v186, v187
    v_cvt_pk_bf16_f32 v46, v188, v189
    v_cvt_pk_bf16_f32 v47, v190, v191

    buffer_store_dwordx4 v[44:47], v6, s[40:43], 0 offen offset:3072 sc0 sc1
    v_cvt_pk_bf16_f32 v48, v200, v201
    v_cvt_pk_bf16_f32 v49, v202, v203
    v_cvt_pk_bf16_f32 v50, v204, v205
    v_cvt_pk_bf16_f32 v51, v206, v207

    v_add_u32 v6, 4096, v6
    buffer_store_dwordx4 v[48:51], v6, s[40:43], 0 offen offset:0 sc0 sc1
    v_cvt_pk_bf16_f32 v52, v216, v217
    v_cvt_pk_bf16_f32 v53, v218, v219
    v_cvt_pk_bf16_f32 v54, v220, v221
    v_cvt_pk_bf16_f32 v55, v222, v223

    buffer_store_dwordx4 v[52:55], v6, s[40:43], 0 offen offset:1024 sc0 sc1
    v_cvt_pk_bf16_f32 v56, v232, v233
    v_cvt_pk_bf16_f32 v57, v234, v235
    v_cvt_pk_bf16_f32 v58, v236, v237
    v_cvt_pk_bf16_f32 v59, v238, v239

    buffer_store_dwordx4 v[56:59], v6, s[40:43], 0 offen offset:2048 sc0 sc1
    v_cvt_pk_bf16_f32 v60, v248, v249
    v_cvt_pk_bf16_f32 v61, v250, v251
    v_cvt_pk_bf16_f32 v62, v252, v253
    v_cvt_pk_bf16_f32 v63, v254, v255

    buffer_store_dwordx4 v[60:63], v6, s[40:43], 0 offen offset:3072 sc0 sc1
    s_branch L_g1_done
L_g1_done:
    s_waitcnt vmcnt(0)
    s_barrier
    s_cmp_lg_u32 s3, 0
    s_cbranch_scc1 L_w_loop
    s_lshl_b32 s6, s93, 6
    s_add_u32 s6, s6, s92
    s_lshl_b32 s6, s6, 2
    s_add_u32 s6, s6, 119537664
    s_mov_b64 exec, 1
    v_mov_b32 v10, 1
    v_mov_b32 v11, 0
    buffer_store_dword v10, v11, s[40:43], s6 offen sc0 sc1
    s_mov_b64 exec, -1
    s_branch L_w_loop

L_w_t3:
    s_sub_u32 s6, s2, 992
    s_lshr_b32 s92, s6, 5
    s_and_b32 s7, s6, 31
    s_cmp_ge_u32 s7, 16
    s_cbranch_scc1 L_w_g2
    s_lshr_b32 s5, s7, 3
    s_lshl_b32 s6, s92, 1
    s_add_u32 s5, s5, s6
    s_and_b32 s6, s7, 7
    s_lshl_b32 s6, s6, 2
    s_add_u32 s6, s6, s3
    s_lshr_b32 s10, s5, 2
    s_lshl_b32 s10, s10, 6
    s_lshr_b32 s11, s6, 1
    s_add_u32 s10, s10, s11
    s_lshl_b32 s10, s10, 2
    s_add_u32 s10, s10, 119537664
    v_lshlrev_b32 v10, 6, v6
    v_add_u32 v10, s10, v10
    s_lshl_b32 s10, s6, 2
    s_add_u32 s10, s10, 119541760
    v_mov_b32 v12, s10
    v_mov_b32 v11, 1
    s_add_u32 s10, s5, 1
    v_mov_b32 v13, s10
    v_cmp_eq_u32 vcc, 3, v6
    s_nop 1
    v_cndmask_b32 v10, v10, v12, vcc
    v_cndmask_b32 v11, v11, v13, vcc

    s_mov_b64 exec, 15
    s_mov_b32 s19, 1048576

L_w_pa_loop:
    buffer_load_dword v12, v10, s[40:43], 0 offen sc0 sc1
    s_waitcnt vmcnt(0)
    v_cmp_lt_u32 vcc, v12, v11
    s_cbranch_vccz L_w_pa_ok
    s_sleep 3
    s_sub_u32 s19, s19, 1
    s_cmp_lg_u32 s19, 0
    s_cbranch_scc1 L_w_pa_loop
    s_mov_b64 exec, -1
    s_branch L_ch_done

L_w_pa_ok:
    s_mov_b64 exec, -1
    s_lshl_b32 s10, s5, 8
    s_lshl_b32 s11, s6, 2
    s_add_u32 s10, s10, s11
    s_lshl_b32 s10, s10, 10
    s_add_u32 s12, s10, 25165824
    s_add_u32 s13, s12, 131072
    s_add_u32 s14, s10, 41943040
    s_add_u32 s15, s14, 131072
    s_add_u32 s20, s10, 83886080
    s_add_u32 s21, s20, 131072
    s_lshl_b32 s16, s5, 7
    s_add_u32 s16, s16, s11
    s_lshl_b32 s16, s16, 10
    s_add_u32 s16, s16, 100663296
    s_lshl_b32 s17, s5, 8
    s_lshl_b32 s11, s6, 3
    s_add_u32 s17, s17, s11
    s_lshl_b32 s18, s17, 9
    s_add_u32 s18, s18, 109051904
    s_lshl_b32 s17, s17, 10
    s_add_u32 s17, s17, 58720256
    s_add_u32 s19, s17, 4096
    s_mov_b32 s69, 0x3db504f3
    s_mov_b32 s70, 0x3fb8aa3b

    buffer_load_dwordx4 v[10:13], v1, s[40:43], s12 offen offset:0 sc0 sc1
    buffer_load_dwordx4 v[14:17], v1, s[40:43], s12 offen offset:1024 sc0 sc1
    buffer_load_dwordx4 v[18:21], v1, s[40:43], s12 offen offset:2048 sc0 sc1
    buffer_load_dwordx4 v[22:25], v1, s[40:43], s12 offen offset:3072 sc0 sc1
    buffer_load_dwordx4 v[26:29], v1, s[40:43], s13 offen offset:0 sc0 sc1
    buffer_load_dwordx4 v[30:33], v1, s[40:43], s13 offen offset:1024 sc0 sc1
    buffer_load_dwordx4 v[34:37], v1, s[40:43], s13 offen offset:2048 sc0 sc1
    buffer_load_dwordx4 v[38:41], v1, s[40:43], s13 offen offset:3072 sc0 sc1
    buffer_load_dwordx4 v[74:77], v1, s[40:43], s16 offen offset:0 sc0 sc1
    buffer_load_dwordx4 v[78:81], v1, s[40:43], s16 offen offset:1024 sc0 sc1
    buffer_load_dwordx4 v[82:85], v1, s[40:43], s16 offen offset:2048 sc0 sc1
    buffer_load_dwordx4 v[86:89], v1, s[40:43], s16 offen offset:3072 sc0 sc1
    buffer_load_dwordx4 v[42:45], v1, s[40:43], s14 offen offset:0 sc0 sc1
    buffer_load_dwordx4 v[46:49], v1, s[40:43], s14 offen offset:1024 sc0 sc1
    buffer_load_dwordx4 v[50:53], v1, s[40:43], s14 offen offset:2048 sc0 sc1
    buffer_load_dwordx4 v[54:57], v1, s[40:43], s14 offen offset:3072 sc0 sc1
    buffer_load_dwordx4 v[58:61], v1, s[40:43], s15 offen offset:0 sc0 sc1
    buffer_load_dwordx4 v[62:65], v1, s[40:43], s15 offen offset:1024 sc0 sc1
    buffer_load_dwordx4 v[66:69], v1, s[40:43], s15 offen offset:2048 sc0 sc1
    buffer_load_dwordx4 v[70:73], v1, s[40:43], s15 offen offset:3072 sc0 sc1
    buffer_load_dwordx2 v[90:91], v3, s[40:43], s18 offen offset:0 sc0 sc1
    buffer_load_dwordx4 v[92:95], v1, s[40:43], s17 offen offset:0 sc0 sc1
    v_mov_b32 v96, 0
    v_mov_b32 v97, 0
    buffer_load_dwordx2 v[98:99], v3, s[40:43], s18 offen offset:512 sc0 sc1
    buffer_load_dwordx4 v[100:103], v1, s[40:43], s17 offen offset:1024 sc0 sc1
    v_mov_b32 v104, 0
    v_mov_b32 v105, 0
    buffer_load_dwordx2 v[106:107], v3, s[40:43], s18 offen offset:1024 sc0 sc1
    buffer_load_dwordx4 v[108:111], v1, s[40:43], s17 offen offset:2048 sc0 sc1
    v_mov_b32 v112, 0
    v_mov_b32 v113, 0
    buffer_load_dwordx2 v[114:115], v3, s[40:43], s18 offen offset:1536 sc0 sc1
    buffer_load_dwordx4 v[116:119], v1, s[40:43], s17 offen offset:3072 sc0 sc1
    v_mov_b32 v120, 0
    v_mov_b32 v121, 0
    buffer_load_dwordx2 v[122:123], v3, s[40:43], s18 offen offset:2048 sc0 sc1
    buffer_load_dwordx4 v[124:127], v1, s[40:43], s19 offen offset:0 sc0 sc1
    v_mov_b32 v128, 0
    v_mov_b32 v129, 0
    buffer_load_dwordx2 v[130:131], v3, s[40:43], s18 offen offset:2560 sc0 sc1
    buffer_load_dwordx4 v[132:135], v1, s[40:43], s19 offen offset:1024 sc0 sc1
    v_mov_b32 v136, 0
    v_mov_b32 v137, 0
    buffer_load_dwordx2 v[138:139], v3, s[40:43], s18 offen offset:3072 sc0 sc1
    buffer_load_dwordx4 v[140:143], v1, s[40:43], s19 offen offset:2048 sc0 sc1
    v_mov_b32 v144, 0
    v_mov_b32 v145, 0
    buffer_load_dwordx2 v[146:147], v3, s[40:43], s18 offen offset:3584 sc0 sc1
    buffer_load_dwordx4 v[148:151], v1, s[40:43], s19 offen offset:3072 sc0 sc1
    v_mov_b32 v152, 0
    v_mov_b32 v153, 0
    v_cmp_gt_u32 s[60:61], 32, v6
    v_lshlrev_b32 v4, 2, v9
    v_add_u32 v5, 0, v4
    v_cmp_le_u32 s[72:73], v5, v8
    v_add_u32 v5, 1, v4
    v_cmp_le_u32 s[74:75], v5, v8
    v_add_u32 v5, 2, v4
    v_cmp_le_u32 s[76:77], v5, v8
    v_add_u32 v5, 3, v4
    v_cmp_le_u32 s[78:79], v5, v8
    s_waitcnt vmcnt(16)
    v_mfma_f32_16x16x32_bf16 v[154:157], v[74:77], v[10:13], 0
    v_mfma_f32_16x16x32_bf16 v[154:157], v[78:81], v[14:17], v[154:157]
    v_mfma_f32_16x16x32_bf16 v[154:157], v[82:85], v[18:21], v[154:157]
    v_mfma_f32_16x16x32_bf16 v[154:157], v[86:89], v[22:25], v[154:157]
    v_mfma_f32_16x16x32_bf16 v[158:161], v[42:45], v[10:13], 0
    v_mfma_f32_16x16x32_bf16 v[158:161], v[46:49], v[14:17], v[158:161]
    v_mfma_f32_16x16x32_bf16 v[158:161], v[50:53], v[18:21], v[158:161]
    v_mfma_f32_16x16x32_bf16 v[158:161], v[54:57], v[22:25], v[158:161]
    v_mfma_f32_16x16x32_bf16 v[162:165], v[74:77], v[26:29], 0
    v_mfma_f32_16x16x32_bf16 v[162:165], v[78:81], v[30:33], v[162:165]
    v_mfma_f32_16x16x32_bf16 v[162:165], v[82:85], v[34:37], v[162:165]
    v_mfma_f32_16x16x32_bf16 v[162:165], v[86:89], v[38:41], v[162:165]
    v_mfma_f32_16x16x32_bf16 v[166:169], v[42:45], v[26:29], 0
    v_mfma_f32_16x16x32_bf16 v[166:169], v[46:49], v[30:33], v[166:169]
    v_mfma_f32_16x16x32_bf16 v[166:169], v[50:53], v[34:37], v[166:169]
    v_mfma_f32_16x16x32_bf16 v[166:169], v[54:57], v[38:41], v[166:169]
    v_mfma_f32_16x16x32_bf16 v[170:173], v[58:61], v[26:29], 0
    v_mfma_f32_16x16x32_bf16 v[170:173], v[62:65], v[30:33], v[170:173]
    v_mfma_f32_16x16x32_bf16 v[170:173], v[66:69], v[34:37], v[170:173]
    v_mfma_f32_16x16x32_bf16 v[170:173], v[70:73], v[38:41], v[170:173]
    s_nop 7
    s_nop 1
    v_mov_b32 v255, 0xf149f2ca
    v_cvt_pk_bf16_f32 v250, v154, v155
    v_lshlrev_b32 v251, 16, v250
    v_and_b32 v252, 0xffff0000, v250
    v_mul_f32 v251, s69, v251
    v_mul_f32 v252, s69, v252
    v_cvt_pk_bf16_f32 v250, v251, v252
    v_lshlrev_b32 v154, 16, v250
    v_and_b32 v155, 0xffff0000, v250

    v_cvt_pk_bf16_f32 v250, v156, v157
    v_lshlrev_b32 v251, 16, v250
    v_and_b32 v252, 0xffff0000, v250
    v_mul_f32 v251, s69, v251
    v_mul_f32 v252, s69, v252
    v_cvt_pk_bf16_f32 v250, v251, v252
    v_lshlrev_b32 v156, 16, v250
    v_and_b32 v157, 0xffff0000, v250

    v_cvt_pk_bf16_f32 v250, v158, v159
    v_lshlrev_b32 v251, 16, v250
    v_and_b32 v252, 0xffff0000, v250
    v_mul_f32 v251, s69, v251
    v_mul_f32 v252, s69, v252
    v_cvt_pk_bf16_f32 v250, v251, v252
    v_lshlrev_b32 v158, 16, v250
    v_and_b32 v159, 0xffff0000, v250

    v_cvt_pk_bf16_f32 v250, v160, v161
    v_lshlrev_b32 v251, 16, v250
    v_and_b32 v252, 0xffff0000, v250
    v_mul_f32 v251, s69, v251
    v_mul_f32 v252, s69, v252
    v_cvt_pk_bf16_f32 v250, v251, v252
    v_lshlrev_b32 v160, 16, v250
    v_and_b32 v161, 0xffff0000, v250

    v_cvt_pk_bf16_f32 v250, v162, v163
    v_lshlrev_b32 v251, 16, v250
    v_and_b32 v252, 0xffff0000, v250
    v_mul_f32 v251, s69, v251
    v_mul_f32 v252, s69, v252
    v_cvt_pk_bf16_f32 v250, v251, v252
    v_lshlrev_b32 v162, 16, v250
    v_and_b32 v163, 0xffff0000, v250

    v_cvt_pk_bf16_f32 v250, v164, v165
    v_lshlrev_b32 v251, 16, v250
    v_and_b32 v252, 0xffff0000, v250
    v_mul_f32 v251, s69, v251
    v_mul_f32 v252, s69, v252
    v_cvt_pk_bf16_f32 v250, v251, v252
    v_lshlrev_b32 v164, 16, v250
    v_and_b32 v165, 0xffff0000, v250

    v_cvt_pk_bf16_f32 v250, v166, v167
    v_lshlrev_b32 v251, 16, v250
    v_and_b32 v252, 0xffff0000, v250
    v_mul_f32 v251, s69, v251
    v_mul_f32 v252, s69, v252
    v_cvt_pk_bf16_f32 v250, v251, v252
    v_lshlrev_b32 v166, 16, v250
    v_and_b32 v167, 0xffff0000, v250

    v_cvt_pk_bf16_f32 v250, v168, v169
    v_lshlrev_b32 v251, 16, v250
    v_and_b32 v252, 0xffff0000, v250
    v_mul_f32 v251, s69, v251
    v_mul_f32 v252, s69, v252
    v_cvt_pk_bf16_f32 v250, v251, v252
    v_lshlrev_b32 v168, 16, v250
    v_and_b32 v169, 0xffff0000, v250

    v_cvt_pk_bf16_f32 v250, v170, v171
    v_lshlrev_b32 v251, 16, v250
    v_and_b32 v252, 0xffff0000, v250
    v_mul_f32 v251, s69, v251
    v_mul_f32 v252, s69, v252
    v_cvt_pk_bf16_f32 v250, v251, v252
    v_lshlrev_b32 v170, 16, v250
    v_and_b32 v171, 0xffff0000, v250

    v_cvt_pk_bf16_f32 v250, v172, v173
    v_lshlrev_b32 v251, 16, v250
    v_and_b32 v252, 0xffff0000, v250
    v_mul_f32 v251, s69, v251
    v_mul_f32 v252, s69, v252
    v_cvt_pk_bf16_f32 v250, v251, v252
    v_lshlrev_b32 v172, 16, v250
    v_and_b32 v173, 0xffff0000, v250

    v_cndmask_b32 v154, v255, v154, s[60:61]
    v_cndmask_b32 v162, v255, v162, s[60:61]
    v_cndmask_b32 v158, v255, v158, s[72:73]
    v_cndmask_b32 v170, v255, v170, s[72:73]
    v_cndmask_b32 v155, v255, v155, s[60:61]
    v_cndmask_b32 v163, v255, v163, s[60:61]
    v_cndmask_b32 v159, v255, v159, s[74:75]
    v_cndmask_b32 v171, v255, v171, s[74:75]
    v_cndmask_b32 v156, v255, v156, s[60:61]
    v_cndmask_b32 v164, v255, v164, s[60:61]
    v_cndmask_b32 v160, v255, v160, s[76:77]
    v_cndmask_b32 v172, v255, v172, s[76:77]
    v_cndmask_b32 v157, v255, v157, s[60:61]
    v_cndmask_b32 v165, v255, v165, s[60:61]
    v_cndmask_b32 v161, v255, v161, s[78:79]
    v_cndmask_b32 v173, v255, v173, s[78:79]
    v_max3_f32 v250, v154, v155, v156
    v_max3_f32 v250, v250, v157, v158
    v_max3_f32 v250, v250, v159, v160
    v_max_f32 v250, v250, v161
    v_mov_b32 v251, v250
    s_nop 1
    v_permlane32_swap_b32 v250, v251
    v_max_f32 v250, v250, v251
    v_mov_b32 v251, v250
    s_nop 1
    v_permlane16_swap_b32 v250, v251
    v_max_f32 v250, v250, v251

    v_mul_f32 v250, s70, v250
    v_fma_f32 v154, v154, s70, -v250
    v_fma_f32 v155, v155, s70, -v250
    v_fma_f32 v156, v156, s70, -v250
    v_fma_f32 v157, v157, s70, -v250
    v_fma_f32 v158, v158, s70, -v250
    v_fma_f32 v159, v159, s70, -v250
    v_fma_f32 v160, v160, s70, -v250
    v_fma_f32 v161, v161, s70, -v250
    v_exp_f32 v154, v154
    v_exp_f32 v155, v155
    v_exp_f32 v156, v156
    v_exp_f32 v157, v157
    v_exp_f32 v158, v158
    v_exp_f32 v159, v159
    v_exp_f32 v160, v160
    v_exp_f32 v161, v161
    s_nop 0
    v_add_f32 v250, v154, v155
    v_add_f32 v250, v250, v156
    v_add_f32 v250, v250, v157
    v_add_f32 v250, v250, v158
    v_add_f32 v250, v250, v159
    v_add_f32 v250, v250, v160
    v_add_f32 v250, v250, v161
    v_mov_b32 v251, v250
    s_nop 1
    v_permlane32_swap_b32 v250, v251
    v_add_f32 v250, v250, v251
    v_mov_b32 v251, v250
    s_nop 1
    v_permlane16_swap_b32 v250, v251
    v_add_f32 v250, v250, v251

    v_rcp_f32 v250, v250
    s_nop 0
    v_mul_f32 v154, v154, v250
    v_mul_f32 v155, v155, v250
    v_mul_f32 v156, v156, v250
    v_mul_f32 v157, v157, v250
    v_mul_f32 v158, v158, v250
    v_mul_f32 v159, v159, v250
    v_mul_f32 v160, v160, v250
    v_mul_f32 v161, v161, v250
    v_cvt_pk_bf16_f32 v174, v154, v155
    v_cvt_pk_bf16_f32 v175, v156, v157
    v_cvt_pk_bf16_f32 v176, v158, v159
    v_cvt_pk_bf16_f32 v177, v160, v161
    v_max3_f32 v250, v162, v163, v164
    v_max3_f32 v250, v250, v165, v166
    v_max3_f32 v250, v250, v167, v168
    v_max3_f32 v250, v250, v169, v170
    v_max3_f32 v250, v250, v171, v172
    v_max_f32 v250, v250, v173
    v_mov_b32 v251, v250
    s_nop 1
    v_permlane32_swap_b32 v250, v251
    v_max_f32 v250, v250, v251
    v_mov_b32 v251, v250
    s_nop 1
    v_permlane16_swap_b32 v250, v251
    v_max_f32 v250, v250, v251

    v_mul_f32 v250, s70, v250
    v_fma_f32 v162, v162, s70, -v250
    v_fma_f32 v163, v163, s70, -v250
    v_fma_f32 v164, v164, s70, -v250
    v_fma_f32 v165, v165, s70, -v250
    v_fma_f32 v166, v166, s70, -v250
    v_fma_f32 v167, v167, s70, -v250
    v_fma_f32 v168, v168, s70, -v250
    v_fma_f32 v169, v169, s70, -v250
    v_fma_f32 v170, v170, s70, -v250
    v_fma_f32 v171, v171, s70, -v250
    v_fma_f32 v172, v172, s70, -v250
    v_fma_f32 v173, v173, s70, -v250
    v_exp_f32 v162, v162
    v_exp_f32 v163, v163
    v_exp_f32 v164, v164
    v_exp_f32 v165, v165
    v_exp_f32 v166, v166
    v_exp_f32 v167, v167
    v_exp_f32 v168, v168
    v_exp_f32 v169, v169
    v_exp_f32 v170, v170
    v_exp_f32 v171, v171
    v_exp_f32 v172, v172
    v_exp_f32 v173, v173
    s_nop 0
    v_add_f32 v250, v162, v163
    v_add_f32 v250, v250, v164
    v_add_f32 v250, v250, v165
    v_add_f32 v250, v250, v166
    v_add_f32 v250, v250, v167
    v_add_f32 v250, v250, v168
    v_add_f32 v250, v250, v169
    v_add_f32 v250, v250, v170
    v_add_f32 v250, v250, v171
    v_add_f32 v250, v250, v172
    v_add_f32 v250, v250, v173
    v_mov_b32 v251, v250
    s_nop 1
    v_permlane32_swap_b32 v250, v251
    v_add_f32 v250, v250, v251
    v_mov_b32 v251, v250
    s_nop 1
    v_permlane16_swap_b32 v250, v251
    v_add_f32 v250, v250, v251

    v_rcp_f32 v250, v250
    s_nop 0
    v_mul_f32 v162, v162, v250
    v_mul_f32 v163, v163, v250
    v_mul_f32 v164, v164, v250
    v_mul_f32 v165, v165, v250
    v_mul_f32 v166, v166, v250
    v_mul_f32 v167, v167, v250
    v_mul_f32 v168, v168, v250
    v_mul_f32 v169, v169, v250
    v_mul_f32 v170, v170, v250
    v_mul_f32 v171, v171, v250
    v_mul_f32 v172, v172, v250
    v_mul_f32 v173, v173, v250
    v_cvt_pk_bf16_f32 v178, v162, v163
    v_cvt_pk_bf16_f32 v179, v164, v165
    v_cvt_pk_bf16_f32 v180, v166, v167
    v_cvt_pk_bf16_f32 v181, v168, v169
    v_cvt_pk_bf16_f32 v182, v170, v171
    v_cvt_pk_bf16_f32 v183, v172, v173
    v_mov_b32 v184, 0
    v_mov_b32 v185, 0
    s_waitcnt vmcnt(0)
    s_nop 1

    v_mfma_f32_16x16x32_bf16 v[186:189], v[90:93], v[174:177], 0
    v_mfma_f32_16x16x32_bf16 v[190:193], v[90:93], v[178:181], 0
    v_mfma_f32_16x16x32_bf16 v[190:193], v[94:97], v[182:185], v[190:193]
    v_mfma_f32_16x16x32_bf16 v[194:197], v[98:101], v[174:177], 0
    v_mfma_f32_16x16x32_bf16 v[198:201], v[98:101], v[178:181], 0
    v_mfma_f32_16x16x32_bf16 v[198:201], v[102:105], v[182:185], v[198:201]
    v_mfma_f32_16x16x32_bf16 v[202:205], v[106:109], v[174:177], 0
    v_mfma_f32_16x16x32_bf16 v[206:209], v[106:109], v[178:181], 0
    v_mfma_f32_16x16x32_bf16 v[206:209], v[110:113], v[182:185], v[206:209]
    v_mfma_f32_16x16x32_bf16 v[210:213], v[114:117], v[174:177], 0
    v_mfma_f32_16x16x32_bf16 v[214:217], v[114:117], v[178:181], 0
    v_mfma_f32_16x16x32_bf16 v[214:217], v[118:121], v[182:185], v[214:217]
    v_mfma_f32_16x16x32_bf16 v[218:221], v[122:125], v[174:177], 0
    v_mfma_f32_16x16x32_bf16 v[222:225], v[122:125], v[178:181], 0
    v_mfma_f32_16x16x32_bf16 v[222:225], v[126:129], v[182:185], v[222:225]
    v_mfma_f32_16x16x32_bf16 v[226:229], v[130:133], v[174:177], 0
    v_mfma_f32_16x16x32_bf16 v[230:233], v[130:133], v[178:181], 0
    v_mfma_f32_16x16x32_bf16 v[230:233], v[134:137], v[182:185], v[230:233]
    v_mfma_f32_16x16x32_bf16 v[234:237], v[138:141], v[174:177], 0
    v_mfma_f32_16x16x32_bf16 v[238:241], v[138:141], v[178:181], 0
    v_mfma_f32_16x16x32_bf16 v[238:241], v[142:145], v[182:185], v[238:241]
    v_mfma_f32_16x16x32_bf16 v[242:245], v[146:149], v[174:177], 0
    v_mfma_f32_16x16x32_bf16 v[246:249], v[146:149], v[178:181], 0
    v_mfma_f32_16x16x32_bf16 v[246:249], v[150:153], v[182:185], v[246:249]
    s_nop 7
    s_nop 1
    v_cvt_pk_bf16_f32 v10, v186, v187
    v_cvt_pk_bf16_f32 v11, v188, v189
    v_cvt_pk_bf16_f32 v12, v194, v195
    v_cvt_pk_bf16_f32 v13, v196, v197
    buffer_store_dwordx4 v[10:13], v1, s[40:43], s20 offen offset:0 sc0 sc1

    v_cvt_pk_bf16_f32 v14, v202, v203
    v_cvt_pk_bf16_f32 v15, v204, v205
    v_cvt_pk_bf16_f32 v16, v210, v211
    v_cvt_pk_bf16_f32 v17, v212, v213
    buffer_store_dwordx4 v[14:17], v1, s[40:43], s20 offen offset:1024 sc0 sc1

    v_cvt_pk_bf16_f32 v18, v218, v219
    v_cvt_pk_bf16_f32 v19, v220, v221
    v_cvt_pk_bf16_f32 v20, v226, v227
    v_cvt_pk_bf16_f32 v21, v228, v229
    buffer_store_dwordx4 v[18:21], v1, s[40:43], s20 offen offset:2048 sc0 sc1

    v_cvt_pk_bf16_f32 v22, v234, v235
    v_cvt_pk_bf16_f32 v23, v236, v237
    v_cvt_pk_bf16_f32 v24, v242, v243
    v_cvt_pk_bf16_f32 v25, v244, v245
    buffer_store_dwordx4 v[22:25], v1, s[40:43], s20 offen offset:3072 sc0 sc1

    v_cvt_pk_bf16_f32 v26, v190, v191
    v_cvt_pk_bf16_f32 v27, v192, v193
    v_cvt_pk_bf16_f32 v28, v198, v199
    v_cvt_pk_bf16_f32 v29, v200, v201
    buffer_store_dwordx4 v[26:29], v1, s[40:43], s21 offen offset:0 sc0 sc1

    v_cvt_pk_bf16_f32 v30, v206, v207
    v_cvt_pk_bf16_f32 v31, v208, v209
    v_cvt_pk_bf16_f32 v32, v214, v215
    v_cvt_pk_bf16_f32 v33, v216, v217
    buffer_store_dwordx4 v[30:33], v1, s[40:43], s21 offen offset:1024 sc0 sc1

    v_cvt_pk_bf16_f32 v34, v222, v223
    v_cvt_pk_bf16_f32 v35, v224, v225
    v_cvt_pk_bf16_f32 v36, v230, v231
    v_cvt_pk_bf16_f32 v37, v232, v233
    buffer_store_dwordx4 v[34:37], v1, s[40:43], s21 offen offset:2048 sc0 sc1

    v_cvt_pk_bf16_f32 v38, v238, v239
    v_cvt_pk_bf16_f32 v39, v240, v241
    v_cvt_pk_bf16_f32 v40, v246, v247
    v_cvt_pk_bf16_f32 v41, v248, v249
    buffer_store_dwordx4 v[38:41], v1, s[40:43], s21 offen offset:3072 sc0 sc1

    s_waitcnt vmcnt(0)
    s_barrier
    s_cmp_lg_u32 s3, 0
    s_cbranch_scc1 L_w_loop
    s_lshl_b32 s6, s92, 2
    s_add_u32 s6, s6, 119542016
    s_mov_b64 exec, 1
    v_mov_b32 v10, 1
    v_mov_b32 v11, 0
    buffer_atomic_add v10, v11, s[40:43], s6 offen sc1
    s_mov_b64 exec, -1
    s_branch L_w_loop

L_w_g2:
    s_sub_u32 s4, s7, 16
    s_mov_b32 s5, s92
    s_lshr_b32 s10, s92, 1
    s_lshl_b32 s10, s10, 8
    s_add_u32 s10, s10, 119537856
    v_lshlrev_b32 v10, 2, v6
    v_add_u32 v10, s10, v10
    v_mov_b32 v11, 1

    s_mov_b64 exec, 16383
    s_mov_b32 s19, 1048576

L_w_pg_loop:
    buffer_load_dword v12, v10, s[40:43], 0 offen sc0 sc1
    s_waitcnt vmcnt(0)
    v_cmp_lt_u32 vcc, v12, v11
    s_cbranch_vccz L_w_pg_ok
    s_sleep 3
    s_sub_u32 s19, s19, 1
    s_cmp_lg_u32 s19, 0
    s_cbranch_scc1 L_w_pg_loop
    s_mov_b64 exec, -1
    s_branch L_ch_done

L_w_pg_ok:
    s_mov_b64 exec, -1
    v_accvgpr_write_b32 a0, 0
    v_accvgpr_write_b32 a1, 0
    v_accvgpr_write_b32 a2, 0
    v_accvgpr_write_b32 a3, 0
    v_accvgpr_write_b32 a4, 0
    v_accvgpr_write_b32 a5, 0
    v_accvgpr_write_b32 a6, 0
    v_accvgpr_write_b32 a7, 0
    v_accvgpr_write_b32 a8, 0
    v_accvgpr_write_b32 a9, 0
    v_accvgpr_write_b32 a10, 0
    v_accvgpr_write_b32 a11, 0
    v_accvgpr_write_b32 a12, 0
    v_accvgpr_write_b32 a13, 0
    v_accvgpr_write_b32 a14, 0
    v_accvgpr_write_b32 a15, 0
    v_accvgpr_write_b32 a16, 0
    v_accvgpr_write_b32 a17, 0
    v_accvgpr_write_b32 a18, 0
    v_accvgpr_write_b32 a19, 0
    v_accvgpr_write_b32 a20, 0
    v_accvgpr_write_b32 a21, 0
    v_accvgpr_write_b32 a22, 0
    v_accvgpr_write_b32 a23, 0
    v_accvgpr_write_b32 a24, 0
    v_accvgpr_write_b32 a25, 0
    v_accvgpr_write_b32 a26, 0
    v_accvgpr_write_b32 a27, 0
    v_accvgpr_write_b32 a28, 0
    v_accvgpr_write_b32 a29, 0
    v_accvgpr_write_b32 a30, 0
    v_accvgpr_write_b32 a31, 0
    v_accvgpr_write_b32 a32, 0
    v_accvgpr_write_b32 a33, 0
    v_accvgpr_write_b32 a34, 0
    v_accvgpr_write_b32 a35, 0
    v_accvgpr_write_b32 a36, 0
    v_accvgpr_write_b32 a37, 0
    v_accvgpr_write_b32 a38, 0
    v_accvgpr_write_b32 a39, 0
    v_accvgpr_write_b32 a40, 0
    v_accvgpr_write_b32 a41, 0
    v_accvgpr_write_b32 a42, 0
    v_accvgpr_write_b32 a43, 0
    v_accvgpr_write_b32 a44, 0
    v_accvgpr_write_b32 a45, 0
    v_accvgpr_write_b32 a46, 0
    v_accvgpr_write_b32 a47, 0
    v_accvgpr_write_b32 a48, 0
    v_accvgpr_write_b32 a49, 0
    v_accvgpr_write_b32 a50, 0
    v_accvgpr_write_b32 a51, 0
    v_accvgpr_write_b32 a52, 0
    v_accvgpr_write_b32 a53, 0
    v_accvgpr_write_b32 a54, 0
    v_accvgpr_write_b32 a55, 0
    v_accvgpr_write_b32 a56, 0
    v_accvgpr_write_b32 a57, 0
    v_accvgpr_write_b32 a58, 0
    v_accvgpr_write_b32 a59, 0
    v_accvgpr_write_b32 a60, 0
    v_accvgpr_write_b32 a61, 0
    v_accvgpr_write_b32 a62, 0
    v_accvgpr_write_b32 a63, 0
    s_mul_i32 s14, s4, 262144
    s_mul_i32 s15, s3, 32768
    s_add_u32 s14, s14, s15
    s_add_u32 s14, s14, 18874368
    s_mul_i32 s16, s5, 524288
    s_add_u32 s16, s16, s15
    s_add_u32 s16, s16, 83886080

    s_add_u32 s20, s14, 0
    s_add_u32 s21, s14, 131072
    s_add_u32 s22, s16, 0
    s_add_u32 s23, s16, 131072
    s_add_u32 s24, s16, 262144
    s_add_u32 s25, s16, 393216
    s_mul_i32 s14, s4, 114688
    s_mul_i32 s15, s3, 14336
    s_add_u32 s14, s14, s15
    s_add_u32 s14, s14, 23068672
    s_mul_i32 s16, s5, 229376
    s_add_u32 s16, s16, s15
    s_add_u32 s16, s16, 75497472

    s_add_u32 s28, s14, 0
    s_add_u32 s29, s14, 57344
    s_add_u32 s30, s16, 0
    s_add_u32 s31, s16, 57344
    s_add_u32 s32, s16, 114688
    s_add_u32 s33, s16, 172032
    buffer_load_dwordx4 v[32:35], v1, s[40:43], s28 offen offset:0
    buffer_load_dwordx4 v[36:39], v1, s[40:43], s29 offen offset:0
    buffer_load_dwordx4 v[40:43], v1, s[40:43], s30 offen offset:0 sc0 sc1
    buffer_load_dwordx4 v[44:47], v1, s[40:43], s31 offen offset:0 sc0 sc1
    buffer_load_dwordx4 v[48:51], v1, s[40:43], s32 offen offset:0 sc0 sc1
    buffer_load_dwordx4 v[52:55], v1, s[40:43], s33 offen offset:0 sc0 sc1
    buffer_load_dwordx4 v[56:59], v1, s[40:43], s28 offen offset:1024
    buffer_load_dwordx4 v[60:63], v1, s[40:43], s29 offen offset:1024
    buffer_load_dwordx4 v[64:67], v1, s[40:43], s30 offen offset:1024 sc0 sc1
    buffer_load_dwordx4 v[68:71], v1, s[40:43], s31 offen offset:1024 sc0 sc1
    buffer_load_dwordx4 v[72:75], v1, s[40:43], s32 offen offset:1024 sc0 sc1
    buffer_load_dwordx4 v[76:79], v1, s[40:43], s33 offen offset:1024 sc0 sc1
    buffer_load_dwordx4 v[80:83], v1, s[40:43], s28 offen offset:2048
    buffer_load_dwordx4 v[84:87], v1, s[40:43], s29 offen offset:2048
    buffer_load_dwordx4 v[88:91], v1, s[40:43], s30 offen offset:2048 sc0 sc1
    buffer_load_dwordx4 v[92:95], v1, s[40:43], s31 offen offset:2048 sc0 sc1
    buffer_load_dwordx4 v[96:99], v1, s[40:43], s32 offen offset:2048 sc0 sc1
    buffer_load_dwordx4 v[100:103], v1, s[40:43], s33 offen offset:2048 sc0 sc1
    buffer_load_dwordx4 v[104:107], v1, s[40:43], s28 offen offset:3072
    buffer_load_dwordx4 v[108:111], v1, s[40:43], s29 offen offset:3072
    buffer_load_dwordx4 v[112:115], v1, s[40:43], s30 offen offset:3072 sc0 sc1
    buffer_load_dwordx4 v[116:119], v1, s[40:43], s31 offen offset:3072 sc0 sc1
    buffer_load_dwordx4 v[120:123], v1, s[40:43], s32 offen offset:3072 sc0 sc1
    buffer_load_dwordx4 v[124:127], v1, s[40:43], s33 offen offset:3072 sc0 sc1
    s_add_u32 s28, s28, 4096
    s_add_u32 s29, s29, 4096
    s_add_u32 s30, s30, 4096
    s_add_u32 s31, s31, 4096
    s_add_u32 s32, s32, 4096
    s_add_u32 s33, s33, 4096
    buffer_load_dwordx4 v[128:131], v1, s[40:43], s28 offen offset:0
    buffer_load_dwordx4 v[132:135], v1, s[40:43], s29 offen offset:0
    buffer_load_dwordx4 v[136:139], v1, s[40:43], s30 offen offset:0 sc0 sc1
    buffer_load_dwordx4 v[140:143], v1, s[40:43], s31 offen offset:0 sc0 sc1
    buffer_load_dwordx4 v[144:147], v1, s[40:43], s32 offen offset:0 sc0 sc1
    buffer_load_dwordx4 v[148:151], v1, s[40:43], s33 offen offset:0 sc0 sc1
    buffer_load_dwordx4 v[152:155], v1, s[40:43], s28 offen offset:1024
    buffer_load_dwordx4 v[156:159], v1, s[40:43], s29 offen offset:1024
    buffer_load_dwordx4 v[160:163], v1, s[40:43], s30 offen offset:1024 sc0 sc1
    buffer_load_dwordx4 v[164:167], v1, s[40:43], s31 offen offset:1024 sc0 sc1
    buffer_load_dwordx4 v[168:171], v1, s[40:43], s32 offen offset:1024 sc0 sc1
    buffer_load_dwordx4 v[172:175], v1, s[40:43], s33 offen offset:1024 sc0 sc1
    buffer_load_dwordx4 v[176:179], v1, s[40:43], s28 offen offset:2048
    buffer_load_dwordx4 v[180:183], v1, s[40:43], s29 offen offset:2048
    buffer_load_dwordx4 v[184:187], v1, s[40:43], s30 offen offset:2048 sc0 sc1
    buffer_load_dwordx4 v[188:191], v1, s[40:43], s31 offen offset:2048 sc0 sc1
    buffer_load_dwordx4 v[192:195], v1, s[40:43], s32 offen offset:2048 sc0 sc1
    buffer_load_dwordx4 v[196:199], v1, s[40:43], s33 offen offset:2048 sc0 sc1
    buffer_load_dwordx4 v[200:203], v1, s[40:43], s28 offen offset:3072
    buffer_load_dwordx4 v[204:207], v1, s[40:43], s29 offen offset:3072
    buffer_load_dwordx4 v[208:211], v1, s[40:43], s30 offen offset:3072 sc0 sc1
    buffer_load_dwordx4 v[212:215], v1, s[40:43], s31 offen offset:3072 sc0 sc1
    buffer_load_dwordx4 v[216:219], v1, s[40:43], s32 offen offset:3072 sc0 sc1
    buffer_load_dwordx4 v[220:223], v1, s[40:43], s33 offen offset:3072 sc0 sc1
    s_waitcnt vmcnt(42)
    v_mfma_f32_16x16x32_bf16 a[32:35], v[32:35], v[40:43], a[32:35]
    v_mfma_f32_16x16x32_bf16 a[36:39], v[32:35], v[44:47], a[36:39]
    v_mfma_f32_16x16x32_bf16 a[40:43], v[32:35], v[48:51], a[40:43]
    v_mfma_f32_16x16x32_bf16 a[44:47], v[32:35], v[52:55], a[44:47]
    v_mfma_f32_16x16x32_bf16 a[48:51], v[36:39], v[40:43], a[48:51]
    v_mfma_f32_16x16x32_bf16 a[52:55], v[36:39], v[44:47], a[52:55]
    v_mfma_f32_16x16x32_bf16 a[56:59], v[36:39], v[48:51], a[56:59]
    v_mfma_f32_16x16x32_bf16 a[60:63], v[36:39], v[52:55], a[60:63]
    s_add_u32 s28, s28, 4096
    s_add_u32 s29, s29, 4096
    s_add_u32 s30, s30, 4096
    s_add_u32 s31, s31, 4096
    s_add_u32 s32, s32, 4096
    s_add_u32 s33, s33, 4096
    buffer_load_dwordx4 v[32:35], v1, s[40:43], s28 offen offset:0
    buffer_load_dwordx4 v[36:39], v1, s[40:43], s29 offen offset:0
    buffer_load_dwordx4 v[40:43], v1, s[40:43], s30 offen offset:0 sc0 sc1
    buffer_load_dwordx4 v[44:47], v1, s[40:43], s31 offen offset:0 sc0 sc1
    buffer_load_dwordx4 v[48:51], v1, s[40:43], s32 offen offset:0 sc0 sc1
    buffer_load_dwordx4 v[52:55], v1, s[40:43], s33 offen offset:0 sc0 sc1
    s_waitcnt vmcnt(42)
    v_mfma_f32_16x16x32_bf16 a[32:35], v[56:59], v[64:67], a[32:35]
    v_mfma_f32_16x16x32_bf16 a[36:39], v[56:59], v[68:71], a[36:39]
    v_mfma_f32_16x16x32_bf16 a[40:43], v[56:59], v[72:75], a[40:43]
    v_mfma_f32_16x16x32_bf16 a[44:47], v[56:59], v[76:79], a[44:47]
    v_mfma_f32_16x16x32_bf16 a[48:51], v[60:63], v[64:67], a[48:51]
    v_mfma_f32_16x16x32_bf16 a[52:55], v[60:63], v[68:71], a[52:55]
    v_mfma_f32_16x16x32_bf16 a[56:59], v[60:63], v[72:75], a[56:59]
    v_mfma_f32_16x16x32_bf16 a[60:63], v[60:63], v[76:79], a[60:63]
    buffer_load_dwordx4 v[56:59], v1, s[40:43], s28 offen offset:1024
    buffer_load_dwordx4 v[60:63], v1, s[40:43], s29 offen offset:1024
    buffer_load_dwordx4 v[64:67], v1, s[40:43], s30 offen offset:1024 sc0 sc1
    buffer_load_dwordx4 v[68:71], v1, s[40:43], s31 offen offset:1024 sc0 sc1
    buffer_load_dwordx4 v[72:75], v1, s[40:43], s32 offen offset:1024 sc0 sc1
    buffer_load_dwordx4 v[76:79], v1, s[40:43], s33 offen offset:1024 sc0 sc1
    s_waitcnt vmcnt(42)
    v_mfma_f32_16x16x32_bf16 a[32:35], v[80:83], v[88:91], a[32:35]
    v_mfma_f32_16x16x32_bf16 a[36:39], v[80:83], v[92:95], a[36:39]
    v_mfma_f32_16x16x32_bf16 a[40:43], v[80:83], v[96:99], a[40:43]
    v_mfma_f32_16x16x32_bf16 a[44:47], v[80:83], v[100:103], a[44:47]
    v_mfma_f32_16x16x32_bf16 a[48:51], v[84:87], v[88:91], a[48:51]
    v_mfma_f32_16x16x32_bf16 a[52:55], v[84:87], v[92:95], a[52:55]
    v_mfma_f32_16x16x32_bf16 a[56:59], v[84:87], v[96:99], a[56:59]
    v_mfma_f32_16x16x32_bf16 a[60:63], v[84:87], v[100:103], a[60:63]
    buffer_load_dwordx4 v[80:83], v1, s[40:43], s28 offen offset:2048
    buffer_load_dwordx4 v[84:87], v1, s[40:43], s29 offen offset:2048
    buffer_load_dwordx4 v[88:91], v1, s[40:43], s30 offen offset:2048 sc0 sc1
    buffer_load_dwordx4 v[92:95], v1, s[40:43], s31 offen offset:2048 sc0 sc1
    buffer_load_dwordx4 v[96:99], v1, s[40:43], s32 offen offset:2048 sc0 sc1
    buffer_load_dwordx4 v[100:103], v1, s[40:43], s33 offen offset:2048 sc0 sc1
    s_waitcnt vmcnt(42)
    v_mfma_f32_16x16x32_bf16 a[32:35], v[104:107], v[112:115], a[32:35]
    v_mfma_f32_16x16x32_bf16 a[36:39], v[104:107], v[116:119], a[36:39]
    v_mfma_f32_16x16x32_bf16 a[40:43], v[104:107], v[120:123], a[40:43]
    v_mfma_f32_16x16x32_bf16 a[44:47], v[104:107], v[124:127], a[44:47]
    v_mfma_f32_16x16x32_bf16 a[48:51], v[108:111], v[112:115], a[48:51]
    v_mfma_f32_16x16x32_bf16 a[52:55], v[108:111], v[116:119], a[52:55]
    v_mfma_f32_16x16x32_bf16 a[56:59], v[108:111], v[120:123], a[56:59]
    v_mfma_f32_16x16x32_bf16 a[60:63], v[108:111], v[124:127], a[60:63]
    buffer_load_dwordx4 v[104:107], v1, s[40:43], s28 offen offset:3072
    buffer_load_dwordx4 v[108:111], v1, s[40:43], s29 offen offset:3072
    buffer_load_dwordx4 v[112:115], v1, s[40:43], s30 offen offset:3072 sc0 sc1
    buffer_load_dwordx4 v[116:119], v1, s[40:43], s31 offen offset:3072 sc0 sc1
    buffer_load_dwordx4 v[120:123], v1, s[40:43], s32 offen offset:3072 sc0 sc1
    buffer_load_dwordx4 v[124:127], v1, s[40:43], s33 offen offset:3072 sc0 sc1
    s_waitcnt vmcnt(42)
    v_mfma_f32_16x16x32_bf16 a[32:35], v[128:131], v[136:139], a[32:35]
    v_mfma_f32_16x16x32_bf16 a[36:39], v[128:131], v[140:143], a[36:39]
    v_mfma_f32_16x16x32_bf16 a[40:43], v[128:131], v[144:147], a[40:43]
    v_mfma_f32_16x16x32_bf16 a[44:47], v[128:131], v[148:151], a[44:47]
    v_mfma_f32_16x16x32_bf16 a[48:51], v[132:135], v[136:139], a[48:51]
    v_mfma_f32_16x16x32_bf16 a[52:55], v[132:135], v[140:143], a[52:55]
    v_mfma_f32_16x16x32_bf16 a[56:59], v[132:135], v[144:147], a[56:59]
    v_mfma_f32_16x16x32_bf16 a[60:63], v[132:135], v[148:151], a[60:63]
    s_add_u32 s28, s28, 4096
    s_add_u32 s29, s29, 4096
    s_add_u32 s30, s30, 4096
    s_add_u32 s31, s31, 4096
    s_add_u32 s32, s32, 4096
    s_add_u32 s33, s33, 4096
    buffer_load_dwordx4 v[128:131], v1, s[40:43], s28 offen offset:0
    buffer_load_dwordx4 v[132:135], v1, s[40:43], s29 offen offset:0
    buffer_load_dwordx4 v[136:139], v1, s[40:43], s30 offen offset:0 sc0 sc1
    buffer_load_dwordx4 v[140:143], v1, s[40:43], s31 offen offset:0 sc0 sc1
    buffer_load_dwordx4 v[144:147], v1, s[40:43], s32 offen offset:0 sc0 sc1
    buffer_load_dwordx4 v[148:151], v1, s[40:43], s33 offen offset:0 sc0 sc1
    s_waitcnt vmcnt(42)
    v_mfma_f32_16x16x32_bf16 a[32:35], v[152:155], v[160:163], a[32:35]
    v_mfma_f32_16x16x32_bf16 a[36:39], v[152:155], v[164:167], a[36:39]
    v_mfma_f32_16x16x32_bf16 a[40:43], v[152:155], v[168:171], a[40:43]
    v_mfma_f32_16x16x32_bf16 a[44:47], v[152:155], v[172:175], a[44:47]
    v_mfma_f32_16x16x32_bf16 a[48:51], v[156:159], v[160:163], a[48:51]
    v_mfma_f32_16x16x32_bf16 a[52:55], v[156:159], v[164:167], a[52:55]
    v_mfma_f32_16x16x32_bf16 a[56:59], v[156:159], v[168:171], a[56:59]
    v_mfma_f32_16x16x32_bf16 a[60:63], v[156:159], v[172:175], a[60:63]
    buffer_load_dwordx4 v[152:155], v1, s[40:43], s28 offen offset:1024
    buffer_load_dwordx4 v[156:159], v1, s[40:43], s29 offen offset:1024
    buffer_load_dwordx4 v[160:163], v1, s[40:43], s30 offen offset:1024 sc0 sc1
    buffer_load_dwordx4 v[164:167], v1, s[40:43], s31 offen offset:1024 sc0 sc1
    buffer_load_dwordx4 v[168:171], v1, s[40:43], s32 offen offset:1024 sc0 sc1
    buffer_load_dwordx4 v[172:175], v1, s[40:43], s33 offen offset:1024 sc0 sc1
    s_waitcnt vmcnt(42)
    v_mfma_f32_16x16x32_bf16 a[32:35], v[176:179], v[184:187], a[32:35]
    v_mfma_f32_16x16x32_bf16 a[36:39], v[176:179], v[188:191], a[36:39]
    v_mfma_f32_16x16x32_bf16 a[40:43], v[176:179], v[192:195], a[40:43]
    v_mfma_f32_16x16x32_bf16 a[44:47], v[176:179], v[196:199], a[44:47]
    v_mfma_f32_16x16x32_bf16 a[48:51], v[180:183], v[184:187], a[48:51]
    v_mfma_f32_16x16x32_bf16 a[52:55], v[180:183], v[188:191], a[52:55]
    v_mfma_f32_16x16x32_bf16 a[56:59], v[180:183], v[192:195], a[56:59]
    v_mfma_f32_16x16x32_bf16 a[60:63], v[180:183], v[196:199], a[60:63]
    s_waitcnt vmcnt(36)
    v_mfma_f32_16x16x32_bf16 a[32:35], v[200:203], v[208:211], a[32:35]
    v_mfma_f32_16x16x32_bf16 a[36:39], v[200:203], v[212:215], a[36:39]
    v_mfma_f32_16x16x32_bf16 a[40:43], v[200:203], v[216:219], a[40:43]
    v_mfma_f32_16x16x32_bf16 a[44:47], v[200:203], v[220:223], a[44:47]
    v_mfma_f32_16x16x32_bf16 a[48:51], v[204:207], v[208:211], a[48:51]
    v_mfma_f32_16x16x32_bf16 a[52:55], v[204:207], v[212:215], a[52:55]
    v_mfma_f32_16x16x32_bf16 a[56:59], v[204:207], v[216:219], a[56:59]
    v_mfma_f32_16x16x32_bf16 a[60:63], v[204:207], v[220:223], a[60:63]
    s_waitcnt vmcnt(30)
    v_mfma_f32_16x16x32_bf16 a[32:35], v[32:35], v[40:43], a[32:35]
    v_mfma_f32_16x16x32_bf16 a[36:39], v[32:35], v[44:47], a[36:39]
    v_mfma_f32_16x16x32_bf16 a[40:43], v[32:35], v[48:51], a[40:43]
    v_mfma_f32_16x16x32_bf16 a[44:47], v[32:35], v[52:55], a[44:47]
    v_mfma_f32_16x16x32_bf16 a[48:51], v[36:39], v[40:43], a[48:51]
    v_mfma_f32_16x16x32_bf16 a[52:55], v[36:39], v[44:47], a[52:55]
    v_mfma_f32_16x16x32_bf16 a[56:59], v[36:39], v[48:51], a[56:59]
    v_mfma_f32_16x16x32_bf16 a[60:63], v[36:39], v[52:55], a[60:63]
    s_waitcnt vmcnt(24)
    v_mfma_f32_16x16x32_bf16 a[32:35], v[56:59], v[64:67], a[32:35]
    v_mfma_f32_16x16x32_bf16 a[36:39], v[56:59], v[68:71], a[36:39]
    v_mfma_f32_16x16x32_bf16 a[40:43], v[56:59], v[72:75], a[40:43]
    v_mfma_f32_16x16x32_bf16 a[44:47], v[56:59], v[76:79], a[44:47]
    v_mfma_f32_16x16x32_bf16 a[48:51], v[60:63], v[64:67], a[48:51]
    v_mfma_f32_16x16x32_bf16 a[52:55], v[60:63], v[68:71], a[52:55]
    v_mfma_f32_16x16x32_bf16 a[56:59], v[60:63], v[72:75], a[56:59]
    v_mfma_f32_16x16x32_bf16 a[60:63], v[60:63], v[76:79], a[60:63]
    s_waitcnt vmcnt(18)
    v_mfma_f32_16x16x32_bf16 a[32:35], v[80:83], v[88:91], a[32:35]
    v_mfma_f32_16x16x32_bf16 a[36:39], v[80:83], v[92:95], a[36:39]
    v_mfma_f32_16x16x32_bf16 a[40:43], v[80:83], v[96:99], a[40:43]
    v_mfma_f32_16x16x32_bf16 a[44:47], v[80:83], v[100:103], a[44:47]
    v_mfma_f32_16x16x32_bf16 a[48:51], v[84:87], v[88:91], a[48:51]
    v_mfma_f32_16x16x32_bf16 a[52:55], v[84:87], v[92:95], a[52:55]
    v_mfma_f32_16x16x32_bf16 a[56:59], v[84:87], v[96:99], a[56:59]
    v_mfma_f32_16x16x32_bf16 a[60:63], v[84:87], v[100:103], a[60:63]
    s_waitcnt vmcnt(12)
    v_mfma_f32_16x16x32_bf16 a[32:35], v[104:107], v[112:115], a[32:35]
    v_mfma_f32_16x16x32_bf16 a[36:39], v[104:107], v[116:119], a[36:39]
    v_mfma_f32_16x16x32_bf16 a[40:43], v[104:107], v[120:123], a[40:43]
    v_mfma_f32_16x16x32_bf16 a[44:47], v[104:107], v[124:127], a[44:47]
    v_mfma_f32_16x16x32_bf16 a[48:51], v[108:111], v[112:115], a[48:51]
    v_mfma_f32_16x16x32_bf16 a[52:55], v[108:111], v[116:119], a[52:55]
    v_mfma_f32_16x16x32_bf16 a[56:59], v[108:111], v[120:123], a[56:59]
    v_mfma_f32_16x16x32_bf16 a[60:63], v[108:111], v[124:127], a[60:63]
    s_waitcnt vmcnt(6)
    v_mfma_f32_16x16x32_bf16 a[32:35], v[128:131], v[136:139], a[32:35]
    v_mfma_f32_16x16x32_bf16 a[36:39], v[128:131], v[140:143], a[36:39]
    v_mfma_f32_16x16x32_bf16 a[40:43], v[128:131], v[144:147], a[40:43]
    v_mfma_f32_16x16x32_bf16 a[44:47], v[128:131], v[148:151], a[44:47]
    v_mfma_f32_16x16x32_bf16 a[48:51], v[132:135], v[136:139], a[48:51]
    v_mfma_f32_16x16x32_bf16 a[52:55], v[132:135], v[140:143], a[52:55]
    v_mfma_f32_16x16x32_bf16 a[56:59], v[132:135], v[144:147], a[56:59]
    v_mfma_f32_16x16x32_bf16 a[60:63], v[132:135], v[148:151], a[60:63]
    s_waitcnt vmcnt(0)
    v_mfma_f32_16x16x32_bf16 a[32:35], v[152:155], v[160:163], a[32:35]
    v_mfma_f32_16x16x32_bf16 a[36:39], v[152:155], v[164:167], a[36:39]
    v_mfma_f32_16x16x32_bf16 a[40:43], v[152:155], v[168:171], a[40:43]
    v_mfma_f32_16x16x32_bf16 a[44:47], v[152:155], v[172:175], a[44:47]
    v_mfma_f32_16x16x32_bf16 a[48:51], v[156:159], v[160:163], a[48:51]
    v_mfma_f32_16x16x32_bf16 a[52:55], v[156:159], v[164:167], a[52:55]
    v_mfma_f32_16x16x32_bf16 a[56:59], v[156:159], v[168:171], a[56:59]
    v_mfma_f32_16x16x32_bf16 a[60:63], v[156:159], v[172:175], a[60:63]
    s_lshl_b32 s10, s92, 2
    s_add_u32 s10, s10, 119542016
    v_mov_b32 v10, s10
    v_mov_b32 v11, 16

    s_mov_b64 exec, 1
    s_mov_b32 s19, 1048576

L_w_pg2_loop:
    buffer_load_dword v12, v10, s[40:43], 0 offen sc0 sc1
    s_waitcnt vmcnt(0)
    v_cmp_lt_u32 vcc, v12, v11
    s_cbranch_vccz L_w_pg2_ok
    s_sleep 3
    s_sub_u32 s19, s19, 1
    s_cmp_lg_u32 s19, 0
    s_cbranch_scc1 L_w_pg2_loop
    s_mov_b64 exec, -1
    s_branch L_ch_done

L_w_pg2_ok:
    s_mov_b64 exec, -1
    buffer_load_dwordx4 v[32:35], v1, s[40:43], s20 offen offset:0
    buffer_load_dwordx4 v[36:39], v1, s[40:43], s21 offen offset:0
    buffer_load_dwordx4 v[40:43], v1, s[40:43], s22 offen offset:0 sc0 sc1
    buffer_load_dwordx4 v[44:47], v1, s[40:43], s23 offen offset:0 sc0 sc1
    buffer_load_dwordx4 v[48:51], v1, s[40:43], s24 offen offset:0 sc0 sc1
    buffer_load_dwordx4 v[52:55], v1, s[40:43], s25 offen offset:0 sc0 sc1
    buffer_load_dwordx4 v[56:59], v1, s[40:43], s20 offen offset:1024
    buffer_load_dwordx4 v[60:63], v1, s[40:43], s21 offen offset:1024
    buffer_load_dwordx4 v[64:67], v1, s[40:43], s22 offen offset:1024 sc0 sc1
    buffer_load_dwordx4 v[68:71], v1, s[40:43], s23 offen offset:1024 sc0 sc1
    buffer_load_dwordx4 v[72:75], v1, s[40:43], s24 offen offset:1024 sc0 sc1
    buffer_load_dwordx4 v[76:79], v1, s[40:43], s25 offen offset:1024 sc0 sc1
    buffer_load_dwordx4 v[80:83], v1, s[40:43], s20 offen offset:2048
    buffer_load_dwordx4 v[84:87], v1, s[40:43], s21 offen offset:2048
    buffer_load_dwordx4 v[88:91], v1, s[40:43], s22 offen offset:2048 sc0 sc1
    buffer_load_dwordx4 v[92:95], v1, s[40:43], s23 offen offset:2048 sc0 sc1
    buffer_load_dwordx4 v[96:99], v1, s[40:43], s24 offen offset:2048 sc0 sc1
    buffer_load_dwordx4 v[100:103], v1, s[40:43], s25 offen offset:2048 sc0 sc1
    buffer_load_dwordx4 v[104:107], v1, s[40:43], s20 offen offset:3072
    buffer_load_dwordx4 v[108:111], v1, s[40:43], s21 offen offset:3072
    buffer_load_dwordx4 v[112:115], v1, s[40:43], s22 offen offset:3072 sc0 sc1
    buffer_load_dwordx4 v[116:119], v1, s[40:43], s23 offen offset:3072 sc0 sc1
    buffer_load_dwordx4 v[120:123], v1, s[40:43], s24 offen offset:3072 sc0 sc1
    buffer_load_dwordx4 v[124:127], v1, s[40:43], s25 offen offset:3072 sc0 sc1
    s_add_u32 s20, s20, 4096
    s_add_u32 s21, s21, 4096
    s_add_u32 s22, s22, 4096
    s_add_u32 s23, s23, 4096
    s_add_u32 s24, s24, 4096
    s_add_u32 s25, s25, 4096
    buffer_load_dwordx4 v[128:131], v1, s[40:43], s20 offen offset:0
    buffer_load_dwordx4 v[132:135], v1, s[40:43], s21 offen offset:0
    buffer_load_dwordx4 v[136:139], v1, s[40:43], s22 offen offset:0 sc0 sc1
    buffer_load_dwordx4 v[140:143], v1, s[40:43], s23 offen offset:0 sc0 sc1
    buffer_load_dwordx4 v[144:147], v1, s[40:43], s24 offen offset:0 sc0 sc1
    buffer_load_dwordx4 v[148:151], v1, s[40:43], s25 offen offset:0 sc0 sc1
    buffer_load_dwordx4 v[152:155], v1, s[40:43], s20 offen offset:1024
    buffer_load_dwordx4 v[156:159], v1, s[40:43], s21 offen offset:1024
    buffer_load_dwordx4 v[160:163], v1, s[40:43], s22 offen offset:1024 sc0 sc1
    buffer_load_dwordx4 v[164:167], v1, s[40:43], s23 offen offset:1024 sc0 sc1
    buffer_load_dwordx4 v[168:171], v1, s[40:43], s24 offen offset:1024 sc0 sc1
    buffer_load_dwordx4 v[172:175], v1, s[40:43], s25 offen offset:1024 sc0 sc1
    buffer_load_dwordx4 v[176:179], v1, s[40:43], s20 offen offset:2048
    buffer_load_dwordx4 v[180:183], v1, s[40:43], s21 offen offset:2048
    buffer_load_dwordx4 v[184:187], v1, s[40:43], s22 offen offset:2048 sc0 sc1
    buffer_load_dwordx4 v[188:191], v1, s[40:43], s23 offen offset:2048 sc0 sc1
    buffer_load_dwordx4 v[192:195], v1, s[40:43], s24 offen offset:2048 sc0 sc1
    buffer_load_dwordx4 v[196:199], v1, s[40:43], s25 offen offset:2048 sc0 sc1
    buffer_load_dwordx4 v[200:203], v1, s[40:43], s20 offen offset:3072
    buffer_load_dwordx4 v[204:207], v1, s[40:43], s21 offen offset:3072
    buffer_load_dwordx4 v[208:211], v1, s[40:43], s22 offen offset:3072 sc0 sc1
    buffer_load_dwordx4 v[212:215], v1, s[40:43], s23 offen offset:3072 sc0 sc1
    buffer_load_dwordx4 v[216:219], v1, s[40:43], s24 offen offset:3072 sc0 sc1
    buffer_load_dwordx4 v[220:223], v1, s[40:43], s25 offen offset:3072 sc0 sc1
    s_waitcnt vmcnt(42)
    v_mfma_f32_16x16x32_bf16 a[0:3], v[32:35], v[40:43], a[0:3]
    v_mfma_f32_16x16x32_bf16 a[4:7], v[32:35], v[44:47], a[4:7]
    v_mfma_f32_16x16x32_bf16 a[8:11], v[32:35], v[48:51], a[8:11]
    v_mfma_f32_16x16x32_bf16 a[12:15], v[32:35], v[52:55], a[12:15]
    v_mfma_f32_16x16x32_bf16 a[16:19], v[36:39], v[40:43], a[16:19]
    v_mfma_f32_16x16x32_bf16 a[20:23], v[36:39], v[44:47], a[20:23]
    v_mfma_f32_16x16x32_bf16 a[24:27], v[36:39], v[48:51], a[24:27]
    v_mfma_f32_16x16x32_bf16 a[28:31], v[36:39], v[52:55], a[28:31]
    s_add_u32 s20, s20, 4096
    s_add_u32 s21, s21, 4096
    s_add_u32 s22, s22, 4096
    s_add_u32 s23, s23, 4096
    s_add_u32 s24, s24, 4096
    s_add_u32 s25, s25, 4096
    buffer_load_dwordx4 v[32:35], v1, s[40:43], s20 offen offset:0
    buffer_load_dwordx4 v[36:39], v1, s[40:43], s21 offen offset:0
    buffer_load_dwordx4 v[40:43], v1, s[40:43], s22 offen offset:0 sc0 sc1
    buffer_load_dwordx4 v[44:47], v1, s[40:43], s23 offen offset:0 sc0 sc1
    buffer_load_dwordx4 v[48:51], v1, s[40:43], s24 offen offset:0 sc0 sc1
    buffer_load_dwordx4 v[52:55], v1, s[40:43], s25 offen offset:0 sc0 sc1
    s_waitcnt vmcnt(42)
    v_mfma_f32_16x16x32_bf16 a[0:3], v[56:59], v[64:67], a[0:3]
    v_mfma_f32_16x16x32_bf16 a[4:7], v[56:59], v[68:71], a[4:7]
    v_mfma_f32_16x16x32_bf16 a[8:11], v[56:59], v[72:75], a[8:11]
    v_mfma_f32_16x16x32_bf16 a[12:15], v[56:59], v[76:79], a[12:15]
    v_mfma_f32_16x16x32_bf16 a[16:19], v[60:63], v[64:67], a[16:19]
    v_mfma_f32_16x16x32_bf16 a[20:23], v[60:63], v[68:71], a[20:23]
    v_mfma_f32_16x16x32_bf16 a[24:27], v[60:63], v[72:75], a[24:27]
    v_mfma_f32_16x16x32_bf16 a[28:31], v[60:63], v[76:79], a[28:31]
    buffer_load_dwordx4 v[56:59], v1, s[40:43], s20 offen offset:1024
    buffer_load_dwordx4 v[60:63], v1, s[40:43], s21 offen offset:1024
    buffer_load_dwordx4 v[64:67], v1, s[40:43], s22 offen offset:1024 sc0 sc1
    buffer_load_dwordx4 v[68:71], v1, s[40:43], s23 offen offset:1024 sc0 sc1
    buffer_load_dwordx4 v[72:75], v1, s[40:43], s24 offen offset:1024 sc0 sc1
    buffer_load_dwordx4 v[76:79], v1, s[40:43], s25 offen offset:1024 sc0 sc1
    s_waitcnt vmcnt(42)
    v_mfma_f32_16x16x32_bf16 a[0:3], v[80:83], v[88:91], a[0:3]
    v_mfma_f32_16x16x32_bf16 a[4:7], v[80:83], v[92:95], a[4:7]
    v_mfma_f32_16x16x32_bf16 a[8:11], v[80:83], v[96:99], a[8:11]
    v_mfma_f32_16x16x32_bf16 a[12:15], v[80:83], v[100:103], a[12:15]
    v_mfma_f32_16x16x32_bf16 a[16:19], v[84:87], v[88:91], a[16:19]
    v_mfma_f32_16x16x32_bf16 a[20:23], v[84:87], v[92:95], a[20:23]
    v_mfma_f32_16x16x32_bf16 a[24:27], v[84:87], v[96:99], a[24:27]
    v_mfma_f32_16x16x32_bf16 a[28:31], v[84:87], v[100:103], a[28:31]
    buffer_load_dwordx4 v[80:83], v1, s[40:43], s20 offen offset:2048
    buffer_load_dwordx4 v[84:87], v1, s[40:43], s21 offen offset:2048
    buffer_load_dwordx4 v[88:91], v1, s[40:43], s22 offen offset:2048 sc0 sc1
    buffer_load_dwordx4 v[92:95], v1, s[40:43], s23 offen offset:2048 sc0 sc1
    buffer_load_dwordx4 v[96:99], v1, s[40:43], s24 offen offset:2048 sc0 sc1
    buffer_load_dwordx4 v[100:103], v1, s[40:43], s25 offen offset:2048 sc0 sc1
    s_waitcnt vmcnt(42)
    v_mfma_f32_16x16x32_bf16 a[0:3], v[104:107], v[112:115], a[0:3]
    v_mfma_f32_16x16x32_bf16 a[4:7], v[104:107], v[116:119], a[4:7]
    v_mfma_f32_16x16x32_bf16 a[8:11], v[104:107], v[120:123], a[8:11]
    v_mfma_f32_16x16x32_bf16 a[12:15], v[104:107], v[124:127], a[12:15]
    v_mfma_f32_16x16x32_bf16 a[16:19], v[108:111], v[112:115], a[16:19]
    v_mfma_f32_16x16x32_bf16 a[20:23], v[108:111], v[116:119], a[20:23]
    v_mfma_f32_16x16x32_bf16 a[24:27], v[108:111], v[120:123], a[24:27]
    v_mfma_f32_16x16x32_bf16 a[28:31], v[108:111], v[124:127], a[28:31]
    buffer_load_dwordx4 v[104:107], v1, s[40:43], s20 offen offset:3072
    buffer_load_dwordx4 v[108:111], v1, s[40:43], s21 offen offset:3072
    buffer_load_dwordx4 v[112:115], v1, s[40:43], s22 offen offset:3072 sc0 sc1
    buffer_load_dwordx4 v[116:119], v1, s[40:43], s23 offen offset:3072 sc0 sc1
    buffer_load_dwordx4 v[120:123], v1, s[40:43], s24 offen offset:3072 sc0 sc1
    buffer_load_dwordx4 v[124:127], v1, s[40:43], s25 offen offset:3072 sc0 sc1
    s_waitcnt vmcnt(42)
    v_mfma_f32_16x16x32_bf16 a[0:3], v[128:131], v[136:139], a[0:3]
    v_mfma_f32_16x16x32_bf16 a[4:7], v[128:131], v[140:143], a[4:7]
    v_mfma_f32_16x16x32_bf16 a[8:11], v[128:131], v[144:147], a[8:11]
    v_mfma_f32_16x16x32_bf16 a[12:15], v[128:131], v[148:151], a[12:15]
    v_mfma_f32_16x16x32_bf16 a[16:19], v[132:135], v[136:139], a[16:19]
    v_mfma_f32_16x16x32_bf16 a[20:23], v[132:135], v[140:143], a[20:23]
    v_mfma_f32_16x16x32_bf16 a[24:27], v[132:135], v[144:147], a[24:27]
    v_mfma_f32_16x16x32_bf16 a[28:31], v[132:135], v[148:151], a[28:31]
    s_add_u32 s20, s20, 4096
    s_add_u32 s21, s21, 4096
    s_add_u32 s22, s22, 4096
    s_add_u32 s23, s23, 4096
    s_add_u32 s24, s24, 4096
    s_add_u32 s25, s25, 4096
    buffer_load_dwordx4 v[128:131], v1, s[40:43], s20 offen offset:0
    buffer_load_dwordx4 v[132:135], v1, s[40:43], s21 offen offset:0
    buffer_load_dwordx4 v[136:139], v1, s[40:43], s22 offen offset:0 sc0 sc1
    buffer_load_dwordx4 v[140:143], v1, s[40:43], s23 offen offset:0 sc0 sc1
    buffer_load_dwordx4 v[144:147], v1, s[40:43], s24 offen offset:0 sc0 sc1
    buffer_load_dwordx4 v[148:151], v1, s[40:43], s25 offen offset:0 sc0 sc1
    s_waitcnt vmcnt(42)
    v_mfma_f32_16x16x32_bf16 a[0:3], v[152:155], v[160:163], a[0:3]
    v_mfma_f32_16x16x32_bf16 a[4:7], v[152:155], v[164:167], a[4:7]
    v_mfma_f32_16x16x32_bf16 a[8:11], v[152:155], v[168:171], a[8:11]
    v_mfma_f32_16x16x32_bf16 a[12:15], v[152:155], v[172:175], a[12:15]
    v_mfma_f32_16x16x32_bf16 a[16:19], v[156:159], v[160:163], a[16:19]
    v_mfma_f32_16x16x32_bf16 a[20:23], v[156:159], v[164:167], a[20:23]
    v_mfma_f32_16x16x32_bf16 a[24:27], v[156:159], v[168:171], a[24:27]
    v_mfma_f32_16x16x32_bf16 a[28:31], v[156:159], v[172:175], a[28:31]
    buffer_load_dwordx4 v[152:155], v1, s[40:43], s20 offen offset:1024
    buffer_load_dwordx4 v[156:159], v1, s[40:43], s21 offen offset:1024
    buffer_load_dwordx4 v[160:163], v1, s[40:43], s22 offen offset:1024 sc0 sc1
    buffer_load_dwordx4 v[164:167], v1, s[40:43], s23 offen offset:1024 sc0 sc1
    buffer_load_dwordx4 v[168:171], v1, s[40:43], s24 offen offset:1024 sc0 sc1
    buffer_load_dwordx4 v[172:175], v1, s[40:43], s25 offen offset:1024 sc0 sc1
    s_waitcnt vmcnt(42)
    v_mfma_f32_16x16x32_bf16 a[0:3], v[176:179], v[184:187], a[0:3]
    v_mfma_f32_16x16x32_bf16 a[4:7], v[176:179], v[188:191], a[4:7]
    v_mfma_f32_16x16x32_bf16 a[8:11], v[176:179], v[192:195], a[8:11]
    v_mfma_f32_16x16x32_bf16 a[12:15], v[176:179], v[196:199], a[12:15]
    v_mfma_f32_16x16x32_bf16 a[16:19], v[180:183], v[184:187], a[16:19]
    v_mfma_f32_16x16x32_bf16 a[20:23], v[180:183], v[188:191], a[20:23]
    v_mfma_f32_16x16x32_bf16 a[24:27], v[180:183], v[192:195], a[24:27]
    v_mfma_f32_16x16x32_bf16 a[28:31], v[180:183], v[196:199], a[28:31]
    buffer_load_dwordx4 v[176:179], v1, s[40:43], s20 offen offset:2048
    buffer_load_dwordx4 v[180:183], v1, s[40:43], s21 offen offset:2048
    buffer_load_dwordx4 v[184:187], v1, s[40:43], s22 offen offset:2048 sc0 sc1
    buffer_load_dwordx4 v[188:191], v1, s[40:43], s23 offen offset:2048 sc0 sc1
    buffer_load_dwordx4 v[192:195], v1, s[40:43], s24 offen offset:2048 sc0 sc1
    buffer_load_dwordx4 v[196:199], v1, s[40:43], s25 offen offset:2048 sc0 sc1
    s_waitcnt vmcnt(42)
    v_mfma_f32_16x16x32_bf16 a[0:3], v[200:203], v[208:211], a[0:3]
    v_mfma_f32_16x16x32_bf16 a[4:7], v[200:203], v[212:215], a[4:7]
    v_mfma_f32_16x16x32_bf16 a[8:11], v[200:203], v[216:219], a[8:11]
    v_mfma_f32_16x16x32_bf16 a[12:15], v[200:203], v[220:223], a[12:15]
    v_mfma_f32_16x16x32_bf16 a[16:19], v[204:207], v[208:211], a[16:19]
    v_mfma_f32_16x16x32_bf16 a[20:23], v[204:207], v[212:215], a[20:23]
    v_mfma_f32_16x16x32_bf16 a[24:27], v[204:207], v[216:219], a[24:27]
    v_mfma_f32_16x16x32_bf16 a[28:31], v[204:207], v[220:223], a[28:31]
    buffer_load_dwordx4 v[200:203], v1, s[40:43], s20 offen offset:3072
    buffer_load_dwordx4 v[204:207], v1, s[40:43], s21 offen offset:3072
    buffer_load_dwordx4 v[208:211], v1, s[40:43], s22 offen offset:3072 sc0 sc1
    buffer_load_dwordx4 v[212:215], v1, s[40:43], s23 offen offset:3072 sc0 sc1
    buffer_load_dwordx4 v[216:219], v1, s[40:43], s24 offen offset:3072 sc0 sc1
    buffer_load_dwordx4 v[220:223], v1, s[40:43], s25 offen offset:3072 sc0 sc1
    s_waitcnt vmcnt(42)
    v_mfma_f32_16x16x32_bf16 a[0:3], v[32:35], v[40:43], a[0:3]
    v_mfma_f32_16x16x32_bf16 a[4:7], v[32:35], v[44:47], a[4:7]
    v_mfma_f32_16x16x32_bf16 a[8:11], v[32:35], v[48:51], a[8:11]
    v_mfma_f32_16x16x32_bf16 a[12:15], v[32:35], v[52:55], a[12:15]
    v_mfma_f32_16x16x32_bf16 a[16:19], v[36:39], v[40:43], a[16:19]
    v_mfma_f32_16x16x32_bf16 a[20:23], v[36:39], v[44:47], a[20:23]
    v_mfma_f32_16x16x32_bf16 a[24:27], v[36:39], v[48:51], a[24:27]
    v_mfma_f32_16x16x32_bf16 a[28:31], v[36:39], v[52:55], a[28:31]
    s_add_u32 s20, s20, 4096
    s_add_u32 s21, s21, 4096
    s_add_u32 s22, s22, 4096
    s_add_u32 s23, s23, 4096
    s_add_u32 s24, s24, 4096
    s_add_u32 s25, s25, 4096
    buffer_load_dwordx4 v[32:35], v1, s[40:43], s20 offen offset:0
    buffer_load_dwordx4 v[36:39], v1, s[40:43], s21 offen offset:0
    buffer_load_dwordx4 v[40:43], v1, s[40:43], s22 offen offset:0 sc0 sc1
    buffer_load_dwordx4 v[44:47], v1, s[40:43], s23 offen offset:0 sc0 sc1
    buffer_load_dwordx4 v[48:51], v1, s[40:43], s24 offen offset:0 sc0 sc1
    buffer_load_dwordx4 v[52:55], v1, s[40:43], s25 offen offset:0 sc0 sc1
    s_waitcnt vmcnt(42)
    v_mfma_f32_16x16x32_bf16 a[0:3], v[56:59], v[64:67], a[0:3]
    v_mfma_f32_16x16x32_bf16 a[4:7], v[56:59], v[68:71], a[4:7]
    v_mfma_f32_16x16x32_bf16 a[8:11], v[56:59], v[72:75], a[8:11]
    v_mfma_f32_16x16x32_bf16 a[12:15], v[56:59], v[76:79], a[12:15]
    v_mfma_f32_16x16x32_bf16 a[16:19], v[60:63], v[64:67], a[16:19]
    v_mfma_f32_16x16x32_bf16 a[20:23], v[60:63], v[68:71], a[20:23]
    v_mfma_f32_16x16x32_bf16 a[24:27], v[60:63], v[72:75], a[24:27]
    v_mfma_f32_16x16x32_bf16 a[28:31], v[60:63], v[76:79], a[28:31]
    buffer_load_dwordx4 v[56:59], v1, s[40:43], s20 offen offset:1024
    buffer_load_dwordx4 v[60:63], v1, s[40:43], s21 offen offset:1024
    buffer_load_dwordx4 v[64:67], v1, s[40:43], s22 offen offset:1024 sc0 sc1
    buffer_load_dwordx4 v[68:71], v1, s[40:43], s23 offen offset:1024 sc0 sc1
    buffer_load_dwordx4 v[72:75], v1, s[40:43], s24 offen offset:1024 sc0 sc1
    buffer_load_dwordx4 v[76:79], v1, s[40:43], s25 offen offset:1024 sc0 sc1
    s_waitcnt vmcnt(42)
    v_mfma_f32_16x16x32_bf16 a[0:3], v[80:83], v[88:91], a[0:3]
    v_mfma_f32_16x16x32_bf16 a[4:7], v[80:83], v[92:95], a[4:7]
    v_mfma_f32_16x16x32_bf16 a[8:11], v[80:83], v[96:99], a[8:11]
    v_mfma_f32_16x16x32_bf16 a[12:15], v[80:83], v[100:103], a[12:15]
    v_mfma_f32_16x16x32_bf16 a[16:19], v[84:87], v[88:91], a[16:19]
    v_mfma_f32_16x16x32_bf16 a[20:23], v[84:87], v[92:95], a[20:23]
    v_mfma_f32_16x16x32_bf16 a[24:27], v[84:87], v[96:99], a[24:27]
    v_mfma_f32_16x16x32_bf16 a[28:31], v[84:87], v[100:103], a[28:31]
    buffer_load_dwordx4 v[80:83], v1, s[40:43], s20 offen offset:2048
    buffer_load_dwordx4 v[84:87], v1, s[40:43], s21 offen offset:2048
    buffer_load_dwordx4 v[88:91], v1, s[40:43], s22 offen offset:2048 sc0 sc1
    buffer_load_dwordx4 v[92:95], v1, s[40:43], s23 offen offset:2048 sc0 sc1
    buffer_load_dwordx4 v[96:99], v1, s[40:43], s24 offen offset:2048 sc0 sc1
    buffer_load_dwordx4 v[100:103], v1, s[40:43], s25 offen offset:2048 sc0 sc1
    s_waitcnt vmcnt(42)
    v_mfma_f32_16x16x32_bf16 a[0:3], v[104:107], v[112:115], a[0:3]
    v_mfma_f32_16x16x32_bf16 a[4:7], v[104:107], v[116:119], a[4:7]
    v_mfma_f32_16x16x32_bf16 a[8:11], v[104:107], v[120:123], a[8:11]
    v_mfma_f32_16x16x32_bf16 a[12:15], v[104:107], v[124:127], a[12:15]
    v_mfma_f32_16x16x32_bf16 a[16:19], v[108:111], v[112:115], a[16:19]
    v_mfma_f32_16x16x32_bf16 a[20:23], v[108:111], v[116:119], a[20:23]
    v_mfma_f32_16x16x32_bf16 a[24:27], v[108:111], v[120:123], a[24:27]
    v_mfma_f32_16x16x32_bf16 a[28:31], v[108:111], v[124:127], a[28:31]
    buffer_load_dwordx4 v[104:107], v1, s[40:43], s20 offen offset:3072
    buffer_load_dwordx4 v[108:111], v1, s[40:43], s21 offen offset:3072
    buffer_load_dwordx4 v[112:115], v1, s[40:43], s22 offen offset:3072 sc0 sc1
    buffer_load_dwordx4 v[116:119], v1, s[40:43], s23 offen offset:3072 sc0 sc1
    buffer_load_dwordx4 v[120:123], v1, s[40:43], s24 offen offset:3072 sc0 sc1
    buffer_load_dwordx4 v[124:127], v1, s[40:43], s25 offen offset:3072 sc0 sc1
    s_waitcnt vmcnt(42)
    v_mfma_f32_16x16x32_bf16 a[0:3], v[128:131], v[136:139], a[0:3]
    v_mfma_f32_16x16x32_bf16 a[4:7], v[128:131], v[140:143], a[4:7]
    v_mfma_f32_16x16x32_bf16 a[8:11], v[128:131], v[144:147], a[8:11]
    v_mfma_f32_16x16x32_bf16 a[12:15], v[128:131], v[148:151], a[12:15]
    v_mfma_f32_16x16x32_bf16 a[16:19], v[132:135], v[136:139], a[16:19]
    v_mfma_f32_16x16x32_bf16 a[20:23], v[132:135], v[140:143], a[20:23]
    v_mfma_f32_16x16x32_bf16 a[24:27], v[132:135], v[144:147], a[24:27]
    v_mfma_f32_16x16x32_bf16 a[28:31], v[132:135], v[148:151], a[28:31]
    s_add_u32 s20, s20, 4096
    s_add_u32 s21, s21, 4096
    s_add_u32 s22, s22, 4096
    s_add_u32 s23, s23, 4096
    s_add_u32 s24, s24, 4096
    s_add_u32 s25, s25, 4096
    buffer_load_dwordx4 v[128:131], v1, s[40:43], s20 offen offset:0
    buffer_load_dwordx4 v[132:135], v1, s[40:43], s21 offen offset:0
    buffer_load_dwordx4 v[136:139], v1, s[40:43], s22 offen offset:0 sc0 sc1
    buffer_load_dwordx4 v[140:143], v1, s[40:43], s23 offen offset:0 sc0 sc1
    buffer_load_dwordx4 v[144:147], v1, s[40:43], s24 offen offset:0 sc0 sc1
    buffer_load_dwordx4 v[148:151], v1, s[40:43], s25 offen offset:0 sc0 sc1
    s_waitcnt vmcnt(42)
    v_mfma_f32_16x16x32_bf16 a[0:3], v[152:155], v[160:163], a[0:3]
    v_mfma_f32_16x16x32_bf16 a[4:7], v[152:155], v[164:167], a[4:7]
    v_mfma_f32_16x16x32_bf16 a[8:11], v[152:155], v[168:171], a[8:11]
    v_mfma_f32_16x16x32_bf16 a[12:15], v[152:155], v[172:175], a[12:15]
    v_mfma_f32_16x16x32_bf16 a[16:19], v[156:159], v[160:163], a[16:19]
    v_mfma_f32_16x16x32_bf16 a[20:23], v[156:159], v[164:167], a[20:23]
    v_mfma_f32_16x16x32_bf16 a[24:27], v[156:159], v[168:171], a[24:27]
    v_mfma_f32_16x16x32_bf16 a[28:31], v[156:159], v[172:175], a[28:31]
    buffer_load_dwordx4 v[152:155], v1, s[40:43], s20 offen offset:1024
    buffer_load_dwordx4 v[156:159], v1, s[40:43], s21 offen offset:1024
    buffer_load_dwordx4 v[160:163], v1, s[40:43], s22 offen offset:1024 sc0 sc1
    buffer_load_dwordx4 v[164:167], v1, s[40:43], s23 offen offset:1024 sc0 sc1
    buffer_load_dwordx4 v[168:171], v1, s[40:43], s24 offen offset:1024 sc0 sc1
    buffer_load_dwordx4 v[172:175], v1, s[40:43], s25 offen offset:1024 sc0 sc1
    s_waitcnt vmcnt(42)
    v_mfma_f32_16x16x32_bf16 a[0:3], v[176:179], v[184:187], a[0:3]
    v_mfma_f32_16x16x32_bf16 a[4:7], v[176:179], v[188:191], a[4:7]
    v_mfma_f32_16x16x32_bf16 a[8:11], v[176:179], v[192:195], a[8:11]
    v_mfma_f32_16x16x32_bf16 a[12:15], v[176:179], v[196:199], a[12:15]
    v_mfma_f32_16x16x32_bf16 a[16:19], v[180:183], v[184:187], a[16:19]
    v_mfma_f32_16x16x32_bf16 a[20:23], v[180:183], v[188:191], a[20:23]
    v_mfma_f32_16x16x32_bf16 a[24:27], v[180:183], v[192:195], a[24:27]
    v_mfma_f32_16x16x32_bf16 a[28:31], v[180:183], v[196:199], a[28:31]
    buffer_load_dwordx4 v[176:179], v1, s[40:43], s20 offen offset:2048
    buffer_load_dwordx4 v[180:183], v1, s[40:43], s21 offen offset:2048
    buffer_load_dwordx4 v[184:187], v1, s[40:43], s22 offen offset:2048 sc0 sc1
    buffer_load_dwordx4 v[188:191], v1, s[40:43], s23 offen offset:2048 sc0 sc1
    buffer_load_dwordx4 v[192:195], v1, s[40:43], s24 offen offset:2048 sc0 sc1
    buffer_load_dwordx4 v[196:199], v1, s[40:43], s25 offen offset:2048 sc0 sc1
    s_waitcnt vmcnt(42)
    v_mfma_f32_16x16x32_bf16 a[0:3], v[200:203], v[208:211], a[0:3]
    v_mfma_f32_16x16x32_bf16 a[4:7], v[200:203], v[212:215], a[4:7]
    v_mfma_f32_16x16x32_bf16 a[8:11], v[200:203], v[216:219], a[8:11]
    v_mfma_f32_16x16x32_bf16 a[12:15], v[200:203], v[220:223], a[12:15]
    v_mfma_f32_16x16x32_bf16 a[16:19], v[204:207], v[208:211], a[16:19]
    v_mfma_f32_16x16x32_bf16 a[20:23], v[204:207], v[212:215], a[20:23]
    v_mfma_f32_16x16x32_bf16 a[24:27], v[204:207], v[216:219], a[24:27]
    v_mfma_f32_16x16x32_bf16 a[28:31], v[204:207], v[220:223], a[28:31]
    buffer_load_dwordx4 v[200:203], v1, s[40:43], s20 offen offset:3072
    buffer_load_dwordx4 v[204:207], v1, s[40:43], s21 offen offset:3072
    buffer_load_dwordx4 v[208:211], v1, s[40:43], s22 offen offset:3072 sc0 sc1
    buffer_load_dwordx4 v[212:215], v1, s[40:43], s23 offen offset:3072 sc0 sc1
    buffer_load_dwordx4 v[216:219], v1, s[40:43], s24 offen offset:3072 sc0 sc1
    buffer_load_dwordx4 v[220:223], v1, s[40:43], s25 offen offset:3072 sc0 sc1
    s_waitcnt vmcnt(42)
    v_mfma_f32_16x16x32_bf16 a[0:3], v[32:35], v[40:43], a[0:3]
    v_mfma_f32_16x16x32_bf16 a[4:7], v[32:35], v[44:47], a[4:7]
    v_mfma_f32_16x16x32_bf16 a[8:11], v[32:35], v[48:51], a[8:11]
    v_mfma_f32_16x16x32_bf16 a[12:15], v[32:35], v[52:55], a[12:15]
    v_mfma_f32_16x16x32_bf16 a[16:19], v[36:39], v[40:43], a[16:19]
    v_mfma_f32_16x16x32_bf16 a[20:23], v[36:39], v[44:47], a[20:23]
    v_mfma_f32_16x16x32_bf16 a[24:27], v[36:39], v[48:51], a[24:27]
    v_mfma_f32_16x16x32_bf16 a[28:31], v[36:39], v[52:55], a[28:31]
    s_add_u32 s20, s20, 4096
    s_add_u32 s21, s21, 4096
    s_add_u32 s22, s22, 4096
    s_add_u32 s23, s23, 4096
    s_add_u32 s24, s24, 4096
    s_add_u32 s25, s25, 4096
    buffer_load_dwordx4 v[32:35], v1, s[40:43], s20 offen offset:0
    buffer_load_dwordx4 v[36:39], v1, s[40:43], s21 offen offset:0
    buffer_load_dwordx4 v[40:43], v1, s[40:43], s22 offen offset:0 sc0 sc1
    buffer_load_dwordx4 v[44:47], v1, s[40:43], s23 offen offset:0 sc0 sc1
    buffer_load_dwordx4 v[48:51], v1, s[40:43], s24 offen offset:0 sc0 sc1
    buffer_load_dwordx4 v[52:55], v1, s[40:43], s25 offen offset:0 sc0 sc1
    s_waitcnt vmcnt(42)
    v_mfma_f32_16x16x32_bf16 a[0:3], v[56:59], v[64:67], a[0:3]
    v_mfma_f32_16x16x32_bf16 a[4:7], v[56:59], v[68:71], a[4:7]
    v_mfma_f32_16x16x32_bf16 a[8:11], v[56:59], v[72:75], a[8:11]
    v_mfma_f32_16x16x32_bf16 a[12:15], v[56:59], v[76:79], a[12:15]
    v_mfma_f32_16x16x32_bf16 a[16:19], v[60:63], v[64:67], a[16:19]
    v_mfma_f32_16x16x32_bf16 a[20:23], v[60:63], v[68:71], a[20:23]
    v_mfma_f32_16x16x32_bf16 a[24:27], v[60:63], v[72:75], a[24:27]
    v_mfma_f32_16x16x32_bf16 a[28:31], v[60:63], v[76:79], a[28:31]
    buffer_load_dwordx4 v[56:59], v1, s[40:43], s20 offen offset:1024
    buffer_load_dwordx4 v[60:63], v1, s[40:43], s21 offen offset:1024
    buffer_load_dwordx4 v[64:67], v1, s[40:43], s22 offen offset:1024 sc0 sc1
    buffer_load_dwordx4 v[68:71], v1, s[40:43], s23 offen offset:1024 sc0 sc1
    buffer_load_dwordx4 v[72:75], v1, s[40:43], s24 offen offset:1024 sc0 sc1
    buffer_load_dwordx4 v[76:79], v1, s[40:43], s25 offen offset:1024 sc0 sc1
    s_waitcnt vmcnt(42)
    v_mfma_f32_16x16x32_bf16 a[0:3], v[80:83], v[88:91], a[0:3]
    v_mfma_f32_16x16x32_bf16 a[4:7], v[80:83], v[92:95], a[4:7]
    v_mfma_f32_16x16x32_bf16 a[8:11], v[80:83], v[96:99], a[8:11]
    v_mfma_f32_16x16x32_bf16 a[12:15], v[80:83], v[100:103], a[12:15]
    v_mfma_f32_16x16x32_bf16 a[16:19], v[84:87], v[88:91], a[16:19]
    v_mfma_f32_16x16x32_bf16 a[20:23], v[84:87], v[92:95], a[20:23]
    v_mfma_f32_16x16x32_bf16 a[24:27], v[84:87], v[96:99], a[24:27]
    v_mfma_f32_16x16x32_bf16 a[28:31], v[84:87], v[100:103], a[28:31]
    buffer_load_dwordx4 v[80:83], v1, s[40:43], s20 offen offset:2048
    buffer_load_dwordx4 v[84:87], v1, s[40:43], s21 offen offset:2048
    buffer_load_dwordx4 v[88:91], v1, s[40:43], s22 offen offset:2048 sc0 sc1
    buffer_load_dwordx4 v[92:95], v1, s[40:43], s23 offen offset:2048 sc0 sc1
    buffer_load_dwordx4 v[96:99], v1, s[40:43], s24 offen offset:2048 sc0 sc1
    buffer_load_dwordx4 v[100:103], v1, s[40:43], s25 offen offset:2048 sc0 sc1
    s_waitcnt vmcnt(42)
    v_mfma_f32_16x16x32_bf16 a[0:3], v[104:107], v[112:115], a[0:3]
    v_mfma_f32_16x16x32_bf16 a[4:7], v[104:107], v[116:119], a[4:7]
    v_mfma_f32_16x16x32_bf16 a[8:11], v[104:107], v[120:123], a[8:11]
    v_mfma_f32_16x16x32_bf16 a[12:15], v[104:107], v[124:127], a[12:15]
    v_mfma_f32_16x16x32_bf16 a[16:19], v[108:111], v[112:115], a[16:19]
    v_mfma_f32_16x16x32_bf16 a[20:23], v[108:111], v[116:119], a[20:23]
    v_mfma_f32_16x16x32_bf16 a[24:27], v[108:111], v[120:123], a[24:27]
    v_mfma_f32_16x16x32_bf16 a[28:31], v[108:111], v[124:127], a[28:31]
    buffer_load_dwordx4 v[104:107], v1, s[40:43], s20 offen offset:3072
    buffer_load_dwordx4 v[108:111], v1, s[40:43], s21 offen offset:3072
    buffer_load_dwordx4 v[112:115], v1, s[40:43], s22 offen offset:3072 sc0 sc1
    buffer_load_dwordx4 v[116:119], v1, s[40:43], s23 offen offset:3072 sc0 sc1
    buffer_load_dwordx4 v[120:123], v1, s[40:43], s24 offen offset:3072 sc0 sc1
    buffer_load_dwordx4 v[124:127], v1, s[40:43], s25 offen offset:3072 sc0 sc1
    s_waitcnt vmcnt(42)
    v_mfma_f32_16x16x32_bf16 a[0:3], v[128:131], v[136:139], a[0:3]
    v_mfma_f32_16x16x32_bf16 a[4:7], v[128:131], v[140:143], a[4:7]
    v_mfma_f32_16x16x32_bf16 a[8:11], v[128:131], v[144:147], a[8:11]
    v_mfma_f32_16x16x32_bf16 a[12:15], v[128:131], v[148:151], a[12:15]
    v_mfma_f32_16x16x32_bf16 a[16:19], v[132:135], v[136:139], a[16:19]
    v_mfma_f32_16x16x32_bf16 a[20:23], v[132:135], v[140:143], a[20:23]
    v_mfma_f32_16x16x32_bf16 a[24:27], v[132:135], v[144:147], a[24:27]
    v_mfma_f32_16x16x32_bf16 a[28:31], v[132:135], v[148:151], a[28:31]
    s_add_u32 s20, s20, 4096
    s_add_u32 s21, s21, 4096
    s_add_u32 s22, s22, 4096
    s_add_u32 s23, s23, 4096
    s_add_u32 s24, s24, 4096
    s_add_u32 s25, s25, 4096
    buffer_load_dwordx4 v[128:131], v1, s[40:43], s20 offen offset:0
    buffer_load_dwordx4 v[132:135], v1, s[40:43], s21 offen offset:0
    buffer_load_dwordx4 v[136:139], v1, s[40:43], s22 offen offset:0 sc0 sc1
    buffer_load_dwordx4 v[140:143], v1, s[40:43], s23 offen offset:0 sc0 sc1
    buffer_load_dwordx4 v[144:147], v1, s[40:43], s24 offen offset:0 sc0 sc1
    buffer_load_dwordx4 v[148:151], v1, s[40:43], s25 offen offset:0 sc0 sc1
    s_waitcnt vmcnt(42)
    v_mfma_f32_16x16x32_bf16 a[0:3], v[152:155], v[160:163], a[0:3]
    v_mfma_f32_16x16x32_bf16 a[4:7], v[152:155], v[164:167], a[4:7]
    v_mfma_f32_16x16x32_bf16 a[8:11], v[152:155], v[168:171], a[8:11]
    v_mfma_f32_16x16x32_bf16 a[12:15], v[152:155], v[172:175], a[12:15]
    v_mfma_f32_16x16x32_bf16 a[16:19], v[156:159], v[160:163], a[16:19]
    v_mfma_f32_16x16x32_bf16 a[20:23], v[156:159], v[164:167], a[20:23]
    v_mfma_f32_16x16x32_bf16 a[24:27], v[156:159], v[168:171], a[24:27]
    v_mfma_f32_16x16x32_bf16 a[28:31], v[156:159], v[172:175], a[28:31]
    buffer_load_dwordx4 v[152:155], v1, s[40:43], s20 offen offset:1024
    buffer_load_dwordx4 v[156:159], v1, s[40:43], s21 offen offset:1024
    buffer_load_dwordx4 v[160:163], v1, s[40:43], s22 offen offset:1024 sc0 sc1
    buffer_load_dwordx4 v[164:167], v1, s[40:43], s23 offen offset:1024 sc0 sc1
    buffer_load_dwordx4 v[168:171], v1, s[40:43], s24 offen offset:1024 sc0 sc1
    buffer_load_dwordx4 v[172:175], v1, s[40:43], s25 offen offset:1024 sc0 sc1
    s_waitcnt vmcnt(42)
    v_mfma_f32_16x16x32_bf16 a[0:3], v[176:179], v[184:187], a[0:3]
    v_mfma_f32_16x16x32_bf16 a[4:7], v[176:179], v[188:191], a[4:7]
    v_mfma_f32_16x16x32_bf16 a[8:11], v[176:179], v[192:195], a[8:11]
    v_mfma_f32_16x16x32_bf16 a[12:15], v[176:179], v[196:199], a[12:15]
    v_mfma_f32_16x16x32_bf16 a[16:19], v[180:183], v[184:187], a[16:19]
    v_mfma_f32_16x16x32_bf16 a[20:23], v[180:183], v[188:191], a[20:23]
    v_mfma_f32_16x16x32_bf16 a[24:27], v[180:183], v[192:195], a[24:27]
    v_mfma_f32_16x16x32_bf16 a[28:31], v[180:183], v[196:199], a[28:31]
    buffer_load_dwordx4 v[176:179], v1, s[40:43], s20 offen offset:2048
    buffer_load_dwordx4 v[180:183], v1, s[40:43], s21 offen offset:2048
    buffer_load_dwordx4 v[184:187], v1, s[40:43], s22 offen offset:2048 sc0 sc1
    buffer_load_dwordx4 v[188:191], v1, s[40:43], s23 offen offset:2048 sc0 sc1
    buffer_load_dwordx4 v[192:195], v1, s[40:43], s24 offen offset:2048 sc0 sc1
    buffer_load_dwordx4 v[196:199], v1, s[40:43], s25 offen offset:2048 sc0 sc1
    s_waitcnt vmcnt(42)
    v_mfma_f32_16x16x32_bf16 a[0:3], v[200:203], v[208:211], a[0:3]
    v_mfma_f32_16x16x32_bf16 a[4:7], v[200:203], v[212:215], a[4:7]
    v_mfma_f32_16x16x32_bf16 a[8:11], v[200:203], v[216:219], a[8:11]
    v_mfma_f32_16x16x32_bf16 a[12:15], v[200:203], v[220:223], a[12:15]
    v_mfma_f32_16x16x32_bf16 a[16:19], v[204:207], v[208:211], a[16:19]
    v_mfma_f32_16x16x32_bf16 a[20:23], v[204:207], v[212:215], a[20:23]
    v_mfma_f32_16x16x32_bf16 a[24:27], v[204:207], v[216:219], a[24:27]
    v_mfma_f32_16x16x32_bf16 a[28:31], v[204:207], v[220:223], a[28:31]
    buffer_load_dwordx4 v[200:203], v1, s[40:43], s20 offen offset:3072
    buffer_load_dwordx4 v[204:207], v1, s[40:43], s21 offen offset:3072
    buffer_load_dwordx4 v[208:211], v1, s[40:43], s22 offen offset:3072 sc0 sc1
    buffer_load_dwordx4 v[212:215], v1, s[40:43], s23 offen offset:3072 sc0 sc1
    buffer_load_dwordx4 v[216:219], v1, s[40:43], s24 offen offset:3072 sc0 sc1
    buffer_load_dwordx4 v[220:223], v1, s[40:43], s25 offen offset:3072 sc0 sc1
    s_waitcnt vmcnt(42)
    v_mfma_f32_16x16x32_bf16 a[0:3], v[32:35], v[40:43], a[0:3]
    v_mfma_f32_16x16x32_bf16 a[4:7], v[32:35], v[44:47], a[4:7]
    v_mfma_f32_16x16x32_bf16 a[8:11], v[32:35], v[48:51], a[8:11]
    v_mfma_f32_16x16x32_bf16 a[12:15], v[32:35], v[52:55], a[12:15]
    v_mfma_f32_16x16x32_bf16 a[16:19], v[36:39], v[40:43], a[16:19]
    v_mfma_f32_16x16x32_bf16 a[20:23], v[36:39], v[44:47], a[20:23]
    v_mfma_f32_16x16x32_bf16 a[24:27], v[36:39], v[48:51], a[24:27]
    v_mfma_f32_16x16x32_bf16 a[28:31], v[36:39], v[52:55], a[28:31]
    s_waitcnt vmcnt(36)
    v_mfma_f32_16x16x32_bf16 a[0:3], v[56:59], v[64:67], a[0:3]
    v_mfma_f32_16x16x32_bf16 a[4:7], v[56:59], v[68:71], a[4:7]
    v_mfma_f32_16x16x32_bf16 a[8:11], v[56:59], v[72:75], a[8:11]
    v_mfma_f32_16x16x32_bf16 a[12:15], v[56:59], v[76:79], a[12:15]
    v_mfma_f32_16x16x32_bf16 a[16:19], v[60:63], v[64:67], a[16:19]
    v_mfma_f32_16x16x32_bf16 a[20:23], v[60:63], v[68:71], a[20:23]
    v_mfma_f32_16x16x32_bf16 a[24:27], v[60:63], v[72:75], a[24:27]
    v_mfma_f32_16x16x32_bf16 a[28:31], v[60:63], v[76:79], a[28:31]
    s_waitcnt vmcnt(30)
    v_mfma_f32_16x16x32_bf16 a[0:3], v[80:83], v[88:91], a[0:3]
    v_mfma_f32_16x16x32_bf16 a[4:7], v[80:83], v[92:95], a[4:7]
    v_mfma_f32_16x16x32_bf16 a[8:11], v[80:83], v[96:99], a[8:11]
    v_mfma_f32_16x16x32_bf16 a[12:15], v[80:83], v[100:103], a[12:15]
    v_mfma_f32_16x16x32_bf16 a[16:19], v[84:87], v[88:91], a[16:19]
    v_mfma_f32_16x16x32_bf16 a[20:23], v[84:87], v[92:95], a[20:23]
    v_mfma_f32_16x16x32_bf16 a[24:27], v[84:87], v[96:99], a[24:27]
    v_mfma_f32_16x16x32_bf16 a[28:31], v[84:87], v[100:103], a[28:31]
    s_waitcnt vmcnt(24)
    v_mfma_f32_16x16x32_bf16 a[0:3], v[104:107], v[112:115], a[0:3]
    v_mfma_f32_16x16x32_bf16 a[4:7], v[104:107], v[116:119], a[4:7]
    v_mfma_f32_16x16x32_bf16 a[8:11], v[104:107], v[120:123], a[8:11]
    v_mfma_f32_16x16x32_bf16 a[12:15], v[104:107], v[124:127], a[12:15]
    v_mfma_f32_16x16x32_bf16 a[16:19], v[108:111], v[112:115], a[16:19]
    v_mfma_f32_16x16x32_bf16 a[20:23], v[108:111], v[116:119], a[20:23]
    v_mfma_f32_16x16x32_bf16 a[24:27], v[108:111], v[120:123], a[24:27]
    v_mfma_f32_16x16x32_bf16 a[28:31], v[108:111], v[124:127], a[28:31]
    s_waitcnt vmcnt(18)
    v_mfma_f32_16x16x32_bf16 a[0:3], v[128:131], v[136:139], a[0:3]
    v_mfma_f32_16x16x32_bf16 a[4:7], v[128:131], v[140:143], a[4:7]
    v_mfma_f32_16x16x32_bf16 a[8:11], v[128:131], v[144:147], a[8:11]
    v_mfma_f32_16x16x32_bf16 a[12:15], v[128:131], v[148:151], a[12:15]
    v_mfma_f32_16x16x32_bf16 a[16:19], v[132:135], v[136:139], a[16:19]
    v_mfma_f32_16x16x32_bf16 a[20:23], v[132:135], v[140:143], a[20:23]
    v_mfma_f32_16x16x32_bf16 a[24:27], v[132:135], v[144:147], a[24:27]
    v_mfma_f32_16x16x32_bf16 a[28:31], v[132:135], v[148:151], a[28:31]
    s_waitcnt vmcnt(12)
    v_mfma_f32_16x16x32_bf16 a[0:3], v[152:155], v[160:163], a[0:3]
    v_mfma_f32_16x16x32_bf16 a[4:7], v[152:155], v[164:167], a[4:7]
    v_mfma_f32_16x16x32_bf16 a[8:11], v[152:155], v[168:171], a[8:11]
    v_mfma_f32_16x16x32_bf16 a[12:15], v[152:155], v[172:175], a[12:15]
    v_mfma_f32_16x16x32_bf16 a[16:19], v[156:159], v[160:163], a[16:19]
    v_mfma_f32_16x16x32_bf16 a[20:23], v[156:159], v[164:167], a[20:23]
    v_mfma_f32_16x16x32_bf16 a[24:27], v[156:159], v[168:171], a[24:27]
    v_mfma_f32_16x16x32_bf16 a[28:31], v[156:159], v[172:175], a[28:31]
    s_waitcnt vmcnt(6)
    v_mfma_f32_16x16x32_bf16 a[0:3], v[176:179], v[184:187], a[0:3]
    v_mfma_f32_16x16x32_bf16 a[4:7], v[176:179], v[188:191], a[4:7]
    v_mfma_f32_16x16x32_bf16 a[8:11], v[176:179], v[192:195], a[8:11]
    v_mfma_f32_16x16x32_bf16 a[12:15], v[176:179], v[196:199], a[12:15]
    v_mfma_f32_16x16x32_bf16 a[16:19], v[180:183], v[184:187], a[16:19]
    v_mfma_f32_16x16x32_bf16 a[20:23], v[180:183], v[188:191], a[20:23]
    v_mfma_f32_16x16x32_bf16 a[24:27], v[180:183], v[192:195], a[24:27]
    v_mfma_f32_16x16x32_bf16 a[28:31], v[180:183], v[196:199], a[28:31]
    s_waitcnt vmcnt(0)
    v_mfma_f32_16x16x32_bf16 a[0:3], v[200:203], v[208:211], a[0:3]
    v_mfma_f32_16x16x32_bf16 a[4:7], v[200:203], v[212:215], a[4:7]
    v_mfma_f32_16x16x32_bf16 a[8:11], v[200:203], v[216:219], a[8:11]
    v_mfma_f32_16x16x32_bf16 a[12:15], v[200:203], v[220:223], a[12:15]
    v_mfma_f32_16x16x32_bf16 a[16:19], v[204:207], v[208:211], a[16:19]
    v_mfma_f32_16x16x32_bf16 a[20:23], v[204:207], v[212:215], a[20:23]
    v_mfma_f32_16x16x32_bf16 a[24:27], v[204:207], v[216:219], a[24:27]
    v_mfma_f32_16x16x32_bf16 a[28:31], v[204:207], v[220:223], a[28:31]
    s_nop 7
    s_nop 1
    s_mul_i32 s14, s3, 16384
    v_add_u32 v4, s14, v1

    ds_write_b128 v4, a[0:3] offset:0
    ds_write_b128 v4, a[4:7] offset:1024
    ds_write_b128 v4, a[8:11] offset:2048
    ds_write_b128 v4, a[12:15] offset:3072
    ds_write_b128 v4, a[16:19] offset:4096
    ds_write_b128 v4, a[20:23] offset:5120
    ds_write_b128 v4, a[24:27] offset:6144
    ds_write_b128 v4, a[28:31] offset:7168
    ds_write_b128 v4, a[32:35] offset:8192
    ds_write_b128 v4, a[36:39] offset:9216
    ds_write_b128 v4, a[40:43] offset:10240
    ds_write_b128 v4, a[44:47] offset:11264
    ds_write_b128 v4, a[48:51] offset:12288
    ds_write_b128 v4, a[52:55] offset:13312
    ds_write_b128 v4, a[56:59] offset:14336
    ds_write_b128 v4, a[60:63] offset:15360
    s_lshl_b32 s14, s5, 16
    s_lshl_b32 s15, s3, 14
    s_add_u32 s14, s14, s15
    s_mul_i32 s15, s4, 64
    s_add_u32 s14, s14, s15
    v_lshlrev_b32 v7, 10, v8
    v_lshl_add_u32 v7, v9, 3, v7
    v_add_u32 v7, s14, v7

    buffer_load_dwordx2 v[16:17], v7, s[84:87], 0 offen offset:0
    buffer_load_dwordx2 v[18:19], v7, s[84:87], 0 offen offset:32
    s_waitcnt lgkmcnt(0)
    s_barrier
    s_lshl_b32 s14, s3, 10
    v_add_u32 v4, s14, v1

    ds_read_b128 v[32:35], v4 offset:0
    ds_read_b128 v[36:39], v4 offset:16384
    ds_read_b128 v[40:43], v4 offset:32768
    ds_read_b128 v[44:47], v4 offset:49152
    ds_read_b128 v[48:51], v4 offset:4096
    ds_read_b128 v[52:55], v4 offset:20480
    ds_read_b128 v[56:59], v4 offset:36864
    ds_read_b128 v[60:63], v4 offset:53248
    ds_read_b128 v[64:67], v4 offset:8192
    ds_read_b128 v[68:71], v4 offset:24576
    ds_read_b128 v[72:75], v4 offset:40960
    ds_read_b128 v[76:79], v4 offset:57344
    ds_read_b128 v[80:83], v4 offset:12288
    ds_read_b128 v[84:87], v4 offset:28672
    ds_read_b128 v[88:91], v4 offset:45056
    ds_read_b128 v[92:95], v4 offset:61440
    s_waitcnt lgkmcnt(0)
    v_add_f32 v32, v32, v36
    v_add_f32 v40, v40, v44
    v_add_f32 v32, v32, v40
    v_add_f32 v33, v33, v37
    v_add_f32 v41, v41, v45
    v_add_f32 v33, v33, v41
    v_add_f32 v34, v34, v38
    v_add_f32 v42, v42, v46
    v_add_f32 v34, v34, v42
    v_add_f32 v35, v35, v39
    v_add_f32 v43, v43, v47
    v_add_f32 v35, v35, v43
    v_add_f32 v48, v48, v52
    v_add_f32 v56, v56, v60
    v_add_f32 v48, v48, v56
    v_add_f32 v49, v49, v53
    v_add_f32 v57, v57, v61
    v_add_f32 v49, v49, v57
    v_add_f32 v50, v50, v54
    v_add_f32 v58, v58, v62
    v_add_f32 v50, v50, v58
    v_add_f32 v51, v51, v55
    v_add_f32 v59, v59, v63
    v_add_f32 v51, v51, v59
    v_add_f32 v64, v64, v68
    v_add_f32 v72, v72, v76
    v_add_f32 v64, v64, v72
    v_add_f32 v65, v65, v69
    v_add_f32 v73, v73, v77
    v_add_f32 v65, v65, v73
    v_add_f32 v66, v66, v70
    v_add_f32 v74, v74, v78
    v_add_f32 v66, v66, v74
    v_add_f32 v67, v67, v71
    v_add_f32 v75, v75, v79
    v_add_f32 v67, v67, v75
    v_add_f32 v80, v80, v84
    v_add_f32 v88, v88, v92
    v_add_f32 v80, v80, v88
    v_add_f32 v81, v81, v85
    v_add_f32 v89, v89, v93
    v_add_f32 v81, v81, v89
    v_add_f32 v82, v82, v86
    v_add_f32 v90, v90, v94
    v_add_f32 v82, v82, v90
    v_add_f32 v83, v83, v87
    v_add_f32 v91, v91, v95
    v_add_f32 v83, v83, v91
    s_waitcnt vmcnt(0)
    v_cvt_pk_bf16_f32 v10, v32, v33
    v_cvt_pk_bf16_f32 v11, v64, v65
    v_lshlrev_b32 v12, 16, v10
    v_and_b32 v13, 0xffff0000, v10
    v_lshlrev_b32 v14, 16, v16
    v_and_b32 v15, 0xffff0000, v16
    v_add_f32 v12, v12, v14
    v_add_f32 v13, v13, v15
    v_cvt_pk_bf16_f32 v10, v12, v13
    v_lshlrev_b32 v12, 16, v10
    v_and_b32 v13, 0xffff0000, v10
    v_lshlrev_b32 v14, 16, v11
    v_and_b32 v15, 0xffff0000, v11
    v_add_f32 v12, v12, v14
    v_add_f32 v13, v13, v15
    v_cvt_pk_bf16_f32 v24, v12, v13

    v_cvt_pk_bf16_f32 v10, v34, v35
    v_cvt_pk_bf16_f32 v11, v66, v67
    v_lshlrev_b32 v12, 16, v10
    v_and_b32 v13, 0xffff0000, v10
    v_lshlrev_b32 v14, 16, v17
    v_and_b32 v15, 0xffff0000, v17
    v_add_f32 v12, v12, v14
    v_add_f32 v13, v13, v15
    v_cvt_pk_bf16_f32 v10, v12, v13
    v_lshlrev_b32 v12, 16, v10
    v_and_b32 v13, 0xffff0000, v10
    v_lshlrev_b32 v14, 16, v11
    v_and_b32 v15, 0xffff0000, v11
    v_add_f32 v12, v12, v14
    v_add_f32 v13, v13, v15
    v_cvt_pk_bf16_f32 v25, v12, v13

    buffer_store_dwordx2 v[24:25], v7, s[88:91], 0 offen offset:0
    v_cvt_pk_bf16_f32 v10, v48, v49
    v_cvt_pk_bf16_f32 v11, v80, v81
    v_lshlrev_b32 v12, 16, v10
    v_and_b32 v13, 0xffff0000, v10
    v_lshlrev_b32 v14, 16, v18
    v_and_b32 v15, 0xffff0000, v18
    v_add_f32 v12, v12, v14
    v_add_f32 v13, v13, v15
    v_cvt_pk_bf16_f32 v10, v12, v13
    v_lshlrev_b32 v12, 16, v10
    v_and_b32 v13, 0xffff0000, v10
    v_lshlrev_b32 v14, 16, v11
    v_and_b32 v15, 0xffff0000, v11
    v_add_f32 v12, v12, v14
    v_add_f32 v13, v13, v15
    v_cvt_pk_bf16_f32 v26, v12, v13

    v_cvt_pk_bf16_f32 v10, v50, v51
    v_cvt_pk_bf16_f32 v11, v82, v83
    v_lshlrev_b32 v12, 16, v10
    v_and_b32 v13, 0xffff0000, v10
    v_lshlrev_b32 v14, 16, v19
    v_and_b32 v15, 0xffff0000, v19
    v_add_f32 v12, v12, v14
    v_add_f32 v13, v13, v15
    v_cvt_pk_bf16_f32 v10, v12, v13
    v_lshlrev_b32 v12, 16, v10
    v_and_b32 v13, 0xffff0000, v10
    v_lshlrev_b32 v14, 16, v11
    v_and_b32 v15, 0xffff0000, v11
    v_add_f32 v12, v12, v14
    v_add_f32 v13, v13, v15
    v_cvt_pk_bf16_f32 v27, v12, v13

    buffer_store_dwordx2 v[26:27], v7, s[88:91], 0 offen offset:32
    s_branch L_w_loop
L_ch_done:
L_ch_end:
    s_endpgm
.section .rodata,"a"
.p2align 6
.amdhsa_kernel prep_kernel
  .amdhsa_next_free_vgpr 208
  .amdhsa_next_free_sgpr 48
  .amdhsa_accum_offset 208
  .amdhsa_group_segment_fixed_size 0
  .amdhsa_kernarg_size 112
  .amdhsa_user_sgpr_count 2
  .amdhsa_user_sgpr_kernarg_segment_ptr 1
  .amdhsa_system_sgpr_workgroup_id_x 1
.end_amdhsa_kernel
.section .rodata,"a"
.p2align 6
.amdhsa_kernel chain_kernel
  .amdhsa_next_free_vgpr 512
  .amdhsa_next_free_sgpr 100
  .amdhsa_accum_offset 256
  .amdhsa_group_segment_fixed_size 0
  .amdhsa_kernarg_size 112
  .amdhsa_user_sgpr_count 2
  .amdhsa_user_sgpr_kernarg_segment_ptr 1
  .amdhsa_system_sgpr_workgroup_id_x 1
.end_amdhsa_kernel
```
